```python
import torch

def _softmax(x, axis=-1):
    return torch.softmax(x, dim=axis)
def _gelu(x):
    return torch.nn.functional.gelu(x, approximate="tanh")
def _silu(x):
    return torch.nn.functional.silu(x)
def _sigmoid(x):
    return torch.sigmoid(x)
def _layernorm(x, axis=-1, eps=1e-5):
    m = x.mean(dim=axis, keepdim=True)
    v = x.var(dim=axis, keepdim=True, unbiased=False)
    return (x - m) / torch.sqrt(v + eps)
def _scatter_add(tgt, idx, src, axis=0):
    return tgt.clone().index_add_(axis, idx, src)
def _segment_sum(src, seg, n):
    out = torch.zeros((n,) + src.shape[1:], dtype=src.dtype)
    return out.index_add_(0, seg, src)
def _pad(x, pw):
    flat = tuple(v for pair in reversed(pw) for v in pair)
    return torch.nn.functional.pad(x, flat)

kernel_name = 'sequential_preLN__linear_attn_block__glu_gated_bilinear__prompt'

def setup_inputs():

    _w = (lambda a: (lambda t: t.to(torch.bfloat16) if t.is_floating_point() else t)(torch.as_tensor(a)))
    def _A_setup():
        B, S, D = 1, 2048, 576
        return {
            "x": _w((lambda *s: torch.randn(*s, dtype=torch.bfloat16) * 0.05)(B, S, D)),
            "wqkv": _w((lambda *s: torch.randn(*s, dtype=torch.bfloat16) * 0.05)(D, 3 * D)),
            "wo": _w((lambda *s: torch.randn(*s, dtype=torch.bfloat16) * 0.05)(D, D)),
        }
    _A_in = _A_setup()

    def _B_setup():
        B, S, D, F = 1, 2048, 576, 4608
        return {
            "x": _w((lambda *s: torch.randn(*s, dtype=torch.bfloat16) * 0.05)(B, S, D)),
            "w_gate": _w((lambda *s: torch.randn(*s, dtype=torch.bfloat16) * 0.4)(D, F) * (D ** -0.5)),
            "w_up": _w((lambda *s: torch.randn(*s, dtype=torch.bfloat16) * 0.4)(D, F) * (D ** -0.5)),
            "w_down": _w((lambda *s: torch.randn(*s, dtype=torch.bfloat16) * 0.4)(F, D) * (F ** -0.5)),
        }
    _B_in = _B_setup()

    return {
        "A_x": _A_in["x"],
        "A_wqkv": _A_in["wqkv"],
        "A_wo": _A_in["wo"],
        "B_x": _B_in["x"],
        "B_w_gate": _B_in["w_gate"],
        "B_w_up": _B_in["w_up"],
        "B_w_down": _B_in["w_down"],
    }

def reference(A_x, A_wqkv, A_wo, B_x, B_w_gate, B_w_up, B_w_down):
    def _A_ref(x, wqkv, wo):
        B, S, D = x.shape
        H = 32; Dh = D // H
        qkv = (lambda x, *d: x.permute(*d))((x @ wqkv).reshape(B, S, 3, H, Dh), 2, 0, 3, 1, 4)
        q, k, v = qkv[0], qkv[1], qkv[2]
        phi = lambda t: torch.where(t > 0, t + 1, torch.exp(t)) + 1e-6
        pq, pk = phi(q), phi(k)
        kv = torch.einsum("bhsd,bhse->bhde", pk, v)
        z = torch.einsum("bhsd->bhd", pk)
        num = torch.einsum("bhqd,bhde->bhqe", pq, kv)
        den = torch.einsum("bhqd,bhd->bhq", pq, z)[..., None] + 1e-6
        o = num / den
        return (lambda x, *d: x.permute(*d))(o, 0, 2, 1, 3).reshape(B, S, D) @ wo

    def _B_ref(x, w_gate, w_up, w_down):
        g = torch.einsum("bsd,df->bsf", x, w_gate)
        u = torch.einsum("bsd,df->bsf", x, w_up)
        h = g * u
        return torch.einsum("bsf,fd->bsd", h, w_down)

    x = A_x
    h = x + _A_ref(_layernorm(x, axis=-1), A_wqkv, A_wo)
    h2 = h + _B_ref(_layernorm(h, axis=-1), B_w_gate, B_w_up, B_w_down)
    return h2
```

```asm
; @launch kernel=k1_kernel grid=(256,1,1) block=(640,1,1) lds=147456
; @launch kernel=k3_kernel grid=(256,1,1) block=(512,1,1) lds=163840
; @launch kernel=ffn_kernel grid=(256,1,1) block=(256,1,1) lds=163840
; @launch kernel=red_kernel grid=(576,1,1) block=(256,1,1) lds=0
.amdgcn_target "amdgcn-amd-amdhsa--gfx950"
.text
.globl k1_kernel
.p2align 8
.type k1_kernel,@function
k1_kernel:
    s_cmp_ge_u32 s2, 256
    s_cbranch_scc1 k1_kernel_end
    s_load_dwordx4 s[56:59], s[0:1], 0
    s_load_dwordx4 s[60:63], s[0:1], 64
    s_load_dwordx4 s[24:27], s[0:1], 32
    s_load_dwordx2 s[96:97], s[0:1], 48
    v_lshrrev_b32 v24, 6, v0
    v_and_b32 v0, 63, v0
    v_readfirstlane_b32 s32, v24
    s_and_b32 s33, s2, 7
    s_lshr_b32 s34, s2, 3
    s_cmp_ge_u32 s34, 24
    s_cbranch_scc1 k1_kernel_spare
    s_and_b32 s92, s32, 3
    s_lshr_b32 s93, s32, 2
    s_lshl_b32 s95, s93, 1
    s_add_u32 s95, s95, s92
    s_and_b32 s95, s95, 3
    s_lshr_b32 s36, s33, 1
    s_lshl_b32 s36, s36, 2
    s_and_b32 s37, s33, 1
    s_cmp_ge_u32 s34, 16
    s_cselect_b32 s3, 1, 0
    s_cbranch_scc1 k1_kernel_decq
    s_lshr_b32 s38, s34, 2
    s_add_u32 s6, s36, s38
    s_lshl_b32 s37, s37, 2
    s_and_b32 s38, s34, 3
    s_add_u32 s7, s37, s38
    s_mul_i32 s38, s7, 144
    s_add_u32 s38, s38, 1152
    s_movk_i32 s39, 1152
    s_branch k1_kernel_decd
k1_kernel_decq:
    s_sub_u32 s38, s34, 16
    s_lshr_b32 s38, s38, 1
    s_add_u32 s6, s36, s38
    s_lshl_b32 s37, s37, 1
    s_and_b32 s38, s34, 1
    s_add_u32 s7, s37, s38
    s_mul_i32 s38, s7, 288
    s_movk_i32 s39, 144
k1_kernel_decd:
    v_and_b32 v25, 15, v0
    v_lshrrev_b32 v26, 4, v0
    s_cmp_ge_u32 s32, 8
    s_cbranch_scc1 k1_kernel_loader
    v_bfe_u32 v27, v0, 2, 2
    v_and_b32 v28, 1, v26
    v_lshl_add_u32 v28, v28, 2, v27
    v_lshlrev_b32 v28, 1, v28
    v_lshl_add_u32 v27, v26, 3, v27
    v_lshlrev_b32 v27, 8, v27
    s_lshl_b32 s36, s93, 13
    v_add_u32 v27, s36, v27
    v_bfe_u32 v29, v0, 1, 1
    v_add_u32 v29, v29, v28
    v_and_b32 v30, 1, v0
    v_lshl_add_u32 v30, v30, 3, v27
    v_add_u32 v31, 0, v29
    v_and_b32 v31, 15, v31
    v_lshl_add_u32 v5, v31, 4, v30
    v_add_u32 v31, 3, v29
    v_and_b32 v31, 15, v31
    v_lshl_add_u32 v6, v31, 4, v30
    v_add_u32 v31, 6, v29
    v_and_b32 v31, 15, v31
    v_lshl_add_u32 v7, v31, 4, v30
    v_add_u32 v31, 9, v29
    v_and_b32 v31, 15, v31
    v_lshl_add_u32 v8, v31, 4, v30
    v_and_b32 v31, 3, v0
    v_mul_u32_u24 v31, 3, v31
    v_add3_u32 v31, v31, v28, 2
    v_and_b32 v31, 15, v31
    v_lshl_add_u32 v9, v31, 4, v27
    v_add_u32 v9, 8, v9
    v_add_u32 v10, 49152, v5
    v_add_u32 v11, 49152, v6
    v_add_u32 v12, 49152, v7
    v_add_u32 v13, 49152, v8
    v_add_u32 v14, 49152, v9
    v_lshrrev_b32 v27, 1, v25
    v_xor_b32 v27, v27, v26
    v_lshlrev_b32 v27, 4, v27
    v_lshl_add_u32 v27, v25, 7, v27
    s_lshl_b32 s36, s92, 12
    s_add_u32 s36, s36, 98304
    v_add_u32 v15, s36, v27
    v_xor_b32 v27, 64, v27
    v_add_u32 v16, s36, v27
    v_mov_b32 v20, 0x3f803f80
    v_mov_b32 v21, 0x3f803f80
    v_mov_b32 v22, 0x3f803f80
    v_mov_b32 v23, 0x3f803f80
    v_mov_b32 v32, 0xbae38e39
    v_mov_b32 v33, 0x3727c5ac
    v_mov_b32 v34, 0x3fb8aa3b
    v_mov_b32 v35, 0x3f800008
    v_mov_b32 v36, 0x358637bd
    v_mov_b32 v37, 0x3ae38e39
    s_waitcnt lgkmcnt(0)
    s_mov_b32 s4, s62
    s_mov_b32 s5, s63
    s_mov_b32 s16, s60
    s_mov_b32 s17, s61
    s_mov_b32 s18, 256
    s_mov_b32 s19, 0x20000
    s_add_u32 s20, s4, 2490368
    s_addc_u32 s21, s5, 0
    s_mov_b32 s22, 49152
    s_mov_b32 s23, 0x20000
    s_mul_i32 s36, s7, 6144
    s_lshl_b32 s37, s32, 8
    s_add_u32 s36, s36, s37
    v_lshl_add_u32 v17, v0, 2, s36
    s_or_b32 s37, s6, s3
    s_cmp_eq_u32 s37, 0
    s_cselect_b32 s28, 0, 0x100000
    v_add_u32 v18, s28, v17
    v_mov_b32 v19, 0
    s_movk_i32 s29, 4096
    buffer_store_dword v19, v18, s[20:23], 0 offen sc1
    buffer_store_dword v19, v18, s[20:23], 0 offen offset:2048 sc1
    buffer_store_dword v19, v18, s[20:23], s29 offen sc1
    s_lshl_b32 s94, s7, 3
    s_add_u32 s94, s94, s32
    s_lshl_b32 s94, s94, 2
    s_cmp_eq_u32 s3, 1
    s_cbranch_scc1 k1_kernel_q
    s_barrier
    ds_read_b128 v[148:151], v15 offset:0
    ds_read_b128 v[152:155], v15 offset:2048
    ds_read_b64_tr_b16 v[108:109], v5 offset:0
    ds_read_b64_tr_b16 v[110:111], v5 offset:1024
    ds_read_b64_tr_b16 v[112:113], v6 offset:0
    ds_read_b64_tr_b16 v[114:115], v6 offset:1024
    ds_read_b64_tr_b16 v[116:117], v7 offset:0
    ds_read_b64_tr_b16 v[118:119], v7 offset:1024
    ds_read_b64_tr_b16 v[120:121], v8 offset:0
    ds_read_b64_tr_b16 v[122:123], v8 offset:1024
    ds_read_b64_tr_b16 v[124:125], v9 offset:0
    ds_read_b64_tr_b16 v[126:127], v9 offset:1024
    s_waitcnt lgkmcnt(0)
    v_mfma_f32_16x16x32_bf16 v[40:43], v[148:151], v[108:111], 0
    ds_read_b128 v[156:159], v16 offset:0
    ds_read_b128 v[160:163], v16 offset:2048
    v_mfma_f32_16x16x32_bf16 v[44:47], v[152:155], v[108:111], 0
    ds_read_b64_tr_b16 v[128:129], v5 offset:16384
    ds_read_b64_tr_b16 v[130:131], v5 offset:17408
    v_mfma_f32_16x16x32_bf16 v[48:51], v[148:151], v[112:115], 0
    ds_read_b64_tr_b16 v[132:133], v6 offset:16384
    v_mfma_f32_16x16x32_bf16 v[52:55], v[152:155], v[112:115], 0
    ds_read_b64_tr_b16 v[134:135], v6 offset:17408
    v_mfma_f32_16x16x32_bf16 v[56:59], v[148:151], v[116:119], 0
    ds_read_b64_tr_b16 v[136:137], v7 offset:16384
    v_mfma_f32_16x16x32_bf16 v[60:63], v[152:155], v[116:119], 0
    ds_read_b64_tr_b16 v[138:139], v7 offset:17408
    v_mfma_f32_16x16x32_bf16 v[64:67], v[148:151], v[120:123], 0
    ds_read_b64_tr_b16 v[140:141], v8 offset:16384
    v_mfma_f32_16x16x32_bf16 v[68:71], v[152:155], v[120:123], 0
    ds_read_b64_tr_b16 v[142:143], v8 offset:17408
    v_mfma_f32_16x16x32_bf16 v[72:75], v[148:151], v[124:127], 0
    ds_read_b64_tr_b16 v[144:145], v9 offset:16384
    v_mfma_f32_16x16x32_bf16 v[76:79], v[152:155], v[124:127], 0
    ds_read_b64_tr_b16 v[146:147], v9 offset:17408
    s_cmp_eq_u32 s93, 0
    s_cbranch_scc1 k1_kernel_s_1a
    v_mfma_f32_16x16x32_bf16 v[80:83], v[148:151], v[148:151], 0
    v_mfma_f32_16x16x32_bf16 v[84:87], v[152:155], v[152:155], 0
    s_branch k1_kernel_s_1b
k1_kernel_s_1a:
    v_mfma_f32_16x16x32_bf16 v[80:83], v[148:151], v[20:23], 0
    v_mfma_f32_16x16x32_bf16 v[84:87], v[152:155], v[20:23], 0
k1_kernel_s_1b:
    s_cmp_lg_u32 s95, 0
    s_cbranch_scc1 k1_kernel_s_1c
    v_mfma_f32_16x16x32_bf16 v[88:91], v[20:23], v[108:111], 0
    v_mfma_f32_16x16x32_bf16 v[92:95], v[20:23], v[112:115], 0
    v_mfma_f32_16x16x32_bf16 v[96:99], v[20:23], v[116:119], 0
    v_mfma_f32_16x16x32_bf16 v[100:103], v[20:23], v[120:123], 0
    v_mfma_f32_16x16x32_bf16 v[104:107], v[20:23], v[124:127], 0
k1_kernel_s_1c:
    s_waitcnt lgkmcnt(0)
    s_barrier
    v_mfma_f32_16x16x32_bf16 v[40:43], v[156:159], v[128:131], v[40:43]
    ds_read_b128 v[148:151], v15 offset:16384
    ds_read_b128 v[152:155], v15 offset:18432
    v_mfma_f32_16x16x32_bf16 v[44:47], v[160:163], v[128:131], v[44:47]
    ds_read_b64_tr_b16 v[108:109], v5 offset:32768
    ds_read_b64_tr_b16 v[110:111], v5 offset:33792
    v_mfma_f32_16x16x32_bf16 v[48:51], v[156:159], v[132:135], v[48:51]
    ds_read_b64_tr_b16 v[112:113], v6 offset:32768
    v_mfma_f32_16x16x32_bf16 v[52:55], v[160:163], v[132:135], v[52:55]
    ds_read_b64_tr_b16 v[114:115], v6 offset:33792
    v_mfma_f32_16x16x32_bf16 v[56:59], v[156:159], v[136:139], v[56:59]
    ds_read_b64_tr_b16 v[116:117], v7 offset:32768
    v_mfma_f32_16x16x32_bf16 v[60:63], v[160:163], v[136:139], v[60:63]
    ds_read_b64_tr_b16 v[118:119], v7 offset:33792
    v_mfma_f32_16x16x32_bf16 v[64:67], v[156:159], v[140:143], v[64:67]
    ds_read_b64_tr_b16 v[120:121], v8 offset:32768
    v_mfma_f32_16x16x32_bf16 v[68:71], v[160:163], v[140:143], v[68:71]
    ds_read_b64_tr_b16 v[122:123], v8 offset:33792
    v_mfma_f32_16x16x32_bf16 v[72:75], v[156:159], v[144:147], v[72:75]
    ds_read_b64_tr_b16 v[124:125], v9 offset:32768
    v_mfma_f32_16x16x32_bf16 v[76:79], v[160:163], v[144:147], v[76:79]
    ds_read_b64_tr_b16 v[126:127], v9 offset:33792
    s_cmp_eq_u32 s93, 0
    s_cbranch_scc1 k1_kernel_s_2a
    v_mfma_f32_16x16x32_bf16 v[80:83], v[156:159], v[156:159], v[80:83]
    v_mfma_f32_16x16x32_bf16 v[84:87], v[160:163], v[160:163], v[84:87]
    s_branch k1_kernel_s_2b
k1_kernel_s_2a:
    v_mfma_f32_16x16x32_bf16 v[80:83], v[156:159], v[20:23], v[80:83]
    v_mfma_f32_16x16x32_bf16 v[84:87], v[160:163], v[20:23], v[84:87]
k1_kernel_s_2b:
    s_cmp_lg_u32 s95, 1
    s_cbranch_scc1 k1_kernel_s_2c
    v_mfma_f32_16x16x32_bf16 v[88:91], v[20:23], v[128:131], 0
    v_mfma_f32_16x16x32_bf16 v[92:95], v[20:23], v[132:135], 0
    v_mfma_f32_16x16x32_bf16 v[96:99], v[20:23], v[136:139], 0
    v_mfma_f32_16x16x32_bf16 v[100:103], v[20:23], v[140:143], 0
    v_mfma_f32_16x16x32_bf16 v[104:107], v[20:23], v[144:147], 0
k1_kernel_s_2c:
    s_waitcnt lgkmcnt(0)
    v_mfma_f32_16x16x32_bf16 v[40:43], v[148:151], v[108:111], v[40:43]
    ds_read_b128 v[156:159], v16 offset:16384
    ds_read_b128 v[160:163], v16 offset:18432
    v_mfma_f32_16x16x32_bf16 v[44:47], v[152:155], v[108:111], v[44:47]
    ds_read_b64_tr_b16 v[128:129], v10 offset:0
    ds_read_b64_tr_b16 v[130:131], v10 offset:1024
    v_mfma_f32_16x16x32_bf16 v[48:51], v[148:151], v[112:115], v[48:51]
    ds_read_b64_tr_b16 v[132:133], v11 offset:0
    v_mfma_f32_16x16x32_bf16 v[52:55], v[152:155], v[112:115], v[52:55]
    ds_read_b64_tr_b16 v[134:135], v11 offset:1024
    v_mfma_f32_16x16x32_bf16 v[56:59], v[148:151], v[116:119], v[56:59]
    ds_read_b64_tr_b16 v[136:137], v12 offset:0
    v_mfma_f32_16x16x32_bf16 v[60:63], v[152:155], v[116:119], v[60:63]
    ds_read_b64_tr_b16 v[138:139], v12 offset:1024
    v_mfma_f32_16x16x32_bf16 v[64:67], v[148:151], v[120:123], v[64:67]
    ds_read_b64_tr_b16 v[140:141], v13 offset:0
    v_mfma_f32_16x16x32_bf16 v[68:71], v[152:155], v[120:123], v[68:71]
    ds_read_b64_tr_b16 v[142:143], v13 offset:1024
    v_mfma_f32_16x16x32_bf16 v[72:75], v[148:151], v[124:127], v[72:75]
    ds_read_b64_tr_b16 v[144:145], v14 offset:0
    v_mfma_f32_16x16x32_bf16 v[76:79], v[152:155], v[124:127], v[76:79]
    ds_read_b64_tr_b16 v[146:147], v14 offset:1024
    s_cmp_eq_u32 s93, 0
    s_cbranch_scc1 k1_kernel_s_3a
    v_mfma_f32_16x16x32_bf16 v[80:83], v[148:151], v[148:151], v[80:83]
    v_mfma_f32_16x16x32_bf16 v[84:87], v[152:155], v[152:155], v[84:87]
    s_branch k1_kernel_s_3b
k1_kernel_s_3a:
    v_mfma_f32_16x16x32_bf16 v[80:83], v[148:151], v[20:23], v[80:83]
    v_mfma_f32_16x16x32_bf16 v[84:87], v[152:155], v[20:23], v[84:87]
k1_kernel_s_3b:
    s_cmp_lg_u32 s95, 2
    s_cbranch_scc1 k1_kernel_s_3c
    v_mfma_f32_16x16x32_bf16 v[88:91], v[20:23], v[108:111], 0
    v_mfma_f32_16x16x32_bf16 v[92:95], v[20:23], v[112:115], 0
    v_mfma_f32_16x16x32_bf16 v[96:99], v[20:23], v[116:119], 0
    v_mfma_f32_16x16x32_bf16 v[100:103], v[20:23], v[120:123], 0
    v_mfma_f32_16x16x32_bf16 v[104:107], v[20:23], v[124:127], 0
k1_kernel_s_3c:
    s_waitcnt lgkmcnt(0)
    s_barrier
    v_mfma_f32_16x16x32_bf16 v[40:43], v[156:159], v[128:131], v[40:43]
    ds_read_b128 v[148:151], v15 offset:32768
    ds_read_b128 v[152:155], v15 offset:34816
    v_mfma_f32_16x16x32_bf16 v[44:47], v[160:163], v[128:131], v[44:47]
    ds_read_b64_tr_b16 v[108:109], v10 offset:16384
    ds_read_b64_tr_b16 v[110:111], v10 offset:17408
    v_mfma_f32_16x16x32_bf16 v[48:51], v[156:159], v[132:135], v[48:51]
    ds_read_b64_tr_b16 v[112:113], v11 offset:16384
    v_mfma_f32_16x16x32_bf16 v[52:55], v[160:163], v[132:135], v[52:55]
    ds_read_b64_tr_b16 v[114:115], v11 offset:17408
    v_mfma_f32_16x16x32_bf16 v[56:59], v[156:159], v[136:139], v[56:59]
    ds_read_b64_tr_b16 v[116:117], v12 offset:16384
    v_mfma_f32_16x16x32_bf16 v[60:63], v[160:163], v[136:139], v[60:63]
    ds_read_b64_tr_b16 v[118:119], v12 offset:17408
    v_mfma_f32_16x16x32_bf16 v[64:67], v[156:159], v[140:143], v[64:67]
    ds_read_b64_tr_b16 v[120:121], v13 offset:16384
    v_mfma_f32_16x16x32_bf16 v[68:71], v[160:163], v[140:143], v[68:71]
    ds_read_b64_tr_b16 v[122:123], v13 offset:17408
    v_mfma_f32_16x16x32_bf16 v[72:75], v[156:159], v[144:147], v[72:75]
    ds_read_b64_tr_b16 v[124:125], v14 offset:16384
    v_mfma_f32_16x16x32_bf16 v[76:79], v[160:163], v[144:147], v[76:79]
    ds_read_b64_tr_b16 v[126:127], v14 offset:17408
    s_cmp_eq_u32 s93, 0
    s_cbranch_scc1 k1_kernel_s_4a
    v_mfma_f32_16x16x32_bf16 v[80:83], v[156:159], v[156:159], v[80:83]
    v_mfma_f32_16x16x32_bf16 v[84:87], v[160:163], v[160:163], v[84:87]
    s_branch k1_kernel_s_4b
k1_kernel_s_4a:
    v_mfma_f32_16x16x32_bf16 v[80:83], v[156:159], v[20:23], v[80:83]
    v_mfma_f32_16x16x32_bf16 v[84:87], v[160:163], v[20:23], v[84:87]
k1_kernel_s_4b:
    s_cmp_lg_u32 s95, 3
    s_cbranch_scc1 k1_kernel_s_4c
    v_mfma_f32_16x16x32_bf16 v[88:91], v[20:23], v[128:131], 0
    v_mfma_f32_16x16x32_bf16 v[92:95], v[20:23], v[132:135], 0
    v_mfma_f32_16x16x32_bf16 v[96:99], v[20:23], v[136:139], 0
    v_mfma_f32_16x16x32_bf16 v[100:103], v[20:23], v[140:143], 0
    v_mfma_f32_16x16x32_bf16 v[104:107], v[20:23], v[144:147], 0
k1_kernel_s_4c:
    s_waitcnt lgkmcnt(0)
    s_waitcnt vmcnt(0)
    v_mfma_f32_16x16x32_bf16 v[40:43], v[148:151], v[108:111], v[40:43]
    ds_read_b128 v[156:159], v16 offset:32768
    ds_read_b128 v[160:163], v16 offset:34816
    v_mfma_f32_16x16x32_bf16 v[44:47], v[152:155], v[108:111], v[44:47]
    ds_read_b64_tr_b16 v[128:129], v10 offset:32768
    ds_read_b64_tr_b16 v[130:131], v10 offset:33792
    v_mfma_f32_16x16x32_bf16 v[48:51], v[148:151], v[112:115], v[48:51]
    ds_read_b64_tr_b16 v[132:133], v11 offset:32768
    ds_read_b64_tr_b16 v[134:135], v11 offset:33792
    v_mfma_f32_16x16x32_bf16 v[52:55], v[152:155], v[112:115], v[52:55]
    ds_read_b64_tr_b16 v[136:137], v12 offset:32768
    v_mfma_f32_16x16x32_bf16 v[56:59], v[148:151], v[116:119], v[56:59]
    ds_read_b64_tr_b16 v[138:139], v12 offset:33792
    v_mfma_f32_16x16x32_bf16 v[60:63], v[152:155], v[116:119], v[60:63]
    ds_read_b64_tr_b16 v[140:141], v13 offset:32768
    v_mfma_f32_16x16x32_bf16 v[64:67], v[148:151], v[120:123], v[64:67]
    ds_read_b64_tr_b16 v[142:143], v13 offset:33792
    v_mfma_f32_16x16x32_bf16 v[68:71], v[152:155], v[120:123], v[68:71]
    ds_read_b64_tr_b16 v[144:145], v14 offset:32768
    v_mfma_f32_16x16x32_bf16 v[72:75], v[148:151], v[124:127], v[72:75]
    ds_read_b64_tr_b16 v[146:147], v14 offset:33792
    v_mfma_f32_16x16x32_bf16 v[76:79], v[152:155], v[124:127], v[76:79]
    s_add_u32 s36, s94, s28
    v_mov_b32 v18, s36
    v_mov_b32 v19, 1
    buffer_store_dword v19, v18, s[16:19], 0 offen sc1
    s_cmp_eq_u32 s93, 0
    s_cbranch_scc1 k1_kernel_s_5a
    v_mfma_f32_16x16x32_bf16 v[80:83], v[148:151], v[148:151], v[80:83]
    v_mfma_f32_16x16x32_bf16 v[84:87], v[152:155], v[152:155], v[84:87]
    s_branch k1_kernel_s_5b
k1_kernel_s_5a:
    v_mfma_f32_16x16x32_bf16 v[80:83], v[148:151], v[20:23], v[80:83]
    v_mfma_f32_16x16x32_bf16 v[84:87], v[152:155], v[20:23], v[84:87]
k1_kernel_s_5b:
    s_cmp_lg_u32 s95, 0
    s_cbranch_scc1 k1_kernel_s_5c
    v_mfma_f32_16x16x32_bf16 v[88:91], v[20:23], v[108:111], v[88:91]
    v_mfma_f32_16x16x32_bf16 v[92:95], v[20:23], v[112:115], v[92:95]
    v_mfma_f32_16x16x32_bf16 v[96:99], v[20:23], v[116:119], v[96:99]
    v_mfma_f32_16x16x32_bf16 v[100:103], v[20:23], v[120:123], v[100:103]
    v_mfma_f32_16x16x32_bf16 v[104:107], v[20:23], v[124:127], v[104:107]
k1_kernel_s_5c:
    s_waitcnt lgkmcnt(0)
    s_barrier
    v_mfma_f32_16x16x32_bf16 v[40:43], v[156:159], v[128:131], v[40:43]
    ds_read_b128 v[148:151], v15 offset:0
    ds_read_b128 v[152:155], v15 offset:2048
    v_mfma_f32_16x16x32_bf16 v[44:47], v[160:163], v[128:131], v[44:47]
    ds_read_b64_tr_b16 v[108:109], v5 offset:0
    ds_read_b64_tr_b16 v[110:111], v5 offset:1024
    v_mfma_f32_16x16x32_bf16 v[48:51], v[156:159], v[132:135], v[48:51]
    ds_read_b64_tr_b16 v[112:113], v6 offset:0
    v_mfma_f32_16x16x32_bf16 v[52:55], v[160:163], v[132:135], v[52:55]
    ds_read_b64_tr_b16 v[114:115], v6 offset:1024
    v_mfma_f32_16x16x32_bf16 v[56:59], v[156:159], v[136:139], v[56:59]
    ds_read_b64_tr_b16 v[116:117], v7 offset:0
    v_mfma_f32_16x16x32_bf16 v[60:63], v[160:163], v[136:139], v[60:63]
    ds_read_b64_tr_b16 v[118:119], v7 offset:1024
    v_mfma_f32_16x16x32_bf16 v[64:67], v[156:159], v[140:143], v[64:67]
    ds_read_b64_tr_b16 v[120:121], v8 offset:0
    v_mfma_f32_16x16x32_bf16 v[68:71], v[160:163], v[140:143], v[68:71]
    ds_read_b64_tr_b16 v[122:123], v8 offset:1024
    v_mfma_f32_16x16x32_bf16 v[72:75], v[156:159], v[144:147], v[72:75]
    ds_read_b64_tr_b16 v[124:125], v9 offset:0
    v_mfma_f32_16x16x32_bf16 v[76:79], v[160:163], v[144:147], v[76:79]
    ds_read_b64_tr_b16 v[126:127], v9 offset:1024
    s_cmp_eq_u32 s93, 0
    s_cbranch_scc1 k1_kernel_s_6a
    v_mfma_f32_16x16x32_bf16 v[80:83], v[156:159], v[156:159], v[80:83]
    v_mfma_f32_16x16x32_bf16 v[84:87], v[160:163], v[160:163], v[84:87]
    s_branch k1_kernel_s_6b
k1_kernel_s_6a:
    v_mfma_f32_16x16x32_bf16 v[80:83], v[156:159], v[20:23], v[80:83]
    v_mfma_f32_16x16x32_bf16 v[84:87], v[160:163], v[20:23], v[84:87]
k1_kernel_s_6b:
    s_cmp_lg_u32 s95, 1
    s_cbranch_scc1 k1_kernel_s_6c
    v_mfma_f32_16x16x32_bf16 v[88:91], v[20:23], v[128:131], v[88:91]
    v_mfma_f32_16x16x32_bf16 v[92:95], v[20:23], v[132:135], v[92:95]
    v_mfma_f32_16x16x32_bf16 v[96:99], v[20:23], v[136:139], v[96:99]
    v_mfma_f32_16x16x32_bf16 v[100:103], v[20:23], v[140:143], v[100:103]
    v_mfma_f32_16x16x32_bf16 v[104:107], v[20:23], v[144:147], v[104:107]
k1_kernel_s_6c:
    s_waitcnt lgkmcnt(0)
    v_mfma_f32_16x16x32_bf16 v[40:43], v[148:151], v[108:111], v[40:43]
    ds_read_b128 v[156:159], v16 offset:0
    ds_read_b128 v[160:163], v16 offset:2048
    v_mfma_f32_16x16x32_bf16 v[44:47], v[152:155], v[108:111], v[44:47]
    ds_read_b64_tr_b16 v[128:129], v5 offset:16384
    ds_read_b64_tr_b16 v[130:131], v5 offset:17408
    v_mfma_f32_16x16x32_bf16 v[48:51], v[148:151], v[112:115], v[48:51]
    ds_read_b64_tr_b16 v[132:133], v6 offset:16384
    v_mfma_f32_16x16x32_bf16 v[52:55], v[152:155], v[112:115], v[52:55]
    ds_read_b64_tr_b16 v[134:135], v6 offset:17408
    v_mfma_f32_16x16x32_bf16 v[56:59], v[148:151], v[116:119], v[56:59]
    ds_read_b64_tr_b16 v[136:137], v7 offset:16384
    v_mfma_f32_16x16x32_bf16 v[60:63], v[152:155], v[116:119], v[60:63]
    ds_read_b64_tr_b16 v[138:139], v7 offset:17408
    v_mfma_f32_16x16x32_bf16 v[64:67], v[148:151], v[120:123], v[64:67]
    ds_read_b64_tr_b16 v[140:141], v8 offset:16384
    v_mfma_f32_16x16x32_bf16 v[68:71], v[152:155], v[120:123], v[68:71]
    ds_read_b64_tr_b16 v[142:143], v8 offset:17408
    v_mfma_f32_16x16x32_bf16 v[72:75], v[148:151], v[124:127], v[72:75]
    ds_read_b64_tr_b16 v[144:145], v9 offset:16384
    v_mfma_f32_16x16x32_bf16 v[76:79], v[152:155], v[124:127], v[76:79]
    ds_read_b64_tr_b16 v[146:147], v9 offset:17408
    s_cmp_eq_u32 s93, 0
    s_cbranch_scc1 k1_kernel_s_7a
    v_mfma_f32_16x16x32_bf16 v[80:83], v[148:151], v[148:151], v[80:83]
    v_mfma_f32_16x16x32_bf16 v[84:87], v[152:155], v[152:155], v[84:87]
    s_branch k1_kernel_s_7b
k1_kernel_s_7a:
    v_mfma_f32_16x16x32_bf16 v[80:83], v[148:151], v[20:23], v[80:83]
    v_mfma_f32_16x16x32_bf16 v[84:87], v[152:155], v[20:23], v[84:87]
k1_kernel_s_7b:
    s_cmp_lg_u32 s95, 2
    s_cbranch_scc1 k1_kernel_s_7c
    v_mfma_f32_16x16x32_bf16 v[88:91], v[20:23], v[108:111], v[88:91]
    v_mfma_f32_16x16x32_bf16 v[92:95], v[20:23], v[112:115], v[92:95]
    v_mfma_f32_16x16x32_bf16 v[96:99], v[20:23], v[116:119], v[96:99]
    v_mfma_f32_16x16x32_bf16 v[100:103], v[20:23], v[120:123], v[100:103]
    v_mfma_f32_16x16x32_bf16 v[104:107], v[20:23], v[124:127], v[104:107]
k1_kernel_s_7c:
    s_waitcnt lgkmcnt(0)
    s_barrier
    v_mfma_f32_16x16x32_bf16 v[40:43], v[156:159], v[128:131], v[40:43]
    ds_read_b128 v[148:151], v15 offset:16384
    ds_read_b128 v[152:155], v15 offset:18432
    v_mfma_f32_16x16x32_bf16 v[44:47], v[160:163], v[128:131], v[44:47]
    ds_read_b64_tr_b16 v[108:109], v5 offset:32768
    ds_read_b64_tr_b16 v[110:111], v5 offset:33792
    v_mfma_f32_16x16x32_bf16 v[48:51], v[156:159], v[132:135], v[48:51]
    ds_read_b64_tr_b16 v[112:113], v6 offset:32768
    v_mfma_f32_16x16x32_bf16 v[52:55], v[160:163], v[132:135], v[52:55]
    ds_read_b64_tr_b16 v[114:115], v6 offset:33792
    v_mfma_f32_16x16x32_bf16 v[56:59], v[156:159], v[136:139], v[56:59]
    ds_read_b64_tr_b16 v[116:117], v7 offset:32768
    v_mfma_f32_16x16x32_bf16 v[60:63], v[160:163], v[136:139], v[60:63]
    ds_read_b64_tr_b16 v[118:119], v7 offset:33792
    v_mfma_f32_16x16x32_bf16 v[64:67], v[156:159], v[140:143], v[64:67]
    ds_read_b64_tr_b16 v[120:121], v8 offset:32768
    v_mfma_f32_16x16x32_bf16 v[68:71], v[160:163], v[140:143], v[68:71]
    ds_read_b64_tr_b16 v[122:123], v8 offset:33792
    v_mfma_f32_16x16x32_bf16 v[72:75], v[156:159], v[144:147], v[72:75]
    ds_read_b64_tr_b16 v[124:125], v9 offset:32768
    v_mfma_f32_16x16x32_bf16 v[76:79], v[160:163], v[144:147], v[76:79]
    ds_read_b64_tr_b16 v[126:127], v9 offset:33792
    s_cmp_eq_u32 s93, 0
    s_cbranch_scc1 k1_kernel_s_8a
    v_mfma_f32_16x16x32_bf16 v[80:83], v[156:159], v[156:159], v[80:83]
    v_mfma_f32_16x16x32_bf16 v[84:87], v[160:163], v[160:163], v[84:87]
    s_branch k1_kernel_s_8b
k1_kernel_s_8a:
    v_mfma_f32_16x16x32_bf16 v[80:83], v[156:159], v[20:23], v[80:83]
    v_mfma_f32_16x16x32_bf16 v[84:87], v[160:163], v[20:23], v[84:87]
k1_kernel_s_8b:
    s_cmp_lg_u32 s95, 3
    s_cbranch_scc1 k1_kernel_s_8c
    v_mfma_f32_16x16x32_bf16 v[88:91], v[20:23], v[128:131], v[88:91]
    v_mfma_f32_16x16x32_bf16 v[92:95], v[20:23], v[132:135], v[92:95]
    v_mfma_f32_16x16x32_bf16 v[96:99], v[20:23], v[136:139], v[96:99]
    v_mfma_f32_16x16x32_bf16 v[100:103], v[20:23], v[140:143], v[100:103]
    v_mfma_f32_16x16x32_bf16 v[104:107], v[20:23], v[144:147], v[104:107]
k1_kernel_s_8c:
    s_waitcnt lgkmcnt(0)
    v_mfma_f32_16x16x32_bf16 v[40:43], v[148:151], v[108:111], v[40:43]
    ds_read_b128 v[156:159], v16 offset:16384
    ds_read_b128 v[160:163], v16 offset:18432
    v_mfma_f32_16x16x32_bf16 v[44:47], v[152:155], v[108:111], v[44:47]
    ds_read_b64_tr_b16 v[128:129], v10 offset:0
    ds_read_b64_tr_b16 v[130:131], v10 offset:1024
    v_mfma_f32_16x16x32_bf16 v[48:51], v[148:151], v[112:115], v[48:51]
    ds_read_b64_tr_b16 v[132:133], v11 offset:0
    v_mfma_f32_16x16x32_bf16 v[52:55], v[152:155], v[112:115], v[52:55]
    ds_read_b64_tr_b16 v[134:135], v11 offset:1024
    v_mfma_f32_16x16x32_bf16 v[56:59], v[148:151], v[116:119], v[56:59]
    ds_read_b64_tr_b16 v[136:137], v12 offset:0
    v_mfma_f32_16x16x32_bf16 v[60:63], v[152:155], v[116:119], v[60:63]
    ds_read_b64_tr_b16 v[138:139], v12 offset:1024
    v_mfma_f32_16x16x32_bf16 v[64:67], v[148:151], v[120:123], v[64:67]
    ds_read_b64_tr_b16 v[140:141], v13 offset:0
    v_mfma_f32_16x16x32_bf16 v[68:71], v[152:155], v[120:123], v[68:71]
    ds_read_b64_tr_b16 v[142:143], v13 offset:1024
    v_mfma_f32_16x16x32_bf16 v[72:75], v[148:151], v[124:127], v[72:75]
    ds_read_b64_tr_b16 v[144:145], v14 offset:0
    v_mfma_f32_16x16x32_bf16 v[76:79], v[152:155], v[124:127], v[76:79]
    ds_read_b64_tr_b16 v[146:147], v14 offset:1024
    s_cmp_eq_u32 s93, 0
    s_cbranch_scc1 k1_kernel_s_9a
    v_mfma_f32_16x16x32_bf16 v[80:83], v[148:151], v[148:151], v[80:83]
    v_mfma_f32_16x16x32_bf16 v[84:87], v[152:155], v[152:155], v[84:87]
    s_branch k1_kernel_s_9b
k1_kernel_s_9a:
    v_mfma_f32_16x16x32_bf16 v[80:83], v[148:151], v[20:23], v[80:83]
    v_mfma_f32_16x16x32_bf16 v[84:87], v[152:155], v[20:23], v[84:87]
k1_kernel_s_9b:
    s_cmp_lg_u32 s95, 0
    s_cbranch_scc1 k1_kernel_s_9c
    v_mfma_f32_16x16x32_bf16 v[88:91], v[20:23], v[108:111], v[88:91]
    v_mfma_f32_16x16x32_bf16 v[92:95], v[20:23], v[112:115], v[92:95]
    v_mfma_f32_16x16x32_bf16 v[96:99], v[20:23], v[116:119], v[96:99]
    v_mfma_f32_16x16x32_bf16 v[100:103], v[20:23], v[120:123], v[100:103]
    v_mfma_f32_16x16x32_bf16 v[104:107], v[20:23], v[124:127], v[104:107]
k1_kernel_s_9c:
    s_waitcnt lgkmcnt(0)
    s_barrier
    v_mfma_f32_16x16x32_bf16 v[40:43], v[156:159], v[128:131], v[40:43]
    ds_read_b128 v[148:151], v15 offset:32768
    ds_read_b128 v[152:155], v15 offset:34816
    v_mfma_f32_16x16x32_bf16 v[44:47], v[160:163], v[128:131], v[44:47]
    ds_read_b64_tr_b16 v[108:109], v10 offset:16384
    ds_read_b64_tr_b16 v[110:111], v10 offset:17408
    v_mfma_f32_16x16x32_bf16 v[48:51], v[156:159], v[132:135], v[48:51]
    ds_read_b64_tr_b16 v[112:113], v11 offset:16384
    v_mfma_f32_16x16x32_bf16 v[52:55], v[160:163], v[132:135], v[52:55]
    ds_read_b64_tr_b16 v[114:115], v11 offset:17408
    v_mfma_f32_16x16x32_bf16 v[56:59], v[156:159], v[136:139], v[56:59]
    ds_read_b64_tr_b16 v[116:117], v12 offset:16384
    v_mfma_f32_16x16x32_bf16 v[60:63], v[160:163], v[136:139], v[60:63]
    ds_read_b64_tr_b16 v[118:119], v12 offset:17408
    v_mfma_f32_16x16x32_bf16 v[64:67], v[156:159], v[140:143], v[64:67]
    ds_read_b64_tr_b16 v[120:121], v13 offset:16384
    v_mfma_f32_16x16x32_bf16 v[68:71], v[160:163], v[140:143], v[68:71]
    ds_read_b64_tr_b16 v[122:123], v13 offset:17408
    v_mfma_f32_16x16x32_bf16 v[72:75], v[156:159], v[144:147], v[72:75]
    ds_read_b64_tr_b16 v[124:125], v14 offset:16384
    v_mfma_f32_16x16x32_bf16 v[76:79], v[160:163], v[144:147], v[76:79]
    ds_read_b64_tr_b16 v[126:127], v14 offset:17408
    s_cmp_eq_u32 s93, 0
    s_cbranch_scc1 k1_kernel_s_10a
    v_mfma_f32_16x16x32_bf16 v[80:83], v[156:159], v[156:159], v[80:83]
    v_mfma_f32_16x16x32_bf16 v[84:87], v[160:163], v[160:163], v[84:87]
    s_branch k1_kernel_s_10b
k1_kernel_s_10a:
    v_mfma_f32_16x16x32_bf16 v[80:83], v[156:159], v[20:23], v[80:83]
    v_mfma_f32_16x16x32_bf16 v[84:87], v[160:163], v[20:23], v[84:87]
k1_kernel_s_10b:
    s_cmp_lg_u32 s95, 1
    s_cbranch_scc1 k1_kernel_s_10c
    v_mfma_f32_16x16x32_bf16 v[88:91], v[20:23], v[128:131], v[88:91]
    v_mfma_f32_16x16x32_bf16 v[92:95], v[20:23], v[132:135], v[92:95]
    v_mfma_f32_16x16x32_bf16 v[96:99], v[20:23], v[136:139], v[96:99]
    v_mfma_f32_16x16x32_bf16 v[100:103], v[20:23], v[140:143], v[100:103]
    v_mfma_f32_16x16x32_bf16 v[104:107], v[20:23], v[144:147], v[104:107]
k1_kernel_s_10c:
    s_waitcnt lgkmcnt(0)
    v_mfma_f32_16x16x32_bf16 v[40:43], v[148:151], v[108:111], v[40:43]
    ds_read_b128 v[156:159], v16 offset:32768
    ds_read_b128 v[160:163], v16 offset:34816
    v_mfma_f32_16x16x32_bf16 v[44:47], v[152:155], v[108:111], v[44:47]
    ds_read_b64_tr_b16 v[128:129], v10 offset:32768
    ds_read_b64_tr_b16 v[130:131], v10 offset:33792
    v_mfma_f32_16x16x32_bf16 v[48:51], v[148:151], v[112:115], v[48:51]
    ds_read_b64_tr_b16 v[132:133], v11 offset:32768
    v_mfma_f32_16x16x32_bf16 v[52:55], v[152:155], v[112:115], v[52:55]
    ds_read_b64_tr_b16 v[134:135], v11 offset:33792
    v_mfma_f32_16x16x32_bf16 v[56:59], v[148:151], v[116:119], v[56:59]
    ds_read_b64_tr_b16 v[136:137], v12 offset:32768
    v_mfma_f32_16x16x32_bf16 v[60:63], v[152:155], v[116:119], v[60:63]
    ds_read_b64_tr_b16 v[138:139], v12 offset:33792
    v_mfma_f32_16x16x32_bf16 v[64:67], v[148:151], v[120:123], v[64:67]
    ds_read_b64_tr_b16 v[140:141], v13 offset:32768
    v_mfma_f32_16x16x32_bf16 v[68:71], v[152:155], v[120:123], v[68:71]
    ds_read_b64_tr_b16 v[142:143], v13 offset:33792
    v_mfma_f32_16x16x32_bf16 v[72:75], v[148:151], v[124:127], v[72:75]
    ds_read_b64_tr_b16 v[144:145], v14 offset:32768
    v_mfma_f32_16x16x32_bf16 v[76:79], v[152:155], v[124:127], v[76:79]
    ds_read_b64_tr_b16 v[146:147], v14 offset:33792
    s_cmp_eq_u32 s93, 0
    s_cbranch_scc1 k1_kernel_s_11a
    v_mfma_f32_16x16x32_bf16 v[80:83], v[148:151], v[148:151], v[80:83]
    v_mfma_f32_16x16x32_bf16 v[84:87], v[152:155], v[152:155], v[84:87]
    s_branch k1_kernel_s_11b
k1_kernel_s_11a:
    v_mfma_f32_16x16x32_bf16 v[80:83], v[148:151], v[20:23], v[80:83]
    v_mfma_f32_16x16x32_bf16 v[84:87], v[152:155], v[20:23], v[84:87]
k1_kernel_s_11b:
    s_cmp_lg_u32 s95, 2
    s_cbranch_scc1 k1_kernel_s_11c
    v_mfma_f32_16x16x32_bf16 v[88:91], v[20:23], v[108:111], v[88:91]
    v_mfma_f32_16x16x32_bf16 v[92:95], v[20:23], v[112:115], v[92:95]
    v_mfma_f32_16x16x32_bf16 v[96:99], v[20:23], v[116:119], v[96:99]
    v_mfma_f32_16x16x32_bf16 v[100:103], v[20:23], v[120:123], v[100:103]
    v_mfma_f32_16x16x32_bf16 v[104:107], v[20:23], v[124:127], v[104:107]
k1_kernel_s_11c:
    s_waitcnt lgkmcnt(0)
    s_barrier
    v_mfma_f32_16x16x32_bf16 v[40:43], v[156:159], v[128:131], v[40:43]
    ds_read_b128 v[148:151], v15 offset:0
    ds_read_b128 v[152:155], v15 offset:2048
    v_mfma_f32_16x16x32_bf16 v[44:47], v[160:163], v[128:131], v[44:47]
    ds_read_b64_tr_b16 v[108:109], v5 offset:0
    ds_read_b64_tr_b16 v[110:111], v5 offset:1024
    v_mfma_f32_16x16x32_bf16 v[48:51], v[156:159], v[132:135], v[48:51]
    ds_read_b64_tr_b16 v[112:113], v6 offset:0
    v_mfma_f32_16x16x32_bf16 v[52:55], v[160:163], v[132:135], v[52:55]
    ds_read_b64_tr_b16 v[114:115], v6 offset:1024
    v_mfma_f32_16x16x32_bf16 v[56:59], v[156:159], v[136:139], v[56:59]
    ds_read_b64_tr_b16 v[116:117], v7 offset:0
    v_mfma_f32_16x16x32_bf16 v[60:63], v[160:163], v[136:139], v[60:63]
    ds_read_b64_tr_b16 v[118:119], v7 offset:1024
    v_mfma_f32_16x16x32_bf16 v[64:67], v[156:159], v[140:143], v[64:67]
    ds_read_b64_tr_b16 v[120:121], v8 offset:0
    v_mfma_f32_16x16x32_bf16 v[68:71], v[160:163], v[140:143], v[68:71]
    ds_read_b64_tr_b16 v[122:123], v8 offset:1024
    v_mfma_f32_16x16x32_bf16 v[72:75], v[156:159], v[144:147], v[72:75]
    ds_read_b64_tr_b16 v[124:125], v9 offset:0
    v_mfma_f32_16x16x32_bf16 v[76:79], v[160:163], v[144:147], v[76:79]
    ds_read_b64_tr_b16 v[126:127], v9 offset:1024
    s_cmp_eq_u32 s93, 0
    s_cbranch_scc1 k1_kernel_s_12a
    v_mfma_f32_16x16x32_bf16 v[80:83], v[156:159], v[156:159], v[80:83]
    v_mfma_f32_16x16x32_bf16 v[84:87], v[160:163], v[160:163], v[84:87]
    s_branch k1_kernel_s_12b
k1_kernel_s_12a:
    v_mfma_f32_16x16x32_bf16 v[80:83], v[156:159], v[20:23], v[80:83]
    v_mfma_f32_16x16x32_bf16 v[84:87], v[160:163], v[20:23], v[84:87]
k1_kernel_s_12b:
    s_cmp_lg_u32 s95, 3
    s_cbranch_scc1 k1_kernel_s_12c
    v_mfma_f32_16x16x32_bf16 v[88:91], v[20:23], v[128:131], v[88:91]
    v_mfma_f32_16x16x32_bf16 v[92:95], v[20:23], v[132:135], v[92:95]
    v_mfma_f32_16x16x32_bf16 v[96:99], v[20:23], v[136:139], v[96:99]
    v_mfma_f32_16x16x32_bf16 v[100:103], v[20:23], v[140:143], v[100:103]
    v_mfma_f32_16x16x32_bf16 v[104:107], v[20:23], v[144:147], v[104:107]
k1_kernel_s_12c:
    s_waitcnt lgkmcnt(0)
    v_mfma_f32_16x16x32_bf16 v[40:43], v[148:151], v[108:111], v[40:43]
    ds_read_b128 v[156:159], v16 offset:0
    ds_read_b128 v[160:163], v16 offset:2048
    v_mfma_f32_16x16x32_bf16 v[44:47], v[152:155], v[108:111], v[44:47]
    ds_read_b64_tr_b16 v[128:129], v5 offset:16384
    ds_read_b64_tr_b16 v[130:131], v5 offset:17408
    v_mfma_f32_16x16x32_bf16 v[48:51], v[148:151], v[112:115], v[48:51]
    ds_read_b64_tr_b16 v[132:133], v6 offset:16384
    v_mfma_f32_16x16x32_bf16 v[52:55], v[152:155], v[112:115], v[52:55]
    ds_read_b64_tr_b16 v[134:135], v6 offset:17408
    v_mfma_f32_16x16x32_bf16 v[56:59], v[148:151], v[116:119], v[56:59]
    ds_read_b64_tr_b16 v[136:137], v7 offset:16384
    v_mfma_f32_16x16x32_bf16 v[60:63], v[152:155], v[116:119], v[60:63]
    ds_read_b64_tr_b16 v[138:139], v7 offset:17408
    v_mfma_f32_16x16x32_bf16 v[64:67], v[148:151], v[120:123], v[64:67]
    ds_read_b64_tr_b16 v[140:141], v8 offset:16384
    v_mfma_f32_16x16x32_bf16 v[68:71], v[152:155], v[120:123], v[68:71]
    ds_read_b64_tr_b16 v[142:143], v8 offset:17408
    v_mfma_f32_16x16x32_bf16 v[72:75], v[148:151], v[124:127], v[72:75]
    ds_read_b64_tr_b16 v[144:145], v9 offset:16384
    v_mfma_f32_16x16x32_bf16 v[76:79], v[152:155], v[124:127], v[76:79]
    ds_read_b64_tr_b16 v[146:147], v9 offset:17408
    s_cmp_eq_u32 s93, 0
    s_cbranch_scc1 k1_kernel_s_13a
    v_mfma_f32_16x16x32_bf16 v[80:83], v[148:151], v[148:151], v[80:83]
    v_mfma_f32_16x16x32_bf16 v[84:87], v[152:155], v[152:155], v[84:87]
    s_branch k1_kernel_s_13b
k1_kernel_s_13a:
    v_mfma_f32_16x16x32_bf16 v[80:83], v[148:151], v[20:23], v[80:83]
    v_mfma_f32_16x16x32_bf16 v[84:87], v[152:155], v[20:23], v[84:87]
k1_kernel_s_13b:
    s_cmp_lg_u32 s95, 0
    s_cbranch_scc1 k1_kernel_s_13c
    v_mfma_f32_16x16x32_bf16 v[88:91], v[20:23], v[108:111], v[88:91]
    v_mfma_f32_16x16x32_bf16 v[92:95], v[20:23], v[112:115], v[92:95]
    v_mfma_f32_16x16x32_bf16 v[96:99], v[20:23], v[116:119], v[96:99]
    v_mfma_f32_16x16x32_bf16 v[100:103], v[20:23], v[120:123], v[100:103]
    v_mfma_f32_16x16x32_bf16 v[104:107], v[20:23], v[124:127], v[104:107]
k1_kernel_s_13c:
    s_waitcnt lgkmcnt(0)
    s_barrier
    v_mfma_f32_16x16x32_bf16 v[40:43], v[156:159], v[128:131], v[40:43]
    ds_read_b128 v[148:151], v15 offset:16384
    ds_read_b128 v[152:155], v15 offset:18432
    v_mfma_f32_16x16x32_bf16 v[44:47], v[160:163], v[128:131], v[44:47]
    ds_read_b64_tr_b16 v[108:109], v5 offset:32768
    ds_read_b64_tr_b16 v[110:111], v5 offset:33792
    v_mfma_f32_16x16x32_bf16 v[48:51], v[156:159], v[132:135], v[48:51]
    ds_read_b64_tr_b16 v[112:113], v6 offset:32768
    v_mfma_f32_16x16x32_bf16 v[52:55], v[160:163], v[132:135], v[52:55]
    ds_read_b64_tr_b16 v[114:115], v6 offset:33792
    v_mfma_f32_16x16x32_bf16 v[56:59], v[156:159], v[136:139], v[56:59]
    ds_read_b64_tr_b16 v[116:117], v7 offset:32768
    v_mfma_f32_16x16x32_bf16 v[60:63], v[160:163], v[136:139], v[60:63]
    ds_read_b64_tr_b16 v[118:119], v7 offset:33792
    v_mfma_f32_16x16x32_bf16 v[64:67], v[156:159], v[140:143], v[64:67]
    ds_read_b64_tr_b16 v[120:121], v8 offset:32768
    v_mfma_f32_16x16x32_bf16 v[68:71], v[160:163], v[140:143], v[68:71]
    ds_read_b64_tr_b16 v[122:123], v8 offset:33792
    v_mfma_f32_16x16x32_bf16 v[72:75], v[156:159], v[144:147], v[72:75]
    ds_read_b64_tr_b16 v[124:125], v9 offset:32768
    v_mfma_f32_16x16x32_bf16 v[76:79], v[160:163], v[144:147], v[76:79]
    ds_read_b64_tr_b16 v[126:127], v9 offset:33792
    s_cmp_eq_u32 s93, 0
    s_cbranch_scc1 k1_kernel_s_14a
    v_mfma_f32_16x16x32_bf16 v[80:83], v[156:159], v[156:159], v[80:83]
    v_mfma_f32_16x16x32_bf16 v[84:87], v[160:163], v[160:163], v[84:87]
    s_branch k1_kernel_s_14b
k1_kernel_s_14a:
    v_mfma_f32_16x16x32_bf16 v[80:83], v[156:159], v[20:23], v[80:83]
    v_mfma_f32_16x16x32_bf16 v[84:87], v[160:163], v[20:23], v[84:87]
k1_kernel_s_14b:
    s_cmp_lg_u32 s95, 1
    s_cbranch_scc1 k1_kernel_s_14c
    v_mfma_f32_16x16x32_bf16 v[88:91], v[20:23], v[128:131], v[88:91]
    v_mfma_f32_16x16x32_bf16 v[92:95], v[20:23], v[132:135], v[92:95]
    v_mfma_f32_16x16x32_bf16 v[96:99], v[20:23], v[136:139], v[96:99]
    v_mfma_f32_16x16x32_bf16 v[100:103], v[20:23], v[140:143], v[100:103]
    v_mfma_f32_16x16x32_bf16 v[104:107], v[20:23], v[144:147], v[104:107]
k1_kernel_s_14c:
    s_waitcnt lgkmcnt(0)
    v_mfma_f32_16x16x32_bf16 v[40:43], v[148:151], v[108:111], v[40:43]
    ds_read_b128 v[156:159], v16 offset:16384
    ds_read_b128 v[160:163], v16 offset:18432
    v_mfma_f32_16x16x32_bf16 v[44:47], v[152:155], v[108:111], v[44:47]
    ds_read_b64_tr_b16 v[128:129], v10 offset:0
    ds_read_b64_tr_b16 v[130:131], v10 offset:1024
    v_mfma_f32_16x16x32_bf16 v[48:51], v[148:151], v[112:115], v[48:51]
    ds_read_b64_tr_b16 v[132:133], v11 offset:0
    v_mfma_f32_16x16x32_bf16 v[52:55], v[152:155], v[112:115], v[52:55]
    ds_read_b64_tr_b16 v[134:135], v11 offset:1024
    v_mfma_f32_16x16x32_bf16 v[56:59], v[148:151], v[116:119], v[56:59]
    ds_read_b64_tr_b16 v[136:137], v12 offset:0
    v_mfma_f32_16x16x32_bf16 v[60:63], v[152:155], v[116:119], v[60:63]
    ds_read_b64_tr_b16 v[138:139], v12 offset:1024
    v_mfma_f32_16x16x32_bf16 v[64:67], v[148:151], v[120:123], v[64:67]
    ds_read_b64_tr_b16 v[140:141], v13 offset:0
    v_mfma_f32_16x16x32_bf16 v[68:71], v[152:155], v[120:123], v[68:71]
    ds_read_b64_tr_b16 v[142:143], v13 offset:1024
    v_mfma_f32_16x16x32_bf16 v[72:75], v[148:151], v[124:127], v[72:75]
    ds_read_b64_tr_b16 v[144:145], v14 offset:0
    v_mfma_f32_16x16x32_bf16 v[76:79], v[152:155], v[124:127], v[76:79]
    ds_read_b64_tr_b16 v[146:147], v14 offset:1024
    s_cmp_eq_u32 s93, 0
    s_cbranch_scc1 k1_kernel_s_15a
    v_mfma_f32_16x16x32_bf16 v[80:83], v[148:151], v[148:151], v[80:83]
    v_mfma_f32_16x16x32_bf16 v[84:87], v[152:155], v[152:155], v[84:87]
    s_branch k1_kernel_s_15b
k1_kernel_s_15a:
    v_mfma_f32_16x16x32_bf16 v[80:83], v[148:151], v[20:23], v[80:83]
    v_mfma_f32_16x16x32_bf16 v[84:87], v[152:155], v[20:23], v[84:87]
k1_kernel_s_15b:
    s_cmp_lg_u32 s95, 2
    s_cbranch_scc1 k1_kernel_s_15c
    v_mfma_f32_16x16x32_bf16 v[88:91], v[20:23], v[108:111], v[88:91]
    v_mfma_f32_16x16x32_bf16 v[92:95], v[20:23], v[112:115], v[92:95]
    v_mfma_f32_16x16x32_bf16 v[96:99], v[20:23], v[116:119], v[96:99]
    v_mfma_f32_16x16x32_bf16 v[100:103], v[20:23], v[120:123], v[100:103]
    v_mfma_f32_16x16x32_bf16 v[104:107], v[20:23], v[124:127], v[104:107]
k1_kernel_s_15c:
    s_waitcnt lgkmcnt(0)
    s_barrier
    v_mfma_f32_16x16x32_bf16 v[40:43], v[156:159], v[128:131], v[40:43]
    ds_read_b128 v[148:151], v15 offset:32768
    ds_read_b128 v[152:155], v15 offset:34816
    v_mfma_f32_16x16x32_bf16 v[44:47], v[160:163], v[128:131], v[44:47]
    ds_read_b64_tr_b16 v[108:109], v10 offset:16384
    ds_read_b64_tr_b16 v[110:111], v10 offset:17408
    v_mfma_f32_16x16x32_bf16 v[48:51], v[156:159], v[132:135], v[48:51]
    ds_read_b64_tr_b16 v[112:113], v11 offset:16384
    v_mfma_f32_16x16x32_bf16 v[52:55], v[160:163], v[132:135], v[52:55]
    ds_read_b64_tr_b16 v[114:115], v11 offset:17408
    v_mfma_f32_16x16x32_bf16 v[56:59], v[156:159], v[136:139], v[56:59]
    ds_read_b64_tr_b16 v[116:117], v12 offset:16384
    v_mfma_f32_16x16x32_bf16 v[60:63], v[160:163], v[136:139], v[60:63]
    ds_read_b64_tr_b16 v[118:119], v12 offset:17408
    v_mfma_f32_16x16x32_bf16 v[64:67], v[156:159], v[140:143], v[64:67]
    ds_read_b64_tr_b16 v[120:121], v13 offset:16384
    v_mfma_f32_16x16x32_bf16 v[68:71], v[160:163], v[140:143], v[68:71]
    ds_read_b64_tr_b16 v[122:123], v13 offset:17408
    v_mfma_f32_16x16x32_bf16 v[72:75], v[156:159], v[144:147], v[72:75]
    ds_read_b64_tr_b16 v[124:125], v14 offset:16384
    v_mfma_f32_16x16x32_bf16 v[76:79], v[160:163], v[144:147], v[76:79]
    ds_read_b64_tr_b16 v[126:127], v14 offset:17408
    s_cmp_eq_u32 s93, 0
    s_cbranch_scc1 k1_kernel_s_16a
    v_mfma_f32_16x16x32_bf16 v[80:83], v[156:159], v[156:159], v[80:83]
    v_mfma_f32_16x16x32_bf16 v[84:87], v[160:163], v[160:163], v[84:87]
    s_branch k1_kernel_s_16b
k1_kernel_s_16a:
    v_mfma_f32_16x16x32_bf16 v[80:83], v[156:159], v[20:23], v[80:83]
    v_mfma_f32_16x16x32_bf16 v[84:87], v[160:163], v[20:23], v[84:87]
k1_kernel_s_16b:
    s_cmp_lg_u32 s95, 3
    s_cbranch_scc1 k1_kernel_s_16c
    v_mfma_f32_16x16x32_bf16 v[88:91], v[20:23], v[128:131], v[88:91]
    v_mfma_f32_16x16x32_bf16 v[92:95], v[20:23], v[132:135], v[92:95]
    v_mfma_f32_16x16x32_bf16 v[96:99], v[20:23], v[136:139], v[96:99]
    v_mfma_f32_16x16x32_bf16 v[100:103], v[20:23], v[140:143], v[100:103]
    v_mfma_f32_16x16x32_bf16 v[104:107], v[20:23], v[144:147], v[104:107]
k1_kernel_s_16c:
    s_waitcnt lgkmcnt(0)
    v_mfma_f32_16x16x32_bf16 v[40:43], v[148:151], v[108:111], v[40:43]
    ds_read_b128 v[156:159], v16 offset:32768
    ds_read_b128 v[160:163], v16 offset:34816
    v_mfma_f32_16x16x32_bf16 v[44:47], v[152:155], v[108:111], v[44:47]
    ds_read_b64_tr_b16 v[128:129], v10 offset:32768
    ds_read_b64_tr_b16 v[130:131], v10 offset:33792
    v_mfma_f32_16x16x32_bf16 v[48:51], v[148:151], v[112:115], v[48:51]
    ds_read_b64_tr_b16 v[132:133], v11 offset:32768
    v_mfma_f32_16x16x32_bf16 v[52:55], v[152:155], v[112:115], v[52:55]
    ds_read_b64_tr_b16 v[134:135], v11 offset:33792
    v_mfma_f32_16x16x32_bf16 v[56:59], v[148:151], v[116:119], v[56:59]
    ds_read_b64_tr_b16 v[136:137], v12 offset:32768
    v_mfma_f32_16x16x32_bf16 v[60:63], v[152:155], v[116:119], v[60:63]
    ds_read_b64_tr_b16 v[138:139], v12 offset:33792
    v_mfma_f32_16x16x32_bf16 v[64:67], v[148:151], v[120:123], v[64:67]
    ds_read_b64_tr_b16 v[140:141], v13 offset:32768
    v_mfma_f32_16x16x32_bf16 v[68:71], v[152:155], v[120:123], v[68:71]
    ds_read_b64_tr_b16 v[142:143], v13 offset:33792
    v_mfma_f32_16x16x32_bf16 v[72:75], v[148:151], v[124:127], v[72:75]
    ds_read_b64_tr_b16 v[144:145], v14 offset:32768
    v_mfma_f32_16x16x32_bf16 v[76:79], v[152:155], v[124:127], v[76:79]
    ds_read_b64_tr_b16 v[146:147], v14 offset:33792
    s_cmp_eq_u32 s93, 0
    s_cbranch_scc1 k1_kernel_s_17a
    v_mfma_f32_16x16x32_bf16 v[80:83], v[148:151], v[148:151], v[80:83]
    v_mfma_f32_16x16x32_bf16 v[84:87], v[152:155], v[152:155], v[84:87]
    s_branch k1_kernel_s_17b
k1_kernel_s_17a:
    v_mfma_f32_16x16x32_bf16 v[80:83], v[148:151], v[20:23], v[80:83]
    v_mfma_f32_16x16x32_bf16 v[84:87], v[152:155], v[20:23], v[84:87]
k1_kernel_s_17b:
    s_cmp_lg_u32 s95, 0
    s_cbranch_scc1 k1_kernel_s_17c
    v_mfma_f32_16x16x32_bf16 v[88:91], v[20:23], v[108:111], v[88:91]
    v_mfma_f32_16x16x32_bf16 v[92:95], v[20:23], v[112:115], v[92:95]
    v_mfma_f32_16x16x32_bf16 v[96:99], v[20:23], v[116:119], v[96:99]
    v_mfma_f32_16x16x32_bf16 v[100:103], v[20:23], v[120:123], v[100:103]
    v_mfma_f32_16x16x32_bf16 v[104:107], v[20:23], v[124:127], v[104:107]
k1_kernel_s_17c:
    s_waitcnt lgkmcnt(0)
    v_mfma_f32_16x16x32_bf16 v[40:43], v[156:159], v[128:131], v[40:43]
    v_mfma_f32_16x16x32_bf16 v[44:47], v[160:163], v[128:131], v[44:47]
    v_mfma_f32_16x16x32_bf16 v[48:51], v[156:159], v[132:135], v[48:51]
    v_mfma_f32_16x16x32_bf16 v[52:55], v[160:163], v[132:135], v[52:55]
    v_mfma_f32_16x16x32_bf16 v[56:59], v[156:159], v[136:139], v[56:59]
    v_mfma_f32_16x16x32_bf16 v[60:63], v[160:163], v[136:139], v[60:63]
    v_mfma_f32_16x16x32_bf16 v[64:67], v[156:159], v[140:143], v[64:67]
    v_mfma_f32_16x16x32_bf16 v[68:71], v[160:163], v[140:143], v[68:71]
    v_mfma_f32_16x16x32_bf16 v[72:75], v[156:159], v[144:147], v[72:75]
    v_mfma_f32_16x16x32_bf16 v[76:79], v[160:163], v[144:147], v[76:79]
    s_cmp_eq_u32 s93, 0
    s_cbranch_scc1 k1_kernel_s_18a
    v_mfma_f32_16x16x32_bf16 v[80:83], v[156:159], v[156:159], v[80:83]
    v_mfma_f32_16x16x32_bf16 v[84:87], v[160:163], v[160:163], v[84:87]
    s_branch k1_kernel_s_18b
k1_kernel_s_18a:
    v_mfma_f32_16x16x32_bf16 v[80:83], v[156:159], v[20:23], v[80:83]
    v_mfma_f32_16x16x32_bf16 v[84:87], v[160:163], v[20:23], v[84:87]
k1_kernel_s_18b:
    s_cmp_lg_u32 s95, 1
    s_cbranch_scc1 k1_kernel_s_18c
    v_mfma_f32_16x16x32_bf16 v[88:91], v[20:23], v[128:131], v[88:91]
    v_mfma_f32_16x16x32_bf16 v[92:95], v[20:23], v[132:135], v[92:95]
    v_mfma_f32_16x16x32_bf16 v[96:99], v[20:23], v[136:139], v[96:99]
    v_mfma_f32_16x16x32_bf16 v[100:103], v[20:23], v[140:143], v[100:103]
    v_mfma_f32_16x16x32_bf16 v[104:107], v[20:23], v[144:147], v[104:107]
k1_kernel_s_18c:
    v_mov_b32 v18, s94
    buffer_load_dword v19, v18, s[16:19], 0 offen sc1
    s_barrier
    v_and_b32 v25, 15, v0
    v_lshrrev_b32 v26, 4, v0
    s_mul_i32 s36, s93, 1280
    s_lshl_b32 s37, s92, 2
    s_add_u32 s37, s37, s36
    v_lshl_add_u32 v24, v25, 4, s37
    v_lshl_add_u32 v27, v25, 4, s36
    v_and_b32 v28, 3, v0
    v_cmp_eq_u32 s[84:85], 1, v28
    v_cmp_eq_u32 s[86:87], 2, v28
    v_cmp_eq_u32 s[88:89], 3, v28
    s_lshl_b32 s36, s92, 7
    s_cmp_eq_u32 s93, 0
    s_cbranch_scc1 k1_kernel_x_19a
    v_bfe_u32 v28, v0, 2, 2
    v_cmp_eq_u32 vcc, v28, v26
    s_add_u32 s37, s36, 4608
    v_lshl_add_u32 v28, v25, 2, s37
    v_mov_b32 v29, 6144
    v_cndmask_b32 v80, v80, v81, s[84:85]
    v_cndmask_b32 v80, v80, v82, s[86:87]
    v_cndmask_b32 v80, v80, v83, s[88:89]
    v_cndmask_b32 v84, v84, v85, s[84:85]
    v_cndmask_b32 v84, v84, v86, s[86:87]
    v_cndmask_b32 v84, v84, v87, s[88:89]
    v_cndmask_b32 v28, v29, v28, vcc
    ds_write_b32 v28, v80 offset:0
    ds_write_b32 v28, v84 offset:64
    s_branch k1_kernel_x_19b
k1_kernel_x_19a:
    s_add_u32 s37, s36, 4096
    v_lshl_add_u32 v28, v26, 4, s37
    ds_write_b128 v28, v[80:83] offset:0
    ds_write_b128 v28, v[84:87] offset:64
k1_kernel_x_19b:
    ds_write_b32 v24, v88 offset:0
    ds_write_b32 v24, v92 offset:256
    ds_write_b32 v24, v96 offset:512
    ds_write_b32 v24, v100 offset:768
    ds_write_b32 v24, v104 offset:1024
    s_waitcnt lgkmcnt(0)
    s_barrier
    ds_read_b128 v[108:111], v27 offset:0
    ds_read_b128 v[112:115], v27 offset:256
    ds_read_b128 v[116:119], v27 offset:512
    ds_read_b128 v[120:123], v27 offset:768
    ds_read_b128 v[124:127], v27 offset:1024
    v_lshl_add_u32 v28, v26, 4, s36
    ds_read_b128 v[148:151], v28 offset:4096
    ds_read_b128 v[156:159], v28 offset:4608
    ds_read_b128 v[152:155], v28 offset:4160
    ds_read_b128 v[160:163], v28 offset:4672
    s_waitcnt lgkmcnt(4)
    v_add_f32 v108, v108, v109
    v_add_f32 v110, v110, v111
    v_add_f32 v112, v112, v113
    v_add_f32 v114, v114, v115
    v_add_f32 v116, v116, v117
    v_add_f32 v118, v118, v119
    v_add_f32 v120, v120, v121
    v_add_f32 v122, v122, v123
    v_add_f32 v124, v124, v125
    v_add_f32 v126, v126, v127
    v_add_f32 v88, v108, v110
    v_add_f32 v89, v112, v114
    v_add_f32 v90, v116, v118
    v_add_f32 v91, v120, v122
    v_add_f32 v92, v124, v126
    s_waitcnt lgkmcnt(0)
    v_mul_f32 v97, v32, v148
    v_mul_f32 v98, v32, v149
    v_mul_f32 v99, v32, v150
    v_mul_f32 v100, v32, v151
    v_mul_f32 v101, v32, v152
    v_mul_f32 v102, v32, v153
    v_mul_f32 v103, v32, v154
    v_mul_f32 v104, v32, v155
    v_fma_f32 v156, v156, v37, v33
    v_fma_f32 v157, v157, v37, v33
    v_fma_f32 v158, v158, v37, v33
    v_fma_f32 v159, v159, v37, v33
    v_fma_f32 v160, v160, v37, v33
    v_fma_f32 v161, v161, v37, v33
    v_fma_f32 v162, v162, v37, v33
    v_fma_f32 v163, v163, v37, v33
    v_fma_f32 v156, -v97, v97, v156
    v_fma_f32 v157, -v98, v98, v157
    v_fma_f32 v158, -v99, v99, v158
    v_fma_f32 v159, -v100, v100, v159
    v_fma_f32 v160, -v101, v101, v160
    v_fma_f32 v161, -v102, v102, v161
    v_fma_f32 v162, -v103, v103, v162
    v_fma_f32 v163, -v104, v104, v163
    v_max_f32 v156, v156, v33
    v_max_f32 v157, v157, v33
    v_max_f32 v158, v158, v33
    v_max_f32 v159, v159, v33
    v_max_f32 v160, v160, v33
    v_max_f32 v161, v161, v33
    v_max_f32 v162, v162, v33
    v_max_f32 v163, v163, v33
    v_rsq_f32 v130, v156
    v_rsq_f32 v131, v157
    v_rsq_f32 v132, v158
    v_rsq_f32 v133, v159
    v_rsq_f32 v134, v160
    v_rsq_f32 v135, v161
    v_rsq_f32 v136, v162
    v_rsq_f32 v137, v163
    s_nop 0
    v_mul_f32 v139, v34, v130
    v_mul_f32 v140, v34, v131
    v_mul_f32 v141, v34, v132
    v_mul_f32 v142, v34, v133
    v_mul_f32 v143, v34, v134
    v_mul_f32 v144, v34, v135
    v_mul_f32 v145, v34, v136
    v_mul_f32 v146, v34, v137
    v_fmac_f32 v40, v88, v97
    v_fmac_f32 v41, v88, v98
    v_fmac_f32 v42, v88, v99
    v_fmac_f32 v43, v88, v100
    v_fmac_f32 v44, v88, v101
    v_fmac_f32 v45, v88, v102
    v_fmac_f32 v46, v88, v103
    v_fmac_f32 v47, v88, v104
    v_fmac_f32 v48, v89, v97
    v_fmac_f32 v49, v89, v98
    v_fmac_f32 v50, v89, v99
    v_fmac_f32 v51, v89, v100
    v_fmac_f32 v52, v89, v101
    v_fmac_f32 v53, v89, v102
    v_fmac_f32 v54, v89, v103
    v_fmac_f32 v55, v89, v104
    v_fmac_f32 v56, v90, v97
    v_fmac_f32 v57, v90, v98
    v_fmac_f32 v58, v90, v99
    v_fmac_f32 v59, v90, v100
    v_fmac_f32 v60, v90, v101
    v_fmac_f32 v61, v90, v102
    v_fmac_f32 v62, v90, v103
    v_fmac_f32 v63, v90, v104
    v_fmac_f32 v64, v91, v97
    v_fmac_f32 v65, v91, v98
    v_fmac_f32 v66, v91, v99
    v_fmac_f32 v67, v91, v100
    v_fmac_f32 v68, v91, v101
    v_fmac_f32 v69, v91, v102
    v_fmac_f32 v70, v91, v103
    v_fmac_f32 v71, v91, v104
    v_fmac_f32 v72, v92, v97
    v_fmac_f32 v73, v92, v98
    v_fmac_f32 v74, v92, v99
    v_fmac_f32 v75, v92, v100
    v_fmac_f32 v76, v92, v101
    v_fmac_f32 v77, v92, v102
    v_fmac_f32 v78, v92, v103
    v_fmac_f32 v79, v92, v104
    s_cmp_eq_u32 s93, 0
    s_cbranch_scc0 k1_kernel_nophi
    v_mul_f32 v24, v40, v139
    v_mul_f32 v25, v41, v140
    v_mul_f32 v26, v42, v141
    v_mul_f32 v27, v43, v142
    v_mul_f32 v28, v44, v143
    v_mul_f32 v29, v45, v144
    v_mul_f32 v30, v46, v145
    v_mul_f32 v31, v47, v146
    v_exp_f32_e64 v24, v24 clamp
    v_exp_f32_e64 v25, v25 clamp
    v_exp_f32_e64 v26, v26 clamp
    v_exp_f32_e64 v27, v27 clamp
    v_exp_f32_e64 v28, v28 clamp
    v_exp_f32_e64 v29, v29 clamp
    v_exp_f32_e64 v30, v30 clamp
    v_exp_f32_e64 v31, v31 clamp
    v_fma_f32 v40, v40, v130, v35
    v_fma_f32 v41, v41, v131, v35
    v_fma_f32 v42, v42, v132, v35
    v_fma_f32 v43, v43, v133, v35
    v_fma_f32 v44, v44, v134, v35
    v_fma_f32 v45, v45, v135, v35
    v_fma_f32 v46, v46, v136, v35
    v_fma_f32 v47, v47, v137, v35
    v_add_f32 v24, v24, v36
    v_add_f32 v25, v25, v36
    v_add_f32 v26, v26, v36
    v_add_f32 v27, v27, v36
    v_add_f32 v28, v28, v36
    v_add_f32 v29, v29, v36
    v_add_f32 v30, v30, v36
    v_add_f32 v31, v31, v36
    v_max_f32 v40, v40, v24
    v_max_f32 v41, v41, v25
    v_max_f32 v42, v42, v26
    v_max_f32 v43, v43, v27
    v_max_f32 v44, v44, v28
    v_max_f32 v45, v45, v29
    v_max_f32 v46, v46, v30
    v_max_f32 v47, v47, v31
    v_mul_f32 v24, v48, v139
    v_mul_f32 v25, v49, v140
    v_mul_f32 v26, v50, v141
    v_mul_f32 v27, v51, v142
    v_mul_f32 v28, v52, v143
    v_mul_f32 v29, v53, v144
    v_mul_f32 v30, v54, v145
    v_mul_f32 v31, v55, v146
    v_exp_f32_e64 v24, v24 clamp
    v_exp_f32_e64 v25, v25 clamp
    v_exp_f32_e64 v26, v26 clamp
    v_exp_f32_e64 v27, v27 clamp
    v_exp_f32_e64 v28, v28 clamp
    v_exp_f32_e64 v29, v29 clamp
    v_exp_f32_e64 v30, v30 clamp
    v_exp_f32_e64 v31, v31 clamp
    v_fma_f32 v48, v48, v130, v35
    v_fma_f32 v49, v49, v131, v35
    v_fma_f32 v50, v50, v132, v35
    v_fma_f32 v51, v51, v133, v35
    v_fma_f32 v52, v52, v134, v35
    v_fma_f32 v53, v53, v135, v35
    v_fma_f32 v54, v54, v136, v35
    v_fma_f32 v55, v55, v137, v35
    v_add_f32 v24, v24, v36
    v_add_f32 v25, v25, v36
    v_add_f32 v26, v26, v36
    v_add_f32 v27, v27, v36
    v_add_f32 v28, v28, v36
    v_add_f32 v29, v29, v36
    v_add_f32 v30, v30, v36
    v_add_f32 v31, v31, v36
    v_max_f32 v48, v48, v24
    v_max_f32 v49, v49, v25
    v_max_f32 v50, v50, v26
    v_max_f32 v51, v51, v27
    v_max_f32 v52, v52, v28
    v_max_f32 v53, v53, v29
    v_max_f32 v54, v54, v30
    v_max_f32 v55, v55, v31
    v_mul_f32 v24, v56, v139
    v_mul_f32 v25, v57, v140
    v_mul_f32 v26, v58, v141
    v_mul_f32 v27, v59, v142
    v_mul_f32 v28, v60, v143
    v_mul_f32 v29, v61, v144
    v_mul_f32 v30, v62, v145
    v_mul_f32 v31, v63, v146
    v_exp_f32_e64 v24, v24 clamp
    v_exp_f32_e64 v25, v25 clamp
    v_exp_f32_e64 v26, v26 clamp
    v_exp_f32_e64 v27, v27 clamp
    v_exp_f32_e64 v28, v28 clamp
    v_exp_f32_e64 v29, v29 clamp
    v_exp_f32_e64 v30, v30 clamp
    v_exp_f32_e64 v31, v31 clamp
    v_fma_f32 v56, v56, v130, v35
    v_fma_f32 v57, v57, v131, v35
    v_fma_f32 v58, v58, v132, v35
    v_fma_f32 v59, v59, v133, v35
    v_fma_f32 v60, v60, v134, v35
    v_fma_f32 v61, v61, v135, v35
    v_fma_f32 v62, v62, v136, v35
    v_fma_f32 v63, v63, v137, v35
    v_add_f32 v24, v24, v36
    v_add_f32 v25, v25, v36
    v_add_f32 v26, v26, v36
    v_add_f32 v27, v27, v36
    v_add_f32 v28, v28, v36
    v_add_f32 v29, v29, v36
    v_add_f32 v30, v30, v36
    v_add_f32 v31, v31, v36
    v_max_f32 v56, v56, v24
    v_max_f32 v57, v57, v25
    v_max_f32 v58, v58, v26
    v_max_f32 v59, v59, v27
    v_max_f32 v60, v60, v28
    v_max_f32 v61, v61, v29
    v_max_f32 v62, v62, v30
    v_max_f32 v63, v63, v31
    v_mul_f32 v24, v64, v139
    v_mul_f32 v25, v65, v140
    v_mul_f32 v26, v66, v141
    v_mul_f32 v27, v67, v142
    v_mul_f32 v28, v68, v143
    v_mul_f32 v29, v69, v144
    v_mul_f32 v30, v70, v145
    v_mul_f32 v31, v71, v146
    v_exp_f32_e64 v24, v24 clamp
    v_exp_f32_e64 v25, v25 clamp
    v_exp_f32_e64 v26, v26 clamp
    v_exp_f32_e64 v27, v27 clamp
    v_exp_f32_e64 v28, v28 clamp
    v_exp_f32_e64 v29, v29 clamp
    v_exp_f32_e64 v30, v30 clamp
    v_exp_f32_e64 v31, v31 clamp
    v_fma_f32 v64, v64, v130, v35
    v_fma_f32 v65, v65, v131, v35
    v_fma_f32 v66, v66, v132, v35
    v_fma_f32 v67, v67, v133, v35
    v_fma_f32 v68, v68, v134, v35
    v_fma_f32 v69, v69, v135, v35
    v_fma_f32 v70, v70, v136, v35
    v_fma_f32 v71, v71, v137, v35
    v_add_f32 v24, v24, v36
    v_add_f32 v25, v25, v36
    v_add_f32 v26, v26, v36
    v_add_f32 v27, v27, v36
    v_add_f32 v28, v28, v36
    v_add_f32 v29, v29, v36
    v_add_f32 v30, v30, v36
    v_add_f32 v31, v31, v36
    v_max_f32 v64, v64, v24
    v_max_f32 v65, v65, v25
    v_max_f32 v66, v66, v26
    v_max_f32 v67, v67, v27
    v_max_f32 v68, v68, v28
    v_max_f32 v69, v69, v29
    v_max_f32 v70, v70, v30
    v_max_f32 v71, v71, v31
    v_mul_f32 v24, v72, v139
    v_mul_f32 v25, v73, v140
    v_mul_f32 v26, v74, v141
    v_mul_f32 v27, v75, v142
    v_mul_f32 v28, v76, v143
    v_mul_f32 v29, v77, v144
    v_mul_f32 v30, v78, v145
    v_mul_f32 v31, v79, v146
    v_exp_f32_e64 v24, v24 clamp
    v_exp_f32_e64 v25, v25 clamp
    v_exp_f32_e64 v26, v26 clamp
    v_exp_f32_e64 v27, v27 clamp
    v_exp_f32_e64 v28, v28 clamp
    v_exp_f32_e64 v29, v29 clamp
    v_exp_f32_e64 v30, v30 clamp
    v_exp_f32_e64 v31, v31 clamp
    v_fma_f32 v72, v72, v130, v35
    v_fma_f32 v73, v73, v131, v35
    v_fma_f32 v74, v74, v132, v35
    v_fma_f32 v75, v75, v133, v35
    v_fma_f32 v76, v76, v134, v35
    v_fma_f32 v77, v77, v135, v35
    v_fma_f32 v78, v78, v136, v35
    v_fma_f32 v79, v79, v137, v35
    v_add_f32 v24, v24, v36
    v_add_f32 v25, v25, v36
    v_add_f32 v26, v26, v36
    v_add_f32 v27, v27, v36
    v_add_f32 v28, v28, v36
    v_add_f32 v29, v29, v36
    v_add_f32 v30, v30, v36
    v_add_f32 v31, v31, v36
    v_max_f32 v72, v72, v24
    v_max_f32 v73, v73, v25
    v_max_f32 v74, v74, v26
    v_max_f32 v75, v75, v27
    v_max_f32 v76, v76, v28
    v_max_f32 v77, v77, v29
    v_max_f32 v78, v78, v30
    v_max_f32 v79, v79, v31
    s_branch k1_kernel_phid
k1_kernel_nophi:
    v_mul_f32 v40, v40, v130
    v_mul_f32 v41, v41, v131
    v_mul_f32 v42, v42, v132
    v_mul_f32 v43, v43, v133
    v_mul_f32 v44, v44, v134
    v_mul_f32 v45, v45, v135
    v_mul_f32 v46, v46, v136
    v_mul_f32 v47, v47, v137
    v_mul_f32 v48, v48, v130
    v_mul_f32 v49, v49, v131
    v_mul_f32 v50, v50, v132
    v_mul_f32 v51, v51, v133
    v_mul_f32 v52, v52, v134
    v_mul_f32 v53, v53, v135
    v_mul_f32 v54, v54, v136
    v_mul_f32 v55, v55, v137
    v_mul_f32 v56, v56, v130
    v_mul_f32 v57, v57, v131
    v_mul_f32 v58, v58, v132
    v_mul_f32 v59, v59, v133
    v_mul_f32 v60, v60, v134
    v_mul_f32 v61, v61, v135
    v_mul_f32 v62, v62, v136
    v_mul_f32 v63, v63, v137
    v_mul_f32 v64, v64, v130
    v_mul_f32 v65, v65, v131
    v_mul_f32 v66, v66, v132
    v_mul_f32 v67, v67, v133
    v_mul_f32 v68, v68, v134
    v_mul_f32 v69, v69, v135
    v_mul_f32 v70, v70, v136
    v_mul_f32 v71, v71, v137
    v_mul_f32 v72, v72, v130
    v_mul_f32 v73, v73, v131
    v_mul_f32 v74, v74, v132
    v_mul_f32 v75, v75, v133
    v_mul_f32 v76, v76, v134
    v_mul_f32 v77, v77, v135
    v_mul_f32 v78, v78, v136
    v_mul_f32 v79, v79, v137
k1_kernel_phid:
    v_cvt_pk_bf16_f32 v108, v40, v41
    v_cvt_pk_bf16_f32 v109, v42, v43
    v_cvt_pk_bf16_f32 v110, v44, v45
    v_cvt_pk_bf16_f32 v111, v46, v47
    v_cvt_pk_bf16_f32 v112, v48, v49
    v_cvt_pk_bf16_f32 v113, v50, v51
    v_cvt_pk_bf16_f32 v114, v52, v53
    v_cvt_pk_bf16_f32 v115, v54, v55
    v_cvt_pk_bf16_f32 v116, v56, v57
    v_cvt_pk_bf16_f32 v117, v58, v59
    v_cvt_pk_bf16_f32 v118, v60, v61
    v_cvt_pk_bf16_f32 v119, v62, v63
    v_cvt_pk_bf16_f32 v120, v64, v65
    v_cvt_pk_bf16_f32 v121, v66, v67
    v_cvt_pk_bf16_f32 v122, v68, v69
    v_cvt_pk_bf16_f32 v123, v70, v71
    v_cvt_pk_bf16_f32 v124, v72, v73
    v_cvt_pk_bf16_f32 v125, v74, v75
    v_cvt_pk_bf16_f32 v126, v76, v77
    v_cvt_pk_bf16_f32 v127, v78, v79
    s_mul_i32 s38, s92, 5120
    s_add_u32 s38, s38, 8192
    v_lshl_add_u32 v24, v0, 4, s38
    s_cmp_eq_u32 s93, 0
    s_cbranch_scc1 k1_kernel_kw
    v_and_b32 v25, 3, v0
    v_cmp_eq_u32 vcc, 0, v25
    s_nop 1
    v_cndmask_b32 v124, v124, v20, vcc
    v_cndmask_b32 v125, v125, v20, vcc
    v_cndmask_b32 v126, v126, v20, vcc
    v_cndmask_b32 v127, v127, v20, vcc
    ds_write_b128 v24, v[108:111] offset:0
    ds_write_b128 v24, v[112:115] offset:1024
    ds_write_b128 v24, v[116:119] offset:2048
    ds_write_b128 v24, v[120:123] offset:3072
    ds_write_b128 v24, v[124:127] offset:4096
    s_waitcnt lgkmcnt(0)
    s_barrier
    s_branch k1_kernel_kvj
k1_kernel_kw:
    v_bfe_u32 v27, v0, 2, 2
    v_lshrrev_b32 v26, 4, v0
    v_cmp_eq_u32 s[84:85], 1, v26
    v_cmp_eq_u32 s[96:97], 1, v27
    v_cmp_eq_u32 s[86:87], 2, v26
    v_cmp_eq_u32 s[98:99], 2, v27
    v_cmp_eq_u32 s[88:89], 3, v26
    v_cmp_eq_u32 s[100:101], 3, v27
    s_barrier
    ds_read_b128 v[128:131], v24 offset:0
    ds_read_b128 v[132:135], v24 offset:1024
    ds_read_b128 v[136:139], v24 offset:2048
    ds_read_b128 v[140:143], v24 offset:3072
    ds_read_b128 v[144:147], v24 offset:4096
    s_mul_i32 s36, s92, 6144
    s_add_u32 s36, s36, 32768
    v_lshl_add_u32 v24, v0, 4, s36
    v_lshl_add_u32 v27, v0, 3, s36
    s_waitcnt lgkmcnt(0)
    v_mfma_f32_16x16x32_bf16 v[56:59], v[108:111], v[144:147], 0
    v_mfma_f32_16x16x32_bf16 v[72:75], v[124:127], v[128:131], 0
    v_mfma_f32_16x16x32_bf16 v[60:63], v[112:115], v[144:147], 0
    v_mfma_f32_16x16x32_bf16 v[76:79], v[124:127], v[132:135], 0
    v_mfma_f32_16x16x32_bf16 v[64:67], v[116:119], v[144:147], 0
    v_mfma_f32_16x16x32_bf16 v[80:83], v[124:127], v[136:139], 0
    v_mfma_f32_16x16x32_bf16 v[68:71], v[120:123], v[144:147], 0
    v_mfma_f32_16x16x32_bf16 v[84:87], v[124:127], v[140:143], 0
    v_mfma_f32_16x16x32_bf16 v[88:91], v[124:127], v[144:147], 0
    v_mfma_f32_16x16x32_bf16 v[40:43], v[108:111], v[128:131], 0
    v_mfma_f32_16x16x32_bf16 v[44:47], v[112:115], v[132:135], 0
    v_mfma_f32_16x16x32_bf16 v[48:51], v[116:119], v[136:139], 0
    v_mfma_f32_16x16x32_bf16 v[52:55], v[120:123], v[140:143], 0
    s_nop 3
    v_cndmask_b32 v56, v56, v60, s[96:97]
    v_cndmask_b32 v57, v57, v61, s[96:97]
    v_cndmask_b32 v58, v58, v62, s[96:97]
    v_cndmask_b32 v59, v59, v63, s[96:97]
    v_cndmask_b32 v74, v74, v78, s[84:85]
    v_cndmask_b32 v75, v75, v79, s[84:85]
    v_cndmask_b32 v56, v56, v64, s[98:99]
    v_cndmask_b32 v57, v57, v65, s[98:99]
    v_cndmask_b32 v58, v58, v66, s[98:99]
    v_cndmask_b32 v59, v59, v67, s[98:99]
    v_cndmask_b32 v74, v74, v82, s[86:87]
    v_cndmask_b32 v75, v75, v83, s[86:87]
    v_cndmask_b32 v56, v56, v68, s[100:101]
    v_cndmask_b32 v57, v57, v69, s[100:101]
    v_cndmask_b32 v58, v58, v70, s[100:101]
    v_cndmask_b32 v59, v59, v71, s[100:101]
    v_cndmask_b32 v74, v74, v86, s[88:89]
    v_cndmask_b32 v75, v75, v87, s[88:89]
    ds_write_b64 v27, v[74:75] offset:4096
    ds_write_b128 v24, v[56:59] offset:4608
    ds_write_b64 v27, v[90:91] offset:5632
    ds_write_b128 v24, v[40:43] offset:0
    ds_write_b128 v24, v[44:47] offset:1024
    ds_write_b128 v24, v[48:51] offset:2048
    ds_write_b128 v24, v[52:55] offset:3072
    s_waitcnt lgkmcnt(0)
k1_kernel_kvj:
    s_mov_b32 s38, 0
k1_kernel_poll:
    s_waitcnt vmcnt(0)
    v_readfirstlane_b32 s37, v19
    s_add_u32 s38, s38, 1
    s_cmp_lg_u32 s37, 0
    s_cbranch_scc1 k1_kernel_polld
    s_cmp_ge_u32 s38, 0x8000
    s_cbranch_scc1 k1_kernel_polld
    buffer_load_dword v19, v18, s[16:19], 0 offen sc1
    s_branch k1_kernel_poll
k1_kernel_polld:
    s_barrier
    s_lshl_b32 s36, s32, 8
    s_add_u32 s36, s36, 32768
    v_lshl_add_u32 v24, v0, 2, s36
    ds_read_b32 v148, v24 offset:0
    ds_read_b32 v149, v24 offset:6144
    ds_read_b32 v150, v24 offset:12288
    ds_read_b32 v151, v24 offset:18432
    ds_read_b32 v152, v24 offset:2048
    ds_read_b32 v153, v24 offset:8192
    ds_read_b32 v154, v24 offset:14336
    ds_read_b32 v155, v24 offset:20480
    ds_read_b32 v156, v24 offset:4096
    ds_read_b32 v157, v24 offset:10240
    ds_read_b32 v158, v24 offset:16384
    ds_read_b32 v159, v24 offset:22528
    s_waitcnt lgkmcnt(8)
    v_add_f32 v148, v148, v149
    v_add_f32 v150, v150, v151
    v_add_f32 v148, v148, v150
    buffer_atomic_add_f32 v148, v17, s[20:23], 0 offen offset:0
    s_waitcnt lgkmcnt(4)
    v_add_f32 v152, v152, v153
    v_add_f32 v154, v154, v155
    v_add_f32 v152, v152, v154
    buffer_atomic_add_f32 v152, v17, s[20:23], 0 offen offset:2048
    s_waitcnt lgkmcnt(0)
    v_add_f32 v156, v156, v157
    v_add_f32 v158, v158, v159
    v_add_f32 v156, v156, v158
    buffer_atomic_add_f32 v156, v17, s[20:23], s29 offen offset:0
    s_branch k1_kernel_fin
k1_kernel_q:
    s_barrier
    ds_read_b128 v[148:151], v15 offset:0
    ds_read_b128 v[152:155], v15 offset:2048
    ds_read_b64_tr_b16 v[108:109], v5 offset:0
    ds_read_b64_tr_b16 v[110:111], v5 offset:1024
    ds_read_b64_tr_b16 v[112:113], v6 offset:0
    ds_read_b64_tr_b16 v[114:115], v6 offset:1024
    ds_read_b64_tr_b16 v[116:117], v7 offset:0
    ds_read_b64_tr_b16 v[118:119], v7 offset:1024
    ds_read_b64_tr_b16 v[120:121], v8 offset:0
    ds_read_b64_tr_b16 v[122:123], v8 offset:1024
    ds_read_b64_tr_b16 v[124:125], v9 offset:0
    ds_read_b64_tr_b16 v[126:127], v9 offset:1024
    s_waitcnt lgkmcnt(0)
    v_mfma_f32_16x16x32_bf16 v[40:43], v[108:111], v[148:151], 0
    ds_read_b128 v[156:159], v16 offset:0
    ds_read_b128 v[160:163], v16 offset:2048
    v_mfma_f32_16x16x32_bf16 v[44:47], v[108:111], v[152:155], 0
    ds_read_b64_tr_b16 v[128:129], v5 offset:16384
    ds_read_b64_tr_b16 v[130:131], v5 offset:17408
    v_mfma_f32_16x16x32_bf16 v[48:51], v[112:115], v[148:151], 0
    ds_read_b64_tr_b16 v[132:133], v6 offset:16384
    v_mfma_f32_16x16x32_bf16 v[52:55], v[112:115], v[152:155], 0
    ds_read_b64_tr_b16 v[134:135], v6 offset:17408
    v_mfma_f32_16x16x32_bf16 v[56:59], v[116:119], v[148:151], 0
    ds_read_b64_tr_b16 v[136:137], v7 offset:16384
    v_mfma_f32_16x16x32_bf16 v[60:63], v[116:119], v[152:155], 0
    ds_read_b64_tr_b16 v[138:139], v7 offset:17408
    v_mfma_f32_16x16x32_bf16 v[64:67], v[120:123], v[148:151], 0
    ds_read_b64_tr_b16 v[140:141], v8 offset:16384
    v_mfma_f32_16x16x32_bf16 v[68:71], v[120:123], v[152:155], 0
    ds_read_b64_tr_b16 v[142:143], v8 offset:17408
    v_mfma_f32_16x16x32_bf16 v[72:75], v[124:127], v[148:151], 0
    ds_read_b64_tr_b16 v[144:145], v9 offset:16384
    v_mfma_f32_16x16x32_bf16 v[76:79], v[124:127], v[152:155], 0
    ds_read_b64_tr_b16 v[146:147], v9 offset:17408
    s_cmp_eq_u32 s93, 0
    s_cbranch_scc1 k1_kernel_s_20a
    v_mfma_f32_16x16x32_bf16 v[80:83], v[148:151], v[148:151], 0
    v_mfma_f32_16x16x32_bf16 v[84:87], v[152:155], v[152:155], 0
    s_branch k1_kernel_s_20b
k1_kernel_s_20a:
    v_mfma_f32_16x16x32_bf16 v[80:83], v[148:151], v[20:23], 0
    v_mfma_f32_16x16x32_bf16 v[84:87], v[152:155], v[20:23], 0
k1_kernel_s_20b:
    s_cmp_lg_u32 s95, 0
    s_cbranch_scc1 k1_kernel_s_20c
    v_mfma_f32_16x16x32_bf16 v[88:91], v[20:23], v[108:111], 0
    v_mfma_f32_16x16x32_bf16 v[92:95], v[20:23], v[112:115], 0
    v_mfma_f32_16x16x32_bf16 v[96:99], v[20:23], v[116:119], 0
    v_mfma_f32_16x16x32_bf16 v[100:103], v[20:23], v[120:123], 0
    v_mfma_f32_16x16x32_bf16 v[104:107], v[20:23], v[124:127], 0
k1_kernel_s_20c:
    s_waitcnt lgkmcnt(0)
    s_barrier
    v_mfma_f32_16x16x32_bf16 v[40:43], v[128:131], v[156:159], v[40:43]
    ds_read_b128 v[148:151], v15 offset:16384
    ds_read_b128 v[152:155], v15 offset:18432
    v_mfma_f32_16x16x32_bf16 v[44:47], v[128:131], v[160:163], v[44:47]
    ds_read_b64_tr_b16 v[108:109], v5 offset:32768
    ds_read_b64_tr_b16 v[110:111], v5 offset:33792
    v_mfma_f32_16x16x32_bf16 v[48:51], v[132:135], v[156:159], v[48:51]
    ds_read_b64_tr_b16 v[112:113], v6 offset:32768
    v_mfma_f32_16x16x32_bf16 v[52:55], v[132:135], v[160:163], v[52:55]
    ds_read_b64_tr_b16 v[114:115], v6 offset:33792
    v_mfma_f32_16x16x32_bf16 v[56:59], v[136:139], v[156:159], v[56:59]
    ds_read_b64_tr_b16 v[116:117], v7 offset:32768
    v_mfma_f32_16x16x32_bf16 v[60:63], v[136:139], v[160:163], v[60:63]
    ds_read_b64_tr_b16 v[118:119], v7 offset:33792
    v_mfma_f32_16x16x32_bf16 v[64:67], v[140:143], v[156:159], v[64:67]
    ds_read_b64_tr_b16 v[120:121], v8 offset:32768
    v_mfma_f32_16x16x32_bf16 v[68:71], v[140:143], v[160:163], v[68:71]
    ds_read_b64_tr_b16 v[122:123], v8 offset:33792
    v_mfma_f32_16x16x32_bf16 v[72:75], v[144:147], v[156:159], v[72:75]
    ds_read_b64_tr_b16 v[124:125], v9 offset:32768
    v_mfma_f32_16x16x32_bf16 v[76:79], v[144:147], v[160:163], v[76:79]
    ds_read_b64_tr_b16 v[126:127], v9 offset:33792
    s_cmp_eq_u32 s93, 0
    s_cbranch_scc1 k1_kernel_s_21a
    v_mfma_f32_16x16x32_bf16 v[80:83], v[156:159], v[156:159], v[80:83]
    v_mfma_f32_16x16x32_bf16 v[84:87], v[160:163], v[160:163], v[84:87]
    s_branch k1_kernel_s_21b
k1_kernel_s_21a:
    v_mfma_f32_16x16x32_bf16 v[80:83], v[156:159], v[20:23], v[80:83]
    v_mfma_f32_16x16x32_bf16 v[84:87], v[160:163], v[20:23], v[84:87]
k1_kernel_s_21b:
    s_cmp_lg_u32 s95, 1
    s_cbranch_scc1 k1_kernel_s_21c
    v_mfma_f32_16x16x32_bf16 v[88:91], v[20:23], v[128:131], 0
    v_mfma_f32_16x16x32_bf16 v[92:95], v[20:23], v[132:135], 0
    v_mfma_f32_16x16x32_bf16 v[96:99], v[20:23], v[136:139], 0
    v_mfma_f32_16x16x32_bf16 v[100:103], v[20:23], v[140:143], 0
    v_mfma_f32_16x16x32_bf16 v[104:107], v[20:23], v[144:147], 0
k1_kernel_s_21c:
    s_waitcnt lgkmcnt(0)
    v_mfma_f32_16x16x32_bf16 v[40:43], v[108:111], v[148:151], v[40:43]
    ds_read_b128 v[156:159], v16 offset:16384
    ds_read_b128 v[160:163], v16 offset:18432
    v_mfma_f32_16x16x32_bf16 v[44:47], v[108:111], v[152:155], v[44:47]
    ds_read_b64_tr_b16 v[128:129], v10 offset:0
    ds_read_b64_tr_b16 v[130:131], v10 offset:1024
    v_mfma_f32_16x16x32_bf16 v[48:51], v[112:115], v[148:151], v[48:51]
    ds_read_b64_tr_b16 v[132:133], v11 offset:0
    v_mfma_f32_16x16x32_bf16 v[52:55], v[112:115], v[152:155], v[52:55]
    ds_read_b64_tr_b16 v[134:135], v11 offset:1024
    v_mfma_f32_16x16x32_bf16 v[56:59], v[116:119], v[148:151], v[56:59]
    ds_read_b64_tr_b16 v[136:137], v12 offset:0
    v_mfma_f32_16x16x32_bf16 v[60:63], v[116:119], v[152:155], v[60:63]
    ds_read_b64_tr_b16 v[138:139], v12 offset:1024
    v_mfma_f32_16x16x32_bf16 v[64:67], v[120:123], v[148:151], v[64:67]
    ds_read_b64_tr_b16 v[140:141], v13 offset:0
    v_mfma_f32_16x16x32_bf16 v[68:71], v[120:123], v[152:155], v[68:71]
    ds_read_b64_tr_b16 v[142:143], v13 offset:1024
    v_mfma_f32_16x16x32_bf16 v[72:75], v[124:127], v[148:151], v[72:75]
    ds_read_b64_tr_b16 v[144:145], v14 offset:0
    v_mfma_f32_16x16x32_bf16 v[76:79], v[124:127], v[152:155], v[76:79]
    ds_read_b64_tr_b16 v[146:147], v14 offset:1024
    s_cmp_eq_u32 s93, 0
    s_cbranch_scc1 k1_kernel_s_22a
    v_mfma_f32_16x16x32_bf16 v[80:83], v[148:151], v[148:151], v[80:83]
    v_mfma_f32_16x16x32_bf16 v[84:87], v[152:155], v[152:155], v[84:87]
    s_branch k1_kernel_s_22b
k1_kernel_s_22a:
    v_mfma_f32_16x16x32_bf16 v[80:83], v[148:151], v[20:23], v[80:83]
    v_mfma_f32_16x16x32_bf16 v[84:87], v[152:155], v[20:23], v[84:87]
k1_kernel_s_22b:
    s_cmp_lg_u32 s95, 2
    s_cbranch_scc1 k1_kernel_s_22c
    v_mfma_f32_16x16x32_bf16 v[88:91], v[20:23], v[108:111], 0
    v_mfma_f32_16x16x32_bf16 v[92:95], v[20:23], v[112:115], 0
    v_mfma_f32_16x16x32_bf16 v[96:99], v[20:23], v[116:119], 0
    v_mfma_f32_16x16x32_bf16 v[100:103], v[20:23], v[120:123], 0
    v_mfma_f32_16x16x32_bf16 v[104:107], v[20:23], v[124:127], 0
k1_kernel_s_22c:
    s_waitcnt lgkmcnt(0)
    s_barrier
    v_mfma_f32_16x16x32_bf16 v[40:43], v[128:131], v[156:159], v[40:43]
    ds_read_b128 v[148:151], v15 offset:32768
    ds_read_b128 v[152:155], v15 offset:34816
    v_mfma_f32_16x16x32_bf16 v[44:47], v[128:131], v[160:163], v[44:47]
    ds_read_b64_tr_b16 v[108:109], v10 offset:16384
    ds_read_b64_tr_b16 v[110:111], v10 offset:17408
    v_mfma_f32_16x16x32_bf16 v[48:51], v[132:135], v[156:159], v[48:51]
    ds_read_b64_tr_b16 v[112:113], v11 offset:16384
    v_mfma_f32_16x16x32_bf16 v[52:55], v[132:135], v[160:163], v[52:55]
    ds_read_b64_tr_b16 v[114:115], v11 offset:17408
    v_mfma_f32_16x16x32_bf16 v[56:59], v[136:139], v[156:159], v[56:59]
    ds_read_b64_tr_b16 v[116:117], v12 offset:16384
    v_mfma_f32_16x16x32_bf16 v[60:63], v[136:139], v[160:163], v[60:63]
    ds_read_b64_tr_b16 v[118:119], v12 offset:17408
    v_mfma_f32_16x16x32_bf16 v[64:67], v[140:143], v[156:159], v[64:67]
    ds_read_b64_tr_b16 v[120:121], v13 offset:16384
    v_mfma_f32_16x16x32_bf16 v[68:71], v[140:143], v[160:163], v[68:71]
    ds_read_b64_tr_b16 v[122:123], v13 offset:17408
    v_mfma_f32_16x16x32_bf16 v[72:75], v[144:147], v[156:159], v[72:75]
    ds_read_b64_tr_b16 v[124:125], v14 offset:16384
    v_mfma_f32_16x16x32_bf16 v[76:79], v[144:147], v[160:163], v[76:79]
    ds_read_b64_tr_b16 v[126:127], v14 offset:17408
    s_cmp_eq_u32 s93, 0
    s_cbranch_scc1 k1_kernel_s_23a
    v_mfma_f32_16x16x32_bf16 v[80:83], v[156:159], v[156:159], v[80:83]
    v_mfma_f32_16x16x32_bf16 v[84:87], v[160:163], v[160:163], v[84:87]
    s_branch k1_kernel_s_23b
k1_kernel_s_23a:
    v_mfma_f32_16x16x32_bf16 v[80:83], v[156:159], v[20:23], v[80:83]
    v_mfma_f32_16x16x32_bf16 v[84:87], v[160:163], v[20:23], v[84:87]
k1_kernel_s_23b:
    s_cmp_lg_u32 s95, 3
    s_cbranch_scc1 k1_kernel_s_23c
    v_mfma_f32_16x16x32_bf16 v[88:91], v[20:23], v[128:131], 0
    v_mfma_f32_16x16x32_bf16 v[92:95], v[20:23], v[132:135], 0
    v_mfma_f32_16x16x32_bf16 v[96:99], v[20:23], v[136:139], 0
    v_mfma_f32_16x16x32_bf16 v[100:103], v[20:23], v[140:143], 0
    v_mfma_f32_16x16x32_bf16 v[104:107], v[20:23], v[144:147], 0
k1_kernel_s_23c:
    s_waitcnt lgkmcnt(0)
    v_mfma_f32_16x16x32_bf16 v[40:43], v[108:111], v[148:151], v[40:43]
    ds_read_b128 v[156:159], v16 offset:32768
    ds_read_b128 v[160:163], v16 offset:34816
    v_mfma_f32_16x16x32_bf16 v[44:47], v[108:111], v[152:155], v[44:47]
    ds_read_b64_tr_b16 v[128:129], v10 offset:32768
    ds_read_b64_tr_b16 v[130:131], v10 offset:33792
    v_mfma_f32_16x16x32_bf16 v[48:51], v[112:115], v[148:151], v[48:51]
    ds_read_b64_tr_b16 v[132:133], v11 offset:32768
    v_mfma_f32_16x16x32_bf16 v[52:55], v[112:115], v[152:155], v[52:55]
    ds_read_b64_tr_b16 v[134:135], v11 offset:33792
    v_mfma_f32_16x16x32_bf16 v[56:59], v[116:119], v[148:151], v[56:59]
    ds_read_b64_tr_b16 v[136:137], v12 offset:32768
    v_mfma_f32_16x16x32_bf16 v[60:63], v[116:119], v[152:155], v[60:63]
    ds_read_b64_tr_b16 v[138:139], v12 offset:33792
    v_mfma_f32_16x16x32_bf16 v[64:67], v[120:123], v[148:151], v[64:67]
    ds_read_b64_tr_b16 v[140:141], v13 offset:32768
    v_mfma_f32_16x16x32_bf16 v[68:71], v[120:123], v[152:155], v[68:71]
    ds_read_b64_tr_b16 v[142:143], v13 offset:33792
    v_mfma_f32_16x16x32_bf16 v[72:75], v[124:127], v[148:151], v[72:75]
    ds_read_b64_tr_b16 v[144:145], v14 offset:32768
    v_mfma_f32_16x16x32_bf16 v[76:79], v[124:127], v[152:155], v[76:79]
    ds_read_b64_tr_b16 v[146:147], v14 offset:33792
    s_cmp_eq_u32 s93, 0
    s_cbranch_scc1 k1_kernel_s_24a
    v_mfma_f32_16x16x32_bf16 v[80:83], v[148:151], v[148:151], v[80:83]
    v_mfma_f32_16x16x32_bf16 v[84:87], v[152:155], v[152:155], v[84:87]
    s_branch k1_kernel_s_24b
k1_kernel_s_24a:
    v_mfma_f32_16x16x32_bf16 v[80:83], v[148:151], v[20:23], v[80:83]
    v_mfma_f32_16x16x32_bf16 v[84:87], v[152:155], v[20:23], v[84:87]
k1_kernel_s_24b:
    s_cmp_lg_u32 s95, 0
    s_cbranch_scc1 k1_kernel_s_24c
    v_mfma_f32_16x16x32_bf16 v[88:91], v[20:23], v[108:111], v[88:91]
    v_mfma_f32_16x16x32_bf16 v[92:95], v[20:23], v[112:115], v[92:95]
    v_mfma_f32_16x16x32_bf16 v[96:99], v[20:23], v[116:119], v[96:99]
    v_mfma_f32_16x16x32_bf16 v[100:103], v[20:23], v[120:123], v[100:103]
    v_mfma_f32_16x16x32_bf16 v[104:107], v[20:23], v[124:127], v[104:107]
k1_kernel_s_24c:
    s_waitcnt lgkmcnt(0)
    s_barrier
    v_mfma_f32_16x16x32_bf16 v[40:43], v[128:131], v[156:159], v[40:43]
    ds_read_b128 v[148:151], v15 offset:0
    ds_read_b128 v[152:155], v15 offset:2048
    v_mfma_f32_16x16x32_bf16 v[44:47], v[128:131], v[160:163], v[44:47]
    ds_read_b64_tr_b16 v[108:109], v5 offset:0
    ds_read_b64_tr_b16 v[110:111], v5 offset:1024
    v_mfma_f32_16x16x32_bf16 v[48:51], v[132:135], v[156:159], v[48:51]
    ds_read_b64_tr_b16 v[112:113], v6 offset:0
    v_mfma_f32_16x16x32_bf16 v[52:55], v[132:135], v[160:163], v[52:55]
    ds_read_b64_tr_b16 v[114:115], v6 offset:1024
    v_mfma_f32_16x16x32_bf16 v[56:59], v[136:139], v[156:159], v[56:59]
    ds_read_b64_tr_b16 v[116:117], v7 offset:0
    v_mfma_f32_16x16x32_bf16 v[60:63], v[136:139], v[160:163], v[60:63]
    ds_read_b64_tr_b16 v[118:119], v7 offset:1024
    v_mfma_f32_16x16x32_bf16 v[64:67], v[140:143], v[156:159], v[64:67]
    ds_read_b64_tr_b16 v[120:121], v8 offset:0
    v_mfma_f32_16x16x32_bf16 v[68:71], v[140:143], v[160:163], v[68:71]
    ds_read_b64_tr_b16 v[122:123], v8 offset:1024
    v_mfma_f32_16x16x32_bf16 v[72:75], v[144:147], v[156:159], v[72:75]
    ds_read_b64_tr_b16 v[124:125], v9 offset:0
    v_mfma_f32_16x16x32_bf16 v[76:79], v[144:147], v[160:163], v[76:79]
    ds_read_b64_tr_b16 v[126:127], v9 offset:1024
    s_cmp_eq_u32 s93, 0
    s_cbranch_scc1 k1_kernel_s_25a
    v_mfma_f32_16x16x32_bf16 v[80:83], v[156:159], v[156:159], v[80:83]
    v_mfma_f32_16x16x32_bf16 v[84:87], v[160:163], v[160:163], v[84:87]
    s_branch k1_kernel_s_25b
k1_kernel_s_25a:
    v_mfma_f32_16x16x32_bf16 v[80:83], v[156:159], v[20:23], v[80:83]
    v_mfma_f32_16x16x32_bf16 v[84:87], v[160:163], v[20:23], v[84:87]
k1_kernel_s_25b:
    s_cmp_lg_u32 s95, 1
    s_cbranch_scc1 k1_kernel_s_25c
    v_mfma_f32_16x16x32_bf16 v[88:91], v[20:23], v[128:131], v[88:91]
    v_mfma_f32_16x16x32_bf16 v[92:95], v[20:23], v[132:135], v[92:95]
    v_mfma_f32_16x16x32_bf16 v[96:99], v[20:23], v[136:139], v[96:99]
    v_mfma_f32_16x16x32_bf16 v[100:103], v[20:23], v[140:143], v[100:103]
    v_mfma_f32_16x16x32_bf16 v[104:107], v[20:23], v[144:147], v[104:107]
k1_kernel_s_25c:
    s_waitcnt lgkmcnt(0)
    v_mfma_f32_16x16x32_bf16 v[40:43], v[108:111], v[148:151], v[40:43]
    ds_read_b128 v[156:159], v16 offset:0
    ds_read_b128 v[160:163], v16 offset:2048
    v_mfma_f32_16x16x32_bf16 v[44:47], v[108:111], v[152:155], v[44:47]
    ds_read_b64_tr_b16 v[128:129], v5 offset:16384
    ds_read_b64_tr_b16 v[130:131], v5 offset:17408
    v_mfma_f32_16x16x32_bf16 v[48:51], v[112:115], v[148:151], v[48:51]
    ds_read_b64_tr_b16 v[132:133], v6 offset:16384
    v_mfma_f32_16x16x32_bf16 v[52:55], v[112:115], v[152:155], v[52:55]
    ds_read_b64_tr_b16 v[134:135], v6 offset:17408
    v_mfma_f32_16x16x32_bf16 v[56:59], v[116:119], v[148:151], v[56:59]
    ds_read_b64_tr_b16 v[136:137], v7 offset:16384
    v_mfma_f32_16x16x32_bf16 v[60:63], v[116:119], v[152:155], v[60:63]
    ds_read_b64_tr_b16 v[138:139], v7 offset:17408
    v_mfma_f32_16x16x32_bf16 v[64:67], v[120:123], v[148:151], v[64:67]
    ds_read_b64_tr_b16 v[140:141], v8 offset:16384
    v_mfma_f32_16x16x32_bf16 v[68:71], v[120:123], v[152:155], v[68:71]
    ds_read_b64_tr_b16 v[142:143], v8 offset:17408
    v_mfma_f32_16x16x32_bf16 v[72:75], v[124:127], v[148:151], v[72:75]
    ds_read_b64_tr_b16 v[144:145], v9 offset:16384
    v_mfma_f32_16x16x32_bf16 v[76:79], v[124:127], v[152:155], v[76:79]
    ds_read_b64_tr_b16 v[146:147], v9 offset:17408
    s_cmp_eq_u32 s93, 0
    s_cbranch_scc1 k1_kernel_s_26a
    v_mfma_f32_16x16x32_bf16 v[80:83], v[148:151], v[148:151], v[80:83]
    v_mfma_f32_16x16x32_bf16 v[84:87], v[152:155], v[152:155], v[84:87]
    s_branch k1_kernel_s_26b
k1_kernel_s_26a:
    v_mfma_f32_16x16x32_bf16 v[80:83], v[148:151], v[20:23], v[80:83]
    v_mfma_f32_16x16x32_bf16 v[84:87], v[152:155], v[20:23], v[84:87]
k1_kernel_s_26b:
    s_cmp_lg_u32 s95, 2
    s_cbranch_scc1 k1_kernel_s_26c
    v_mfma_f32_16x16x32_bf16 v[88:91], v[20:23], v[108:111], v[88:91]
    v_mfma_f32_16x16x32_bf16 v[92:95], v[20:23], v[112:115], v[92:95]
    v_mfma_f32_16x16x32_bf16 v[96:99], v[20:23], v[116:119], v[96:99]
    v_mfma_f32_16x16x32_bf16 v[100:103], v[20:23], v[120:123], v[100:103]
    v_mfma_f32_16x16x32_bf16 v[104:107], v[20:23], v[124:127], v[104:107]
k1_kernel_s_26c:
    s_waitcnt lgkmcnt(0)
    s_barrier
    v_mfma_f32_16x16x32_bf16 v[40:43], v[128:131], v[156:159], v[40:43]
    ds_read_b128 v[148:151], v15 offset:16384
    ds_read_b128 v[152:155], v15 offset:18432
    v_mfma_f32_16x16x32_bf16 v[44:47], v[128:131], v[160:163], v[44:47]
    ds_read_b64_tr_b16 v[108:109], v5 offset:32768
    ds_read_b64_tr_b16 v[110:111], v5 offset:33792
    v_mfma_f32_16x16x32_bf16 v[48:51], v[132:135], v[156:159], v[48:51]
    ds_read_b64_tr_b16 v[112:113], v6 offset:32768
    v_mfma_f32_16x16x32_bf16 v[52:55], v[132:135], v[160:163], v[52:55]
    ds_read_b64_tr_b16 v[114:115], v6 offset:33792
    v_mfma_f32_16x16x32_bf16 v[56:59], v[136:139], v[156:159], v[56:59]
    ds_read_b64_tr_b16 v[116:117], v7 offset:32768
    v_mfma_f32_16x16x32_bf16 v[60:63], v[136:139], v[160:163], v[60:63]
    ds_read_b64_tr_b16 v[118:119], v7 offset:33792
    v_mfma_f32_16x16x32_bf16 v[64:67], v[140:143], v[156:159], v[64:67]
    ds_read_b64_tr_b16 v[120:121], v8 offset:32768
    v_mfma_f32_16x16x32_bf16 v[68:71], v[140:143], v[160:163], v[68:71]
    ds_read_b64_tr_b16 v[122:123], v8 offset:33792
    v_mfma_f32_16x16x32_bf16 v[72:75], v[144:147], v[156:159], v[72:75]
    ds_read_b64_tr_b16 v[124:125], v9 offset:32768
    v_mfma_f32_16x16x32_bf16 v[76:79], v[144:147], v[160:163], v[76:79]
    ds_read_b64_tr_b16 v[126:127], v9 offset:33792
    s_cmp_eq_u32 s93, 0
    s_cbranch_scc1 k1_kernel_s_27a
    v_mfma_f32_16x16x32_bf16 v[80:83], v[156:159], v[156:159], v[80:83]
    v_mfma_f32_16x16x32_bf16 v[84:87], v[160:163], v[160:163], v[84:87]
    s_branch k1_kernel_s_27b
k1_kernel_s_27a:
    v_mfma_f32_16x16x32_bf16 v[80:83], v[156:159], v[20:23], v[80:83]
    v_mfma_f32_16x16x32_bf16 v[84:87], v[160:163], v[20:23], v[84:87]
k1_kernel_s_27b:
    s_cmp_lg_u32 s95, 3
    s_cbranch_scc1 k1_kernel_s_27c
    v_mfma_f32_16x16x32_bf16 v[88:91], v[20:23], v[128:131], v[88:91]
    v_mfma_f32_16x16x32_bf16 v[92:95], v[20:23], v[132:135], v[92:95]
    v_mfma_f32_16x16x32_bf16 v[96:99], v[20:23], v[136:139], v[96:99]
    v_mfma_f32_16x16x32_bf16 v[100:103], v[20:23], v[140:143], v[100:103]
    v_mfma_f32_16x16x32_bf16 v[104:107], v[20:23], v[144:147], v[104:107]
k1_kernel_s_27c:
    s_waitcnt lgkmcnt(0)
    v_mfma_f32_16x16x32_bf16 v[40:43], v[108:111], v[148:151], v[40:43]
    ds_read_b128 v[156:159], v16 offset:16384
    ds_read_b128 v[160:163], v16 offset:18432
    v_mfma_f32_16x16x32_bf16 v[44:47], v[108:111], v[152:155], v[44:47]
    ds_read_b64_tr_b16 v[128:129], v10 offset:0
    ds_read_b64_tr_b16 v[130:131], v10 offset:1024
    v_mfma_f32_16x16x32_bf16 v[48:51], v[112:115], v[148:151], v[48:51]
    ds_read_b64_tr_b16 v[132:133], v11 offset:0
    v_mfma_f32_16x16x32_bf16 v[52:55], v[112:115], v[152:155], v[52:55]
    ds_read_b64_tr_b16 v[134:135], v11 offset:1024
    v_mfma_f32_16x16x32_bf16 v[56:59], v[116:119], v[148:151], v[56:59]
    ds_read_b64_tr_b16 v[136:137], v12 offset:0
    v_mfma_f32_16x16x32_bf16 v[60:63], v[116:119], v[152:155], v[60:63]
    ds_read_b64_tr_b16 v[138:139], v12 offset:1024
    v_mfma_f32_16x16x32_bf16 v[64:67], v[120:123], v[148:151], v[64:67]
    ds_read_b64_tr_b16 v[140:141], v13 offset:0
    v_mfma_f32_16x16x32_bf16 v[68:71], v[120:123], v[152:155], v[68:71]
    ds_read_b64_tr_b16 v[142:143], v13 offset:1024
    v_mfma_f32_16x16x32_bf16 v[72:75], v[124:127], v[148:151], v[72:75]
    ds_read_b64_tr_b16 v[144:145], v14 offset:0
    v_mfma_f32_16x16x32_bf16 v[76:79], v[124:127], v[152:155], v[76:79]
    ds_read_b64_tr_b16 v[146:147], v14 offset:1024
    s_cmp_eq_u32 s93, 0
    s_cbranch_scc1 k1_kernel_s_28a
    v_mfma_f32_16x16x32_bf16 v[80:83], v[148:151], v[148:151], v[80:83]
    v_mfma_f32_16x16x32_bf16 v[84:87], v[152:155], v[152:155], v[84:87]
    s_branch k1_kernel_s_28b
k1_kernel_s_28a:
    v_mfma_f32_16x16x32_bf16 v[80:83], v[148:151], v[20:23], v[80:83]
    v_mfma_f32_16x16x32_bf16 v[84:87], v[152:155], v[20:23], v[84:87]
k1_kernel_s_28b:
    s_cmp_lg_u32 s95, 0
    s_cbranch_scc1 k1_kernel_s_28c
    v_mfma_f32_16x16x32_bf16 v[88:91], v[20:23], v[108:111], v[88:91]
    v_mfma_f32_16x16x32_bf16 v[92:95], v[20:23], v[112:115], v[92:95]
    v_mfma_f32_16x16x32_bf16 v[96:99], v[20:23], v[116:119], v[96:99]
    v_mfma_f32_16x16x32_bf16 v[100:103], v[20:23], v[120:123], v[100:103]
    v_mfma_f32_16x16x32_bf16 v[104:107], v[20:23], v[124:127], v[104:107]
k1_kernel_s_28c:
    s_waitcnt lgkmcnt(0)
    s_barrier
    v_mfma_f32_16x16x32_bf16 v[40:43], v[128:131], v[156:159], v[40:43]
    ds_read_b128 v[148:151], v15 offset:32768
    ds_read_b128 v[152:155], v15 offset:34816
    v_mfma_f32_16x16x32_bf16 v[44:47], v[128:131], v[160:163], v[44:47]
    ds_read_b64_tr_b16 v[108:109], v10 offset:16384
    ds_read_b64_tr_b16 v[110:111], v10 offset:17408
    v_mfma_f32_16x16x32_bf16 v[48:51], v[132:135], v[156:159], v[48:51]
    ds_read_b64_tr_b16 v[112:113], v11 offset:16384
    v_mfma_f32_16x16x32_bf16 v[52:55], v[132:135], v[160:163], v[52:55]
    ds_read_b64_tr_b16 v[114:115], v11 offset:17408
    v_mfma_f32_16x16x32_bf16 v[56:59], v[136:139], v[156:159], v[56:59]
    ds_read_b64_tr_b16 v[116:117], v12 offset:16384
    v_mfma_f32_16x16x32_bf16 v[60:63], v[136:139], v[160:163], v[60:63]
    ds_read_b64_tr_b16 v[118:119], v12 offset:17408
    v_mfma_f32_16x16x32_bf16 v[64:67], v[140:143], v[156:159], v[64:67]
    ds_read_b64_tr_b16 v[120:121], v13 offset:16384
    v_mfma_f32_16x16x32_bf16 v[68:71], v[140:143], v[160:163], v[68:71]
    ds_read_b64_tr_b16 v[122:123], v13 offset:17408
    v_mfma_f32_16x16x32_bf16 v[72:75], v[144:147], v[156:159], v[72:75]
    ds_read_b64_tr_b16 v[124:125], v14 offset:16384
    v_mfma_f32_16x16x32_bf16 v[76:79], v[144:147], v[160:163], v[76:79]
    ds_read_b64_tr_b16 v[126:127], v14 offset:17408
    s_cmp_eq_u32 s93, 0
    s_cbranch_scc1 k1_kernel_s_29a
    v_mfma_f32_16x16x32_bf16 v[80:83], v[156:159], v[156:159], v[80:83]
    v_mfma_f32_16x16x32_bf16 v[84:87], v[160:163], v[160:163], v[84:87]
    s_branch k1_kernel_s_29b
k1_kernel_s_29a:
    v_mfma_f32_16x16x32_bf16 v[80:83], v[156:159], v[20:23], v[80:83]
    v_mfma_f32_16x16x32_bf16 v[84:87], v[160:163], v[20:23], v[84:87]
k1_kernel_s_29b:
    s_cmp_lg_u32 s95, 1
    s_cbranch_scc1 k1_kernel_s_29c
    v_mfma_f32_16x16x32_bf16 v[88:91], v[20:23], v[128:131], v[88:91]
    v_mfma_f32_16x16x32_bf16 v[92:95], v[20:23], v[132:135], v[92:95]
    v_mfma_f32_16x16x32_bf16 v[96:99], v[20:23], v[136:139], v[96:99]
    v_mfma_f32_16x16x32_bf16 v[100:103], v[20:23], v[140:143], v[100:103]
    v_mfma_f32_16x16x32_bf16 v[104:107], v[20:23], v[144:147], v[104:107]
k1_kernel_s_29c:
    s_waitcnt lgkmcnt(0)
    v_mfma_f32_16x16x32_bf16 v[40:43], v[108:111], v[148:151], v[40:43]
    ds_read_b128 v[156:159], v16 offset:32768
    ds_read_b128 v[160:163], v16 offset:34816
    v_mfma_f32_16x16x32_bf16 v[44:47], v[108:111], v[152:155], v[44:47]
    ds_read_b64_tr_b16 v[128:129], v10 offset:32768
    ds_read_b64_tr_b16 v[130:131], v10 offset:33792
    v_mfma_f32_16x16x32_bf16 v[48:51], v[112:115], v[148:151], v[48:51]
    ds_read_b64_tr_b16 v[132:133], v11 offset:32768
    v_mfma_f32_16x16x32_bf16 v[52:55], v[112:115], v[152:155], v[52:55]
    ds_read_b64_tr_b16 v[134:135], v11 offset:33792
    v_mfma_f32_16x16x32_bf16 v[56:59], v[116:119], v[148:151], v[56:59]
    ds_read_b64_tr_b16 v[136:137], v12 offset:32768
    v_mfma_f32_16x16x32_bf16 v[60:63], v[116:119], v[152:155], v[60:63]
    ds_read_b64_tr_b16 v[138:139], v12 offset:33792
    v_mfma_f32_16x16x32_bf16 v[64:67], v[120:123], v[148:151], v[64:67]
    ds_read_b64_tr_b16 v[140:141], v13 offset:32768
    v_mfma_f32_16x16x32_bf16 v[68:71], v[120:123], v[152:155], v[68:71]
    ds_read_b64_tr_b16 v[142:143], v13 offset:33792
    v_mfma_f32_16x16x32_bf16 v[72:75], v[124:127], v[148:151], v[72:75]
    ds_read_b64_tr_b16 v[144:145], v14 offset:32768
    v_mfma_f32_16x16x32_bf16 v[76:79], v[124:127], v[152:155], v[76:79]
    ds_read_b64_tr_b16 v[146:147], v14 offset:33792
    s_cmp_eq_u32 s93, 0
    s_cbranch_scc1 k1_kernel_s_30a
    v_mfma_f32_16x16x32_bf16 v[80:83], v[148:151], v[148:151], v[80:83]
    v_mfma_f32_16x16x32_bf16 v[84:87], v[152:155], v[152:155], v[84:87]
    s_branch k1_kernel_s_30b
k1_kernel_s_30a:
    v_mfma_f32_16x16x32_bf16 v[80:83], v[148:151], v[20:23], v[80:83]
    v_mfma_f32_16x16x32_bf16 v[84:87], v[152:155], v[20:23], v[84:87]
k1_kernel_s_30b:
    s_cmp_lg_u32 s95, 2
    s_cbranch_scc1 k1_kernel_s_30c
    v_mfma_f32_16x16x32_bf16 v[88:91], v[20:23], v[108:111], v[88:91]
    v_mfma_f32_16x16x32_bf16 v[92:95], v[20:23], v[112:115], v[92:95]
    v_mfma_f32_16x16x32_bf16 v[96:99], v[20:23], v[116:119], v[96:99]
    v_mfma_f32_16x16x32_bf16 v[100:103], v[20:23], v[120:123], v[100:103]
    v_mfma_f32_16x16x32_bf16 v[104:107], v[20:23], v[124:127], v[104:107]
k1_kernel_s_30c:
    s_waitcnt lgkmcnt(0)
    s_barrier
    v_mfma_f32_16x16x32_bf16 v[40:43], v[128:131], v[156:159], v[40:43]
    ds_read_b128 v[148:151], v15 offset:0
    ds_read_b128 v[152:155], v15 offset:2048
    v_mfma_f32_16x16x32_bf16 v[44:47], v[128:131], v[160:163], v[44:47]
    ds_read_b64_tr_b16 v[108:109], v5 offset:0
    ds_read_b64_tr_b16 v[110:111], v5 offset:1024
    v_mfma_f32_16x16x32_bf16 v[48:51], v[132:135], v[156:159], v[48:51]
    ds_read_b64_tr_b16 v[112:113], v6 offset:0
    v_mfma_f32_16x16x32_bf16 v[52:55], v[132:135], v[160:163], v[52:55]
    ds_read_b64_tr_b16 v[114:115], v6 offset:1024
    v_mfma_f32_16x16x32_bf16 v[56:59], v[136:139], v[156:159], v[56:59]
    ds_read_b64_tr_b16 v[116:117], v7 offset:0
    v_mfma_f32_16x16x32_bf16 v[60:63], v[136:139], v[160:163], v[60:63]
    ds_read_b64_tr_b16 v[118:119], v7 offset:1024
    v_mfma_f32_16x16x32_bf16 v[64:67], v[140:143], v[156:159], v[64:67]
    ds_read_b64_tr_b16 v[120:121], v8 offset:0
    v_mfma_f32_16x16x32_bf16 v[68:71], v[140:143], v[160:163], v[68:71]
    ds_read_b64_tr_b16 v[122:123], v8 offset:1024
    v_mfma_f32_16x16x32_bf16 v[72:75], v[144:147], v[156:159], v[72:75]
    ds_read_b64_tr_b16 v[124:125], v9 offset:0
    v_mfma_f32_16x16x32_bf16 v[76:79], v[144:147], v[160:163], v[76:79]
    ds_read_b64_tr_b16 v[126:127], v9 offset:1024
    s_cmp_eq_u32 s93, 0
    s_cbranch_scc1 k1_kernel_s_31a
    v_mfma_f32_16x16x32_bf16 v[80:83], v[156:159], v[156:159], v[80:83]
    v_mfma_f32_16x16x32_bf16 v[84:87], v[160:163], v[160:163], v[84:87]
    s_branch k1_kernel_s_31b
k1_kernel_s_31a:
    v_mfma_f32_16x16x32_bf16 v[80:83], v[156:159], v[20:23], v[80:83]
    v_mfma_f32_16x16x32_bf16 v[84:87], v[160:163], v[20:23], v[84:87]
k1_kernel_s_31b:
    s_cmp_lg_u32 s95, 3
    s_cbranch_scc1 k1_kernel_s_31c
    v_mfma_f32_16x16x32_bf16 v[88:91], v[20:23], v[128:131], v[88:91]
    v_mfma_f32_16x16x32_bf16 v[92:95], v[20:23], v[132:135], v[92:95]
    v_mfma_f32_16x16x32_bf16 v[96:99], v[20:23], v[136:139], v[96:99]
    v_mfma_f32_16x16x32_bf16 v[100:103], v[20:23], v[140:143], v[100:103]
    v_mfma_f32_16x16x32_bf16 v[104:107], v[20:23], v[144:147], v[104:107]
k1_kernel_s_31c:
    s_waitcnt lgkmcnt(0)
    v_mfma_f32_16x16x32_bf16 v[40:43], v[108:111], v[148:151], v[40:43]
    ds_read_b128 v[156:159], v16 offset:0
    ds_read_b128 v[160:163], v16 offset:2048
    v_mfma_f32_16x16x32_bf16 v[44:47], v[108:111], v[152:155], v[44:47]
    ds_read_b64_tr_b16 v[128:129], v5 offset:16384
    ds_read_b64_tr_b16 v[130:131], v5 offset:17408
    v_mfma_f32_16x16x32_bf16 v[48:51], v[112:115], v[148:151], v[48:51]
    ds_read_b64_tr_b16 v[132:133], v6 offset:16384
    v_mfma_f32_16x16x32_bf16 v[52:55], v[112:115], v[152:155], v[52:55]
    ds_read_b64_tr_b16 v[134:135], v6 offset:17408
    v_mfma_f32_16x16x32_bf16 v[56:59], v[116:119], v[148:151], v[56:59]
    ds_read_b64_tr_b16 v[136:137], v7 offset:16384
    v_mfma_f32_16x16x32_bf16 v[60:63], v[116:119], v[152:155], v[60:63]
    ds_read_b64_tr_b16 v[138:139], v7 offset:17408
    v_mfma_f32_16x16x32_bf16 v[64:67], v[120:123], v[148:151], v[64:67]
    ds_read_b64_tr_b16 v[140:141], v8 offset:16384
    v_mfma_f32_16x16x32_bf16 v[68:71], v[120:123], v[152:155], v[68:71]
    ds_read_b64_tr_b16 v[142:143], v8 offset:17408
    v_mfma_f32_16x16x32_bf16 v[72:75], v[124:127], v[148:151], v[72:75]
    ds_read_b64_tr_b16 v[144:145], v9 offset:16384
    v_mfma_f32_16x16x32_bf16 v[76:79], v[124:127], v[152:155], v[76:79]
    ds_read_b64_tr_b16 v[146:147], v9 offset:17408
    s_cmp_eq_u32 s93, 0
    s_cbranch_scc1 k1_kernel_s_32a
    v_mfma_f32_16x16x32_bf16 v[80:83], v[148:151], v[148:151], v[80:83]
    v_mfma_f32_16x16x32_bf16 v[84:87], v[152:155], v[152:155], v[84:87]
    s_branch k1_kernel_s_32b
k1_kernel_s_32a:
    v_mfma_f32_16x16x32_bf16 v[80:83], v[148:151], v[20:23], v[80:83]
    v_mfma_f32_16x16x32_bf16 v[84:87], v[152:155], v[20:23], v[84:87]
k1_kernel_s_32b:
    s_cmp_lg_u32 s95, 0
    s_cbranch_scc1 k1_kernel_s_32c
    v_mfma_f32_16x16x32_bf16 v[88:91], v[20:23], v[108:111], v[88:91]
    v_mfma_f32_16x16x32_bf16 v[92:95], v[20:23], v[112:115], v[92:95]
    v_mfma_f32_16x16x32_bf16 v[96:99], v[20:23], v[116:119], v[96:99]
    v_mfma_f32_16x16x32_bf16 v[100:103], v[20:23], v[120:123], v[100:103]
    v_mfma_f32_16x16x32_bf16 v[104:107], v[20:23], v[124:127], v[104:107]
k1_kernel_s_32c:
    s_waitcnt lgkmcnt(0)
    s_barrier
    v_mfma_f32_16x16x32_bf16 v[40:43], v[128:131], v[156:159], v[40:43]
    ds_read_b128 v[148:151], v15 offset:16384
    ds_read_b128 v[152:155], v15 offset:18432
    v_mfma_f32_16x16x32_bf16 v[44:47], v[128:131], v[160:163], v[44:47]
    ds_read_b64_tr_b16 v[108:109], v5 offset:32768
    ds_read_b64_tr_b16 v[110:111], v5 offset:33792
    v_mfma_f32_16x16x32_bf16 v[48:51], v[132:135], v[156:159], v[48:51]
    ds_read_b64_tr_b16 v[112:113], v6 offset:32768
    v_mfma_f32_16x16x32_bf16 v[52:55], v[132:135], v[160:163], v[52:55]
    ds_read_b64_tr_b16 v[114:115], v6 offset:33792
    v_mfma_f32_16x16x32_bf16 v[56:59], v[136:139], v[156:159], v[56:59]
    ds_read_b64_tr_b16 v[116:117], v7 offset:32768
    v_mfma_f32_16x16x32_bf16 v[60:63], v[136:139], v[160:163], v[60:63]
    ds_read_b64_tr_b16 v[118:119], v7 offset:33792
    v_mfma_f32_16x16x32_bf16 v[64:67], v[140:143], v[156:159], v[64:67]
    ds_read_b64_tr_b16 v[120:121], v8 offset:32768
    v_mfma_f32_16x16x32_bf16 v[68:71], v[140:143], v[160:163], v[68:71]
    ds_read_b64_tr_b16 v[122:123], v8 offset:33792
    v_mfma_f32_16x16x32_bf16 v[72:75], v[144:147], v[156:159], v[72:75]
    ds_read_b64_tr_b16 v[124:125], v9 offset:32768
    v_mfma_f32_16x16x32_bf16 v[76:79], v[144:147], v[160:163], v[76:79]
    ds_read_b64_tr_b16 v[126:127], v9 offset:33792
    s_cmp_eq_u32 s93, 0
    s_cbranch_scc1 k1_kernel_s_33a
    v_mfma_f32_16x16x32_bf16 v[80:83], v[156:159], v[156:159], v[80:83]
    v_mfma_f32_16x16x32_bf16 v[84:87], v[160:163], v[160:163], v[84:87]
    s_branch k1_kernel_s_33b
k1_kernel_s_33a:
    v_mfma_f32_16x16x32_bf16 v[80:83], v[156:159], v[20:23], v[80:83]
    v_mfma_f32_16x16x32_bf16 v[84:87], v[160:163], v[20:23], v[84:87]
k1_kernel_s_33b:
    s_cmp_lg_u32 s95, 1
    s_cbranch_scc1 k1_kernel_s_33c
    v_mfma_f32_16x16x32_bf16 v[88:91], v[20:23], v[128:131], v[88:91]
    v_mfma_f32_16x16x32_bf16 v[92:95], v[20:23], v[132:135], v[92:95]
    v_mfma_f32_16x16x32_bf16 v[96:99], v[20:23], v[136:139], v[96:99]
    v_mfma_f32_16x16x32_bf16 v[100:103], v[20:23], v[140:143], v[100:103]
    v_mfma_f32_16x16x32_bf16 v[104:107], v[20:23], v[144:147], v[104:107]
k1_kernel_s_33c:
    s_waitcnt lgkmcnt(0)
    v_mfma_f32_16x16x32_bf16 v[40:43], v[108:111], v[148:151], v[40:43]
    ds_read_b128 v[156:159], v16 offset:16384
    ds_read_b128 v[160:163], v16 offset:18432
    v_mfma_f32_16x16x32_bf16 v[44:47], v[108:111], v[152:155], v[44:47]
    ds_read_b64_tr_b16 v[128:129], v10 offset:0
    ds_read_b64_tr_b16 v[130:131], v10 offset:1024
    v_mfma_f32_16x16x32_bf16 v[48:51], v[112:115], v[148:151], v[48:51]
    ds_read_b64_tr_b16 v[132:133], v11 offset:0
    v_mfma_f32_16x16x32_bf16 v[52:55], v[112:115], v[152:155], v[52:55]
    ds_read_b64_tr_b16 v[134:135], v11 offset:1024
    v_mfma_f32_16x16x32_bf16 v[56:59], v[116:119], v[148:151], v[56:59]
    ds_read_b64_tr_b16 v[136:137], v12 offset:0
    v_mfma_f32_16x16x32_bf16 v[60:63], v[116:119], v[152:155], v[60:63]
    ds_read_b64_tr_b16 v[138:139], v12 offset:1024
    v_mfma_f32_16x16x32_bf16 v[64:67], v[120:123], v[148:151], v[64:67]
    ds_read_b64_tr_b16 v[140:141], v13 offset:0
    v_mfma_f32_16x16x32_bf16 v[68:71], v[120:123], v[152:155], v[68:71]
    ds_read_b64_tr_b16 v[142:143], v13 offset:1024
    v_mfma_f32_16x16x32_bf16 v[72:75], v[124:127], v[148:151], v[72:75]
    ds_read_b64_tr_b16 v[144:145], v14 offset:0
    v_mfma_f32_16x16x32_bf16 v[76:79], v[124:127], v[152:155], v[76:79]
    ds_read_b64_tr_b16 v[146:147], v14 offset:1024
    s_cmp_eq_u32 s93, 0
    s_cbranch_scc1 k1_kernel_s_34a
    v_mfma_f32_16x16x32_bf16 v[80:83], v[148:151], v[148:151], v[80:83]
    v_mfma_f32_16x16x32_bf16 v[84:87], v[152:155], v[152:155], v[84:87]
    s_branch k1_kernel_s_34b
k1_kernel_s_34a:
    v_mfma_f32_16x16x32_bf16 v[80:83], v[148:151], v[20:23], v[80:83]
    v_mfma_f32_16x16x32_bf16 v[84:87], v[152:155], v[20:23], v[84:87]
k1_kernel_s_34b:
    s_cmp_lg_u32 s95, 2
    s_cbranch_scc1 k1_kernel_s_34c
    v_mfma_f32_16x16x32_bf16 v[88:91], v[20:23], v[108:111], v[88:91]
    v_mfma_f32_16x16x32_bf16 v[92:95], v[20:23], v[112:115], v[92:95]
    v_mfma_f32_16x16x32_bf16 v[96:99], v[20:23], v[116:119], v[96:99]
    v_mfma_f32_16x16x32_bf16 v[100:103], v[20:23], v[120:123], v[100:103]
    v_mfma_f32_16x16x32_bf16 v[104:107], v[20:23], v[124:127], v[104:107]
k1_kernel_s_34c:
    s_waitcnt lgkmcnt(0)
    s_barrier
    v_mfma_f32_16x16x32_bf16 v[40:43], v[128:131], v[156:159], v[40:43]
    ds_read_b128 v[148:151], v15 offset:32768
    ds_read_b128 v[152:155], v15 offset:34816
    v_mfma_f32_16x16x32_bf16 v[44:47], v[128:131], v[160:163], v[44:47]
    ds_read_b64_tr_b16 v[108:109], v10 offset:16384
    ds_read_b64_tr_b16 v[110:111], v10 offset:17408
    v_mfma_f32_16x16x32_bf16 v[48:51], v[132:135], v[156:159], v[48:51]
    ds_read_b64_tr_b16 v[112:113], v11 offset:16384
    v_mfma_f32_16x16x32_bf16 v[52:55], v[132:135], v[160:163], v[52:55]
    ds_read_b64_tr_b16 v[114:115], v11 offset:17408
    v_mfma_f32_16x16x32_bf16 v[56:59], v[136:139], v[156:159], v[56:59]
    ds_read_b64_tr_b16 v[116:117], v12 offset:16384
    v_mfma_f32_16x16x32_bf16 v[60:63], v[136:139], v[160:163], v[60:63]
    ds_read_b64_tr_b16 v[118:119], v12 offset:17408
    v_mfma_f32_16x16x32_bf16 v[64:67], v[140:143], v[156:159], v[64:67]
    ds_read_b64_tr_b16 v[120:121], v13 offset:16384
    v_mfma_f32_16x16x32_bf16 v[68:71], v[140:143], v[160:163], v[68:71]
    ds_read_b64_tr_b16 v[122:123], v13 offset:17408
    v_mfma_f32_16x16x32_bf16 v[72:75], v[144:147], v[156:159], v[72:75]
    ds_read_b64_tr_b16 v[124:125], v14 offset:16384
    v_mfma_f32_16x16x32_bf16 v[76:79], v[144:147], v[160:163], v[76:79]
    ds_read_b64_tr_b16 v[126:127], v14 offset:17408
    s_cmp_eq_u32 s93, 0
    s_cbranch_scc1 k1_kernel_s_35a
    v_mfma_f32_16x16x32_bf16 v[80:83], v[156:159], v[156:159], v[80:83]
    v_mfma_f32_16x16x32_bf16 v[84:87], v[160:163], v[160:163], v[84:87]
    s_branch k1_kernel_s_35b
k1_kernel_s_35a:
    v_mfma_f32_16x16x32_bf16 v[80:83], v[156:159], v[20:23], v[80:83]
    v_mfma_f32_16x16x32_bf16 v[84:87], v[160:163], v[20:23], v[84:87]
k1_kernel_s_35b:
    s_cmp_lg_u32 s95, 3
    s_cbranch_scc1 k1_kernel_s_35c
    v_mfma_f32_16x16x32_bf16 v[88:91], v[20:23], v[128:131], v[88:91]
    v_mfma_f32_16x16x32_bf16 v[92:95], v[20:23], v[132:135], v[92:95]
    v_mfma_f32_16x16x32_bf16 v[96:99], v[20:23], v[136:139], v[96:99]
    v_mfma_f32_16x16x32_bf16 v[100:103], v[20:23], v[140:143], v[100:103]
    v_mfma_f32_16x16x32_bf16 v[104:107], v[20:23], v[144:147], v[104:107]
k1_kernel_s_35c:
    s_waitcnt lgkmcnt(0)
    v_mfma_f32_16x16x32_bf16 v[40:43], v[108:111], v[148:151], v[40:43]
    ds_read_b128 v[156:159], v16 offset:32768
    ds_read_b128 v[160:163], v16 offset:34816
    v_mfma_f32_16x16x32_bf16 v[44:47], v[108:111], v[152:155], v[44:47]
    ds_read_b64_tr_b16 v[128:129], v10 offset:32768
    ds_read_b64_tr_b16 v[130:131], v10 offset:33792
    v_mfma_f32_16x16x32_bf16 v[48:51], v[112:115], v[148:151], v[48:51]
    ds_read_b64_tr_b16 v[132:133], v11 offset:32768
    v_mfma_f32_16x16x32_bf16 v[52:55], v[112:115], v[152:155], v[52:55]
    ds_read_b64_tr_b16 v[134:135], v11 offset:33792
    v_mfma_f32_16x16x32_bf16 v[56:59], v[116:119], v[148:151], v[56:59]
    ds_read_b64_tr_b16 v[136:137], v12 offset:32768
    v_mfma_f32_16x16x32_bf16 v[60:63], v[116:119], v[152:155], v[60:63]
    ds_read_b64_tr_b16 v[138:139], v12 offset:33792
    v_mfma_f32_16x16x32_bf16 v[64:67], v[120:123], v[148:151], v[64:67]
    ds_read_b64_tr_b16 v[140:141], v13 offset:32768
    v_mfma_f32_16x16x32_bf16 v[68:71], v[120:123], v[152:155], v[68:71]
    ds_read_b64_tr_b16 v[142:143], v13 offset:33792
    v_mfma_f32_16x16x32_bf16 v[72:75], v[124:127], v[148:151], v[72:75]
    ds_read_b64_tr_b16 v[144:145], v14 offset:32768
    v_mfma_f32_16x16x32_bf16 v[76:79], v[124:127], v[152:155], v[76:79]
    ds_read_b64_tr_b16 v[146:147], v14 offset:33792
    s_cmp_eq_u32 s93, 0
    s_cbranch_scc1 k1_kernel_s_36a
    v_mfma_f32_16x16x32_bf16 v[80:83], v[148:151], v[148:151], v[80:83]
    v_mfma_f32_16x16x32_bf16 v[84:87], v[152:155], v[152:155], v[84:87]
    s_branch k1_kernel_s_36b
k1_kernel_s_36a:
    v_mfma_f32_16x16x32_bf16 v[80:83], v[148:151], v[20:23], v[80:83]
    v_mfma_f32_16x16x32_bf16 v[84:87], v[152:155], v[20:23], v[84:87]
k1_kernel_s_36b:
    s_cmp_lg_u32 s95, 0
    s_cbranch_scc1 k1_kernel_s_36c
    v_mfma_f32_16x16x32_bf16 v[88:91], v[20:23], v[108:111], v[88:91]
    v_mfma_f32_16x16x32_bf16 v[92:95], v[20:23], v[112:115], v[92:95]
    v_mfma_f32_16x16x32_bf16 v[96:99], v[20:23], v[116:119], v[96:99]
    v_mfma_f32_16x16x32_bf16 v[100:103], v[20:23], v[120:123], v[100:103]
    v_mfma_f32_16x16x32_bf16 v[104:107], v[20:23], v[124:127], v[104:107]
k1_kernel_s_36c:
    s_waitcnt lgkmcnt(0)
    v_mfma_f32_16x16x32_bf16 v[40:43], v[128:131], v[156:159], v[40:43]
    v_mfma_f32_16x16x32_bf16 v[44:47], v[128:131], v[160:163], v[44:47]
    v_mfma_f32_16x16x32_bf16 v[48:51], v[132:135], v[156:159], v[48:51]
    v_mfma_f32_16x16x32_bf16 v[52:55], v[132:135], v[160:163], v[52:55]
    v_mfma_f32_16x16x32_bf16 v[56:59], v[136:139], v[156:159], v[56:59]
    v_mfma_f32_16x16x32_bf16 v[60:63], v[136:139], v[160:163], v[60:63]
    v_mfma_f32_16x16x32_bf16 v[64:67], v[140:143], v[156:159], v[64:67]
    v_mfma_f32_16x16x32_bf16 v[68:71], v[140:143], v[160:163], v[68:71]
    v_mfma_f32_16x16x32_bf16 v[72:75], v[144:147], v[156:159], v[72:75]
    v_mfma_f32_16x16x32_bf16 v[76:79], v[144:147], v[160:163], v[76:79]
    s_cmp_eq_u32 s93, 0
    s_cbranch_scc1 k1_kernel_s_37a
    v_mfma_f32_16x16x32_bf16 v[80:83], v[156:159], v[156:159], v[80:83]
    v_mfma_f32_16x16x32_bf16 v[84:87], v[160:163], v[160:163], v[84:87]
    s_branch k1_kernel_s_37b
k1_kernel_s_37a:
    v_mfma_f32_16x16x32_bf16 v[80:83], v[156:159], v[20:23], v[80:83]
    v_mfma_f32_16x16x32_bf16 v[84:87], v[160:163], v[20:23], v[84:87]
k1_kernel_s_37b:
    s_cmp_lg_u32 s95, 1
    s_cbranch_scc1 k1_kernel_s_37c
    v_mfma_f32_16x16x32_bf16 v[88:91], v[20:23], v[128:131], v[88:91]
    v_mfma_f32_16x16x32_bf16 v[92:95], v[20:23], v[132:135], v[92:95]
    v_mfma_f32_16x16x32_bf16 v[96:99], v[20:23], v[136:139], v[96:99]
    v_mfma_f32_16x16x32_bf16 v[100:103], v[20:23], v[140:143], v[100:103]
    v_mfma_f32_16x16x32_bf16 v[104:107], v[20:23], v[144:147], v[104:107]
k1_kernel_s_37c:
    s_barrier
    v_and_b32 v25, 15, v0
    v_lshrrev_b32 v26, 4, v0
    s_mul_i32 s36, s93, 1280
    s_lshl_b32 s37, s92, 2
    s_add_u32 s37, s37, s36
    v_lshl_add_u32 v24, v25, 4, s37
    v_lshl_add_u32 v27, v25, 4, s36
    v_and_b32 v28, 3, v0
    v_cmp_eq_u32 s[84:85], 1, v28
    v_cmp_eq_u32 s[86:87], 2, v28
    v_cmp_eq_u32 s[88:89], 3, v28
    s_lshl_b32 s36, s92, 7
    s_cmp_eq_u32 s93, 0
    s_cbranch_scc1 k1_kernel_x_38a
    v_bfe_u32 v28, v0, 2, 2
    v_cmp_eq_u32 vcc, v28, v26
    s_add_u32 s37, s36, 4608
    v_lshl_add_u32 v28, v25, 2, s37
    v_mov_b32 v29, 6144
    v_cndmask_b32 v80, v80, v81, s[84:85]
    v_cndmask_b32 v80, v80, v82, s[86:87]
    v_cndmask_b32 v80, v80, v83, s[88:89]
    v_cndmask_b32 v84, v84, v85, s[84:85]
    v_cndmask_b32 v84, v84, v86, s[86:87]
    v_cndmask_b32 v84, v84, v87, s[88:89]
    v_cndmask_b32 v28, v29, v28, vcc
    ds_write_b32 v28, v80 offset:0
    ds_write_b32 v28, v84 offset:64
    s_branch k1_kernel_x_38b
k1_kernel_x_38a:
    s_add_u32 s37, s36, 4096
    v_lshl_add_u32 v28, v26, 4, s37
    ds_write_b128 v28, v[80:83] offset:0
    ds_write_b128 v28, v[84:87] offset:64
k1_kernel_x_38b:
    ds_write_b32 v24, v88 offset:0
    ds_write_b32 v24, v92 offset:256
    ds_write_b32 v24, v96 offset:512
    ds_write_b32 v24, v100 offset:768
    ds_write_b32 v24, v104 offset:1024
    s_waitcnt lgkmcnt(0)
    s_barrier
    ds_read_b128 v[108:111], v27 offset:0
    ds_read_b128 v[112:115], v27 offset:256
    ds_read_b128 v[116:119], v27 offset:512
    ds_read_b128 v[120:123], v27 offset:768
    ds_read_b128 v[124:127], v27 offset:1024
    v_lshl_add_u32 v28, v25, 2, s36
    ds_read_b32 v148, v28 offset:4096
    ds_read_b32 v150, v28 offset:4608
    ds_read_b32 v149, v28 offset:4160
    ds_read_b32 v151, v28 offset:4672
    s_waitcnt lgkmcnt(4)
    v_add_f32 v108, v108, v109
    v_add_f32 v110, v110, v111
    v_add_f32 v112, v112, v113
    v_add_f32 v114, v114, v115
    v_add_f32 v116, v116, v117
    v_add_f32 v118, v118, v119
    v_add_f32 v120, v120, v121
    v_add_f32 v122, v122, v123
    v_add_f32 v124, v124, v125
    v_add_f32 v126, v126, v127
    v_add_f32 v128, v108, v110
    v_add_f32 v129, v112, v114
    v_add_f32 v130, v116, v118
    v_add_f32 v131, v120, v122
    v_add_f32 v132, v124, v126
    s_lshl_b32 s38, s32, 9
    s_add_u32 s38, s38, 8192
    v_lshl_add_u32 v24, v25, 2, s38
    ds_write_b32 v24, v128 offset:0
    ds_write_b32 v24, v129 offset:64
    ds_write_b32 v24, v130 offset:128
    ds_write_b32 v24, v131 offset:192
    ds_write_b32 v24, v132 offset:256
    v_lshl_add_u32 v24, v26, 4, s38
    s_waitcnt lgkmcnt(0)
    ds_read_b128 v[88:91], v24 offset:0
    ds_read_b128 v[92:95], v24 offset:64
    ds_read_b128 v[96:99], v24 offset:128
    ds_read_b128 v[100:103], v24 offset:192
    ds_read_b128 v[104:107], v24 offset:256
    v_mul_f32 v161, v32, v148
    v_mul_f32 v162, v32, v149
    v_fma_f32 v150, v150, v37, v33
    v_fma_f32 v151, v151, v37, v33
    v_fma_f32 v150, -v161, v161, v150
    v_fma_f32 v151, -v162, v162, v151
    v_max_f32 v150, v150, v33
    v_max_f32 v151, v151, v33
    v_rsq_f32 v153, v150
    v_rsq_f32 v154, v151
    s_nop 0
    v_mul_f32 v157, v34, v153
    v_mul_f32 v158, v34, v154
    v_mul_f32 v148, v37, v148
    v_mul_f32 v149, v37, v149
    s_add_u32 s20, s4, 2424832
    s_addc_u32 s21, s5, 0
    s_mov_b32 s22, 8192
    s_mov_b32 s23, 0x20000
    s_or_b32 s36, s7, s93
    s_cmp_eq_u32 s36, 0
    s_cselect_b32 s36, 0, 0x100000
    s_lshl_b32 s37, s6, 9
    s_add_u32 s36, s36, s37
    s_lshl_b32 s37, s92, 7
    s_add_u32 s36, s36, s37
    v_lshl_add_u32 v18, v25, 2, s36
    buffer_store_dword v148, v18, s[20:23], 0 offen offset:0 sc1
    buffer_store_dword v149, v18, s[20:23], 0 offen offset:64 sc1
    s_add_u32 s24, s4, 2621440
    s_addc_u32 s25, s5, 0
    s_mov_b32 s26, 3145728
    s_mov_b32 s27, 0x20000
    s_lshl_b32 s38, s6, 3
    s_lshl_b32 s39, s92, 1
    s_add_u32 s38, s38, s39
    s_lshl_b32 s38, s38, 3
    s_lshl_b32 s39, s7, 1
    s_add_u32 s38, s38, s39
    s_add_u32 s38, s38, s93
    s_mul_i32 s38, s38, 3072
    v_lshl_add_u32 v17, v0, 4, s38
    s_movk_i32 s39, 24576
    s_waitcnt lgkmcnt(0)
    v_fmac_f32 v40, v88, v161
    v_fmac_f32 v41, v89, v161
    v_fmac_f32 v42, v90, v161
    v_fmac_f32 v43, v91, v161
    v_fmac_f32 v44, v88, v162
    v_fmac_f32 v45, v89, v162
    v_fmac_f32 v46, v90, v162
    v_fmac_f32 v47, v91, v162
    v_fmac_f32 v48, v92, v161
    v_fmac_f32 v49, v93, v161
    v_fmac_f32 v50, v94, v161
    v_fmac_f32 v51, v95, v161
    v_fmac_f32 v52, v92, v162
    v_fmac_f32 v53, v93, v162
    v_fmac_f32 v54, v94, v162
    v_fmac_f32 v55, v95, v162
    v_fmac_f32 v56, v96, v161
    v_fmac_f32 v57, v97, v161
    v_fmac_f32 v58, v98, v161
    v_fmac_f32 v59, v99, v161
    v_fmac_f32 v60, v96, v162
    v_fmac_f32 v61, v97, v162
    v_fmac_f32 v62, v98, v162
    v_fmac_f32 v63, v99, v162
    v_fmac_f32 v64, v100, v161
    v_fmac_f32 v65, v101, v161
    v_fmac_f32 v66, v102, v161
    v_fmac_f32 v67, v103, v161
    v_fmac_f32 v68, v100, v162
    v_fmac_f32 v69, v101, v162
    v_fmac_f32 v70, v102, v162
    v_fmac_f32 v71, v103, v162
    v_fmac_f32 v72, v104, v161
    v_fmac_f32 v73, v105, v161
    v_fmac_f32 v74, v106, v161
    v_fmac_f32 v75, v107, v161
    v_fmac_f32 v76, v104, v162
    v_fmac_f32 v77, v105, v162
    v_fmac_f32 v78, v106, v162
    v_fmac_f32 v79, v107, v162
    v_mul_f32 v24, v40, v157
    v_mul_f32 v25, v41, v157
    v_mul_f32 v26, v42, v157
    v_mul_f32 v27, v43, v157
    v_mul_f32 v28, v44, v158
    v_mul_f32 v29, v45, v158
    v_mul_f32 v30, v46, v158
    v_mul_f32 v31, v47, v158
    v_exp_f32_e64 v24, v24 clamp
    v_exp_f32_e64 v25, v25 clamp
    v_exp_f32_e64 v26, v26 clamp
    v_exp_f32_e64 v27, v27 clamp
    v_exp_f32_e64 v28, v28 clamp
    v_exp_f32_e64 v29, v29 clamp
    v_exp_f32_e64 v30, v30 clamp
    v_exp_f32_e64 v31, v31 clamp
    v_fma_f32 v40, v40, v153, v35
    v_fma_f32 v41, v41, v153, v35
    v_fma_f32 v42, v42, v153, v35
    v_fma_f32 v43, v43, v153, v35
    v_fma_f32 v44, v44, v154, v35
    v_fma_f32 v45, v45, v154, v35
    v_fma_f32 v46, v46, v154, v35
    v_fma_f32 v47, v47, v154, v35
    v_add_f32 v24, v24, v36
    v_add_f32 v25, v25, v36
    v_add_f32 v26, v26, v36
    v_add_f32 v27, v27, v36
    v_add_f32 v28, v28, v36
    v_add_f32 v29, v29, v36
    v_add_f32 v30, v30, v36
    v_add_f32 v31, v31, v36
    v_max_f32 v40, v40, v24
    v_max_f32 v41, v41, v25
    v_max_f32 v42, v42, v26
    v_max_f32 v43, v43, v27
    v_max_f32 v44, v44, v28
    v_max_f32 v45, v45, v29
    v_max_f32 v46, v46, v30
    v_max_f32 v47, v47, v31
    v_mul_f32 v24, v48, v157
    v_mul_f32 v25, v49, v157
    v_mul_f32 v26, v50, v157
    v_mul_f32 v27, v51, v157
    v_mul_f32 v28, v52, v158
    v_mul_f32 v29, v53, v158
    v_mul_f32 v30, v54, v158
    v_mul_f32 v31, v55, v158
    v_exp_f32_e64 v24, v24 clamp
    v_exp_f32_e64 v25, v25 clamp
    v_exp_f32_e64 v26, v26 clamp
    v_exp_f32_e64 v27, v27 clamp
    v_exp_f32_e64 v28, v28 clamp
    v_exp_f32_e64 v29, v29 clamp
    v_exp_f32_e64 v30, v30 clamp
    v_exp_f32_e64 v31, v31 clamp
    v_fma_f32 v48, v48, v153, v35
    v_fma_f32 v49, v49, v153, v35
    v_fma_f32 v50, v50, v153, v35
    v_fma_f32 v51, v51, v153, v35
    v_fma_f32 v52, v52, v154, v35
    v_fma_f32 v53, v53, v154, v35
    v_fma_f32 v54, v54, v154, v35
    v_fma_f32 v55, v55, v154, v35
    v_add_f32 v24, v24, v36
    v_add_f32 v25, v25, v36
    v_add_f32 v26, v26, v36
    v_add_f32 v27, v27, v36
    v_add_f32 v28, v28, v36
    v_add_f32 v29, v29, v36
    v_add_f32 v30, v30, v36
    v_add_f32 v31, v31, v36
    v_max_f32 v48, v48, v24
    v_max_f32 v49, v49, v25
    v_max_f32 v50, v50, v26
    v_max_f32 v51, v51, v27
    v_max_f32 v52, v52, v28
    v_max_f32 v53, v53, v29
    v_max_f32 v54, v54, v30
    v_max_f32 v55, v55, v31
    v_mul_f32 v24, v56, v157
    v_mul_f32 v25, v57, v157
    v_mul_f32 v26, v58, v157
    v_mul_f32 v27, v59, v157
    v_mul_f32 v28, v60, v158
    v_mul_f32 v29, v61, v158
    v_mul_f32 v30, v62, v158
    v_mul_f32 v31, v63, v158
    v_exp_f32_e64 v24, v24 clamp
    v_exp_f32_e64 v25, v25 clamp
    v_exp_f32_e64 v26, v26 clamp
    v_exp_f32_e64 v27, v27 clamp
    v_exp_f32_e64 v28, v28 clamp
    v_exp_f32_e64 v29, v29 clamp
    v_exp_f32_e64 v30, v30 clamp
    v_exp_f32_e64 v31, v31 clamp
    v_fma_f32 v56, v56, v153, v35
    v_fma_f32 v57, v57, v153, v35
    v_fma_f32 v58, v58, v153, v35
    v_fma_f32 v59, v59, v153, v35
    v_fma_f32 v60, v60, v154, v35
    v_fma_f32 v61, v61, v154, v35
    v_fma_f32 v62, v62, v154, v35
    v_fma_f32 v63, v63, v154, v35
    v_add_f32 v24, v24, v36
    v_add_f32 v25, v25, v36
    v_add_f32 v26, v26, v36
    v_add_f32 v27, v27, v36
    v_add_f32 v28, v28, v36
    v_add_f32 v29, v29, v36
    v_add_f32 v30, v30, v36
    v_add_f32 v31, v31, v36
    v_max_f32 v56, v56, v24
    v_max_f32 v57, v57, v25
    v_max_f32 v58, v58, v26
    v_max_f32 v59, v59, v27
    v_max_f32 v60, v60, v28
    v_max_f32 v61, v61, v29
    v_max_f32 v62, v62, v30
    v_max_f32 v63, v63, v31
    v_mul_f32 v24, v64, v157
    v_mul_f32 v25, v65, v157
    v_mul_f32 v26, v66, v157
    v_mul_f32 v27, v67, v157
    v_mul_f32 v28, v68, v158
    v_mul_f32 v29, v69, v158
    v_mul_f32 v30, v70, v158
    v_mul_f32 v31, v71, v158
    v_exp_f32_e64 v24, v24 clamp
    v_exp_f32_e64 v25, v25 clamp
    v_exp_f32_e64 v26, v26 clamp
    v_exp_f32_e64 v27, v27 clamp
    v_exp_f32_e64 v28, v28 clamp
    v_exp_f32_e64 v29, v29 clamp
    v_exp_f32_e64 v30, v30 clamp
    v_exp_f32_e64 v31, v31 clamp
    v_fma_f32 v64, v64, v153, v35
    v_fma_f32 v65, v65, v153, v35
    v_fma_f32 v66, v66, v153, v35
    v_fma_f32 v67, v67, v153, v35
    v_fma_f32 v68, v68, v154, v35
    v_fma_f32 v69, v69, v154, v35
    v_fma_f32 v70, v70, v154, v35
    v_fma_f32 v71, v71, v154, v35
    v_add_f32 v24, v24, v36
    v_add_f32 v25, v25, v36
    v_add_f32 v26, v26, v36
    v_add_f32 v27, v27, v36
    v_add_f32 v28, v28, v36
    v_add_f32 v29, v29, v36
    v_add_f32 v30, v30, v36
    v_add_f32 v31, v31, v36
    v_max_f32 v64, v64, v24
    v_max_f32 v65, v65, v25
    v_max_f32 v66, v66, v26
    v_max_f32 v67, v67, v27
    v_max_f32 v68, v68, v28
    v_max_f32 v69, v69, v29
    v_max_f32 v70, v70, v30
    v_max_f32 v71, v71, v31
    v_mul_f32 v24, v72, v157
    v_mul_f32 v25, v73, v157
    v_mul_f32 v26, v74, v157
    v_mul_f32 v27, v75, v157
    v_mul_f32 v28, v76, v158
    v_mul_f32 v29, v77, v158
    v_mul_f32 v30, v78, v158
    v_mul_f32 v31, v79, v158
    v_exp_f32_e64 v24, v24 clamp
    v_exp_f32_e64 v25, v25 clamp
    v_exp_f32_e64 v26, v26 clamp
    v_exp_f32_e64 v27, v27 clamp
    v_exp_f32_e64 v28, v28 clamp
    v_exp_f32_e64 v29, v29 clamp
    v_exp_f32_e64 v30, v30 clamp
    v_exp_f32_e64 v31, v31 clamp
    v_fma_f32 v72, v72, v153, v35
    v_fma_f32 v73, v73, v153, v35
    v_fma_f32 v74, v74, v153, v35
    v_fma_f32 v75, v75, v153, v35
    v_fma_f32 v76, v76, v154, v35
    v_fma_f32 v77, v77, v154, v35
    v_fma_f32 v78, v78, v154, v35
    v_fma_f32 v79, v79, v154, v35
    v_add_f32 v24, v24, v36
    v_add_f32 v25, v25, v36
    v_add_f32 v26, v26, v36
    v_add_f32 v27, v27, v36
    v_add_f32 v28, v28, v36
    v_add_f32 v29, v29, v36
    v_add_f32 v30, v30, v36
    v_add_f32 v31, v31, v36
    v_max_f32 v72, v72, v24
    v_max_f32 v73, v73, v25
    v_max_f32 v74, v74, v26
    v_max_f32 v75, v75, v27
    v_max_f32 v76, v76, v28
    v_max_f32 v77, v77, v29
    v_max_f32 v78, v78, v30
    v_max_f32 v79, v79, v31
    v_cvt_pk_bf16_f32 v108, v40, v41
    v_cvt_pk_bf16_f32 v109, v42, v43
    v_cvt_pk_bf16_f32 v110, v72, v73
    v_cvt_pk_bf16_f32 v111, v74, v75
    v_cvt_pk_bf16_f32 v112, v48, v49
    v_cvt_pk_bf16_f32 v113, v50, v51
    v_cvt_pk_bf16_f32 v114, v56, v57
    v_cvt_pk_bf16_f32 v115, v58, v59
    v_cvt_pk_bf16_f32 v116, v72, v73
    v_cvt_pk_bf16_f32 v117, v74, v75
    v_cvt_pk_bf16_f32 v118, v64, v65
    v_cvt_pk_bf16_f32 v119, v66, v67
    buffer_store_dwordx4 v[108:111], v17, s[24:27], 0 offen offset:0 sc1
    buffer_store_dwordx4 v[112:115], v17, s[24:27], 0 offen offset:1024 sc1
    buffer_store_dwordx4 v[116:119], v17, s[24:27], 0 offen offset:2048 sc1
    v_cvt_pk_bf16_f32 v120, v44, v45
    v_cvt_pk_bf16_f32 v121, v46, v47
    v_cvt_pk_bf16_f32 v122, v76, v77
    v_cvt_pk_bf16_f32 v123, v78, v79
    v_cvt_pk_bf16_f32 v124, v52, v53
    v_cvt_pk_bf16_f32 v125, v54, v55
    v_cvt_pk_bf16_f32 v126, v60, v61
    v_cvt_pk_bf16_f32 v127, v62, v63
    v_cvt_pk_bf16_f32 v128, v76, v77
    v_cvt_pk_bf16_f32 v129, v78, v79
    v_cvt_pk_bf16_f32 v130, v68, v69
    v_cvt_pk_bf16_f32 v131, v70, v71
    buffer_store_dwordx4 v[120:123], v17, s[24:27], s39 offen offset:0 sc1
    buffer_store_dwordx4 v[124:127], v17, s[24:27], s39 offen offset:1024 sc1
    buffer_store_dwordx4 v[128:131], v17, s[24:27], s39 offen offset:2048 sc1
    s_branch k1_kernel_fin
k1_kernel_loader:
    s_sub_u32 s93, s32, 8
    s_mul_i32 s36, s93, s39
    s_add_u32 s38, s38, s36
    v_lshlrev_b32 v27, 1, v26
    v_add_u32 v27, 0, v27
    v_sub_u32 v27, v25, v27
    v_and_b32 v27, 15, v27
    v_mul_u32_u24 v28, 0x5556, v27
    v_lshrrev_b32 v28, 16, v28
    v_mul_u32_u24 v29, 3, v28
    v_sub_u32 v29, v27, v29
    v_lshlrev_b32 v29, 4, v29
    v_min_u32 v29, 20, v29
    v_mul_u32_u24 v28, 36, v28
    v_mul_u32_u24 v30, 3456, v26
    v_cmp_lt_u32 vcc, 11, v27
    v_add3_u32 v1, v30, v28, v29
    v_mov_b32 v29, 0x7f000000
    v_add_u32 v1, s38, v1
    v_cndmask_b32 v1, v1, v29, vcc
    v_add_u32 v2, 12800, v1
    v_lshlrev_b32 v27, 1, v26
    v_add_u32 v27, 8, v27
    v_sub_u32 v27, v25, v27
    v_and_b32 v27, 15, v27
    v_mul_u32_u24 v28, 0x5556, v27
    v_lshrrev_b32 v28, 16, v28
    v_mul_u32_u24 v29, 3, v28
    v_sub_u32 v29, v27, v29
    v_lshlrev_b32 v29, 4, v29
    v_min_u32 v29, 20, v29
    v_mul_u32_u24 v28, 36, v28
    v_mul_u32_u24 v30, 3456, v26
    v_cmp_lt_u32 vcc, 11, v27
    v_add3_u32 v3, v30, v28, v29
    v_mov_b32 v29, 0x7f000000
    v_add_u32 v3, s38, v3
    v_cndmask_b32 v3, v3, v29, vcc
    v_add_u32 v4, 12800, v3
    s_lshl_b32 s36, s6, 7
    s_lshl_b32 s37, s93, 6
    s_add_u32 s36, s36, s37
    v_lshrrev_b32 v27, 3, v0
    v_add_u32 v27, s36, v27
    v_mul_u32_u24 v27, 1152, v27
    v_and_b32 v28, 7, v0
    v_xor_b32 v28, v28, v26
    v_lshl_add_u32 v5, v28, 4, v27
    v_xor_b32 v28, 4, v28
    v_lshl_add_u32 v6, v28, 4, v27
    v_add_u32 v6, 8192, v6
    s_lshl_b32 s35, s93, 13
    s_add_u32 s31, s35, 98304
    s_and_b32 s36, s6, 3
    s_and_b32 s37, s34, 3
    s_and_b32 s64, s34, 1
    s_add_u32 s64, s64, 4
    s_cmp_eq_u32 s3, 0
    s_cselect_b32 s37, s37, s64
    s_add_u32 s36, s36, s37
    s_cmp_ge_u32 s36, 3
    s_cselect_b32 s37, 3, 0
    s_sub_u32 s36, s36, s37
    s_cmp_ge_u32 s36, 3
    s_cselect_b32 s37, 3, 0
    s_sub_u32 s36, s36, s37
    s_mul_i32 s64, s36, 221184
    s_lshl_b32 s65, s36, 7
    s_mov_b32 s66, 0
    s_waitcnt lgkmcnt(0)
    s_mov_b32 s8, s56
    s_mov_b32 s9, s57
    s_mov_b32 s10, 2359296
    s_mov_b32 s11, 0x20000
    s_mov_b32 s12, s58
    s_mov_b32 s13, s59
    s_mov_b32 s14, 1990656
    s_mov_b32 s15, 0x20000
    s_add_u32 m0, s31, 0
    s_add_u32 s36, s65, 0
    buffer_load_dwordx4 v5, s[8:11], s36 offen lds
    buffer_load_dwordx4 v6, s[8:11], s36 offen offset:1024 lds
    s_add_u32 m0, s31, 2048
    s_add_u32 s36, s65, 18432
    buffer_load_dwordx4 v5, s[8:11], s36 offen lds
    buffer_load_dwordx4 v6, s[8:11], s36 offen offset:1024 lds
    s_add_u32 m0, s31, 4096
    s_add_u32 s36, s65, 36864
    buffer_load_dwordx4 v5, s[8:11], s36 offen lds
    buffer_load_dwordx4 v6, s[8:11], s36 offen offset:1024 lds
    s_add_u32 m0, s31, 6144
    s_add_u32 s36, s65, 55296
    buffer_load_dwordx4 v5, s[8:11], s36 offen lds
    buffer_load_dwordx4 v6, s[8:11], s36 offen offset:1024 lds
    s_add_u32 s65, s65, 128
    s_cmp_eq_u32 s65, 1152
    s_cselect_b32 s65, 0, s65
    s_add_u32 s31, s31, 16384
    s_cmp_ge_u32 s31, 147456
    s_cselect_b32 s36, 49152, 0
    s_sub_u32 s31, s31, s36
    s_add_u32 m0, s35, 0
    s_add_u32 s36, s64, 0
    buffer_load_dwordx4 v1, s[12:15], s36 offen lds
    buffer_load_dwordx4 v2, s[12:15], s36 offen offset:1024 lds
    s_add_u32 m0, s35, 2048
    s_add_u32 s36, s64, 27648
    buffer_load_dwordx4 v3, s[12:15], s36 offen lds
    buffer_load_dwordx4 v4, s[12:15], s36 offen offset:1024 lds
    s_add_u32 m0, s35, 4096
    s_add_u32 s36, s64, 55296
    buffer_load_dwordx4 v1, s[12:15], s36 offen lds
    buffer_load_dwordx4 v2, s[12:15], s36 offen offset:1024 lds
    s_add_u32 m0, s35, 6144
    s_add_u32 s36, s64, 82944
    buffer_load_dwordx4 v3, s[12:15], s36 offen lds
    buffer_load_dwordx4 v4, s[12:15], s36 offen offset:1024 lds
    s_add_u32 s64, s64, 110592
    s_cmp_eq_u32 s64, 1990656
    s_cselect_b32 s64, 0, s64
    s_add_u32 s35, s35, 16384
    s_cmp_ge_u32 s35, 98304
    s_cselect_b32 s36, 98304, 0
    s_sub_u32 s35, s35, s36
k1_kernel_ll:
    s_add_u32 m0, s35, 0
    s_add_u32 s36, s64, 0
    buffer_load_dwordx4 v1, s[12:15], s36 offen lds
    buffer_load_dwordx4 v2, s[12:15], s36 offen offset:1024 lds
    s_add_u32 m0, s35, 2048
    s_add_u32 s36, s64, 27648
    buffer_load_dwordx4 v3, s[12:15], s36 offen lds
    buffer_load_dwordx4 v4, s[12:15], s36 offen offset:1024 lds
    s_add_u32 m0, s35, 4096
    s_add_u32 s36, s64, 55296
    buffer_load_dwordx4 v1, s[12:15], s36 offen lds
    buffer_load_dwordx4 v2, s[12:15], s36 offen offset:1024 lds
    s_add_u32 m0, s35, 6144
    s_add_u32 s36, s64, 82944
    buffer_load_dwordx4 v3, s[12:15], s36 offen lds
    buffer_load_dwordx4 v4, s[12:15], s36 offen offset:1024 lds
    s_add_u32 s64, s64, 110592
    s_cmp_eq_u32 s64, 1990656
    s_cselect_b32 s64, 0, s64
    s_add_u32 s35, s35, 16384
    s_cmp_ge_u32 s35, 98304
    s_cselect_b32 s36, 98304, 0
    s_sub_u32 s35, s35, s36
    s_add_u32 m0, s31, 0
    s_add_u32 s36, s65, 0
    buffer_load_dwordx4 v5, s[8:11], s36 offen lds
    buffer_load_dwordx4 v6, s[8:11], s36 offen offset:1024 lds
    s_add_u32 m0, s31, 2048
    s_add_u32 s36, s65, 18432
    buffer_load_dwordx4 v5, s[8:11], s36 offen lds
    buffer_load_dwordx4 v6, s[8:11], s36 offen offset:1024 lds
    s_add_u32 m0, s31, 4096
    s_add_u32 s36, s65, 36864
    buffer_load_dwordx4 v5, s[8:11], s36 offen lds
    buffer_load_dwordx4 v6, s[8:11], s36 offen offset:1024 lds
    s_add_u32 m0, s31, 6144
    s_add_u32 s36, s65, 55296
    buffer_load_dwordx4 v5, s[8:11], s36 offen lds
    buffer_load_dwordx4 v6, s[8:11], s36 offen offset:1024 lds
    s_add_u32 s65, s65, 128
    s_cmp_eq_u32 s65, 1152
    s_cselect_b32 s65, 0, s65
    s_add_u32 s31, s31, 16384
    s_cmp_ge_u32 s31, 147456
    s_cselect_b32 s36, 49152, 0
    s_sub_u32 s31, s31, s36
    s_add_u32 m0, s35, 0
    s_add_u32 s36, s64, 0
    buffer_load_dwordx4 v1, s[12:15], s36 offen lds
    buffer_load_dwordx4 v2, s[12:15], s36 offen offset:1024 lds
    s_add_u32 m0, s35, 2048
    s_add_u32 s36, s64, 27648
    buffer_load_dwordx4 v3, s[12:15], s36 offen lds
    buffer_load_dwordx4 v4, s[12:15], s36 offen offset:1024 lds
    s_add_u32 m0, s35, 4096
    s_add_u32 s36, s64, 55296
    buffer_load_dwordx4 v1, s[12:15], s36 offen lds
    buffer_load_dwordx4 v2, s[12:15], s36 offen offset:1024 lds
    s_add_u32 m0, s35, 6144
    s_add_u32 s36, s64, 82944
    buffer_load_dwordx4 v3, s[12:15], s36 offen lds
    buffer_load_dwordx4 v4, s[12:15], s36 offen offset:1024 lds
    s_add_u32 s64, s64, 110592
    s_cmp_eq_u32 s64, 1990656
    s_cselect_b32 s64, 0, s64
    s_add_u32 s35, s35, 16384
    s_cmp_ge_u32 s35, 98304
    s_cselect_b32 s36, 98304, 0
    s_sub_u32 s35, s35, s36
    s_waitcnt vmcnt(16)
    s_barrier
    s_add_u32 s66, s66, 1
    s_cmp_lt_u32 s66, 8
    s_cbranch_scc1 k1_kernel_ll
    s_add_u32 m0, s35, 0
    s_add_u32 s36, s64, 0
    buffer_load_dwordx4 v1, s[12:15], s36 offen lds
    buffer_load_dwordx4 v2, s[12:15], s36 offen offset:1024 lds
    s_add_u32 m0, s35, 2048
    s_add_u32 s36, s64, 27648
    buffer_load_dwordx4 v3, s[12:15], s36 offen lds
    buffer_load_dwordx4 v4, s[12:15], s36 offen offset:1024 lds
    s_add_u32 m0, s35, 4096
    s_add_u32 s36, s64, 55296
    buffer_load_dwordx4 v1, s[12:15], s36 offen lds
    buffer_load_dwordx4 v2, s[12:15], s36 offen offset:1024 lds
    s_add_u32 m0, s35, 6144
    s_add_u32 s36, s64, 82944
    buffer_load_dwordx4 v3, s[12:15], s36 offen lds
    buffer_load_dwordx4 v4, s[12:15], s36 offen offset:1024 lds
    s_add_u32 s64, s64, 110592
    s_cmp_eq_u32 s64, 1990656
    s_cselect_b32 s64, 0, s64
    s_add_u32 s35, s35, 16384
    s_cmp_ge_u32 s35, 98304
    s_cselect_b32 s36, 98304, 0
    s_sub_u32 s35, s35, s36
    s_waitcnt vmcnt(0)
    s_barrier
    s_endpgm
k1_kernel_spare:
    s_cmp_ge_u32 s32, 8
    s_cbranch_scc1 k1_kernel_sp2
    s_waitcnt lgkmcnt(0)
    s_mov_b32 s4, s62
    s_mov_b32 s5, s63
    s_load_dwordx2 s[64:65], s[0:1], 16
    s_load_dwordx2 s[66:67], s[0:1], 56
    s_sub_u32 s34, s34, 24
    s_lshl_b32 s36, s32, 6
    v_add_u32 v1, s36, v0
    s_mov_b32 s68, s56
    s_mov_b32 s69, s57
    s_mov_b32 s70, 2359296
    s_mov_b32 s71, 0x20000
    s_mov_b32 s72, s58
    s_mov_b32 s73, s59
    s_mov_b32 s74, 1990656
    s_mov_b32 s75, 0x20000
    s_lshl_b32 s36, s34, 9
    v_add_u32 v2, s36, v1
    s_and_b32 s37, s33, 1
    s_mul_i32 s37, s37, 512
    s_add_u32 s37, s37, 663552
    v_add_u32 v3, 0, v2
    v_min_u32 v3, 5759, v3
    v_mul_u32_u24 v4, 69906, v3
    v_lshrrev_b32 v4, 20, v4
    v_mul_u32_u24 v5, 15, v4
    v_sub_u32 v5, v3, v5
    v_mul_u32_u24 v6, 13108, v5
    v_lshrrev_b32 v6, 16, v6
    v_mul_u32_u24 v4, 3456, v4
    v_lshl_add_u32 v4, v5, 7, v4
    v_mul_u32_u24 v6, 512, v6
    v_add_u32 v4, v4, v6
    buffer_load_dword v105, v4, s[72:75], s37 offen
    v_min_u32 v3, 3071, v2
    v_and_b32 v4, 511, v3
    v_lshrrev_b32 v5, 9, v3
    v_mul_u32_u24 v4, 1152, v4
    v_lshl_add_u32 v4, v5, 7, v4
    s_lshr_b32 s38, s33, 1
    s_mul_i32 s38, s38, 589824
    s_add_u32 s38, s38, 384
    buffer_load_dword v107, v4, s[68:71], s38 offen
    v_add_u32 v3, 4096, v2
    v_min_u32 v3, 5759, v3
    v_mul_u32_u24 v4, 69906, v3
    v_lshrrev_b32 v4, 20, v4
    v_mul_u32_u24 v5, 15, v4
    v_sub_u32 v5, v3, v5
    v_mul_u32_u24 v6, 13108, v5
    v_lshrrev_b32 v6, 16, v6
    v_mul_u32_u24 v4, 3456, v4
    v_lshl_add_u32 v4, v5, 7, v4
    v_mul_u32_u24 v6, 512, v6
    v_add_u32 v4, v4, v6
    buffer_load_dword v106, v4, s[72:75], s37 offen
    s_getpc_b64 s[20:21]
k1_pc:
    s_add_u32 s20, s20, k1_kernel-k1_pc
    s_addc_u32 s21, s21, -1
    s_lshl_b32 s36, s34, 9
    v_add_u32 v2, s36, v1
    v_lshlrev_b32 v2, 5, v2
    v_min_u32 v2, code_end-k1_kernel-4, v2
    global_load_dword v104, v2, s[20:21]
    s_getpc_b64 s[22:23]
    s_add_u32 s22, s22, kd_base@rel32@lo+4
    s_addc_u32 s23, s23, kd_base@rel32@hi+12
    v_and_b32 v2, 3, v0
    v_lshlrev_b32 v2, 6, v2
    global_load_dword v113, v2, s[22:23]
    s_add_u32 s8, s4, 2359296
    s_addc_u32 s9, s5, 0
    s_mov_b32 s10, 16384
    s_mov_b32 s11, 0x20000
    s_lshl_b32 s36, s33, 3
    s_add_u32 s36, s36, s34
    s_lshl_b32 s36, s36, 8
    v_lshl_add_u32 v2, v0, 2, s36
    v_mov_b32 v3, 0
    buffer_store_dword v3, v2, s[8:11], 0 offen sc1
    s_add_u32 s8, s4, 2555904
    s_addc_u32 s9, s5, 0
    s_mov_b32 s10, 16384
    s_mov_b32 s11, 0x20000
    buffer_store_dword v3, v2, s[8:11], 0 offen sc1
    s_lshl_b32 s36, s33, 3
    s_add_u32 s36, s36, s34
    s_lshl_b32 s36, s36, 4
    v_lshrrev_b32 v4, 5, v1
    v_add_u32 v4, s36, v4
    v_mul_u32_u24 v5, 1152, v4
    v_and_b32 v6, 31, v0
    v_mul_u32_u24 v6, 36, v6
    v_add_u32 v5, v5, v6
    s_waitcnt lgkmcnt(0)
    s_mov_b32 s12, s64
    s_mov_b32 s13, s65
    s_mov_b32 s14, 663552
    s_mov_b32 s15, 0x20000
    buffer_load_dwordx3 v[16:18], v5, s[12:15], 0 offen offset:0
    buffer_load_dwordx3 v[20:22], v5, s[12:15], 0 offen offset:12
    buffer_load_dwordx3 v[24:26], v5, s[12:15], 0 offen offset:24
    s_lshl_b32 s36, s34, 3
    s_add_u32 s36, s36, s32
    s_mul_i32 s36, s36, 82*128
    v_min_u32 v7, 40, v0
    v_lshl_add_u32 v7, v7, 7, s36
    buffer_load_dword v108, v7, s[12:15], 0 offen
    s_movk_i32 s36, 41*128
    buffer_load_dword v109, v7, s[12:15], s36 offen
    v_mul_u32_u24 v6, 3641, v4
    v_lshrrev_b32 v6, 16, v6
    v_mul_u32_u24 v7, 18, v6
    v_sub_u32 v7, v4, v7
    v_lshrrev_b32 v8, 1, v6
    v_lshlrev_b32 v8, 7, v8
    v_lshrrev_b32 v9, 2, v7
    v_lshl_add_u32 v8, v9, 4, v8
    v_and_b32 v9, 1, v6
    v_lshl_add_u32 v8, v9, 3, v8
    v_and_b32 v9, 3, v7
    v_lshl_add_u32 v8, v9, 1, v8
    v_lshrrev_b32 v10, 4, v6
    v_lshlrev_b32 v10, 7, v10
    v_add_u32 v10, 2048, v10
    v_and_b32 v9, 3, v6
    v_lshl_add_u32 v10, v9, 4, v10
    v_bfe_u32 v9, v6, 2, 2
    v_lshl_add_u32 v10, v9, 2, v10
    v_and_b32 v9, 1, v7
    v_lshl_add_u32 v10, v9, 1, v10
    v_cmp_lt_u32 vcc, 15, v7
    v_mov_b32 v11, 575
    s_nop 0
    v_cndmask_b32 v8, v8, v10, vcc
    v_cmp_lt_u32 vcc, v11, v4
    v_mov_b32 v9, 0x10000
    s_nop 0
    v_cndmask_b32 v8, v8, v9, vcc
    s_waitcnt vmcnt(2)
    v_lshlrev_b32 v12, 16, v16
    v_and_b32 v13, 0xffff0000, v16
    v_lshlrev_b32 v14, 16, v17
    v_and_b32 v15, 0xffff0000, v17
    v_add_f32 v12, v12, v14
    v_add_f32 v13, v13, v15
    v_lshlrev_b32 v14, 16, v18
    v_and_b32 v15, 0xffff0000, v18
    v_add_f32 v12, v12, v14
    v_add_f32 v13, v13, v15
    v_lshlrev_b32 v14, 16, v20
    v_and_b32 v15, 0xffff0000, v20
    v_add_f32 v12, v12, v14
    v_add_f32 v13, v13, v15
    v_lshlrev_b32 v14, 16, v21
    v_and_b32 v15, 0xffff0000, v21
    v_add_f32 v12, v12, v14
    v_add_f32 v13, v13, v15
    v_lshlrev_b32 v14, 16, v22
    v_and_b32 v15, 0xffff0000, v22
    v_add_f32 v12, v12, v14
    v_add_f32 v13, v13, v15
    v_lshlrev_b32 v14, 16, v24
    v_and_b32 v15, 0xffff0000, v24
    v_add_f32 v12, v12, v14
    v_add_f32 v13, v13, v15
    v_lshlrev_b32 v14, 16, v25
    v_and_b32 v15, 0xffff0000, v25
    v_add_f32 v12, v12, v14
    v_add_f32 v13, v13, v15
    v_lshlrev_b32 v14, 16, v26
    v_and_b32 v15, 0xffff0000, v26
    v_add_f32 v12, v12, v14
    v_add_f32 v13, v13, v15
    v_add_f32 v12, v12, v13
    s_nop 1
    v_add_f32_dpp v12, v12, v12 quad_perm:[1,0,3,2] row_mask:0xf bank_mask:0xf
    s_nop 1
    v_add_f32_dpp v12, v12, v12 quad_perm:[2,3,0,1] row_mask:0xf bank_mask:0xf
    s_nop 1
    v_add_f32_dpp v12, v12, v12 row_half_mirror row_mask:0xf bank_mask:0xf
    s_nop 1
    v_add_f32_dpp v12, v12, v12 row_mirror row_mask:0xf bank_mask:0xf
    v_mov_b32 v13, v12
    s_nop 1
    v_permlane16_swap_b32 v12, v13
    v_add_f32 v12, v12, v13
    v_mul_f32 v12, 0x3ae38e39, v12
    v_cvt_pk_bf16_f32 v13, v12, v12
    v_lshlrev_b32 v14, 16, v13
    v_sub_f32 v14, v12, v14
    v_cvt_pk_bf16_f32 v14, v14, v14
    s_add_u32 s8, s4, 2441216
    s_addc_u32 s9, s5, 0
    s_mov_b32 s10, 2304
    s_mov_b32 s11, 0x20000
    buffer_store_short v13, v8, s[8:11], 0 offen sc1
    buffer_store_short v14, v8, s[8:11], 0 offen offset:64 sc1
    s_mov_b32 s8, s4
    s_mov_b32 s9, s5
    s_mov_b32 s10, 46137344
    s_mov_b32 s11, 0x20000
    s_lshl_b32 s36, s34, 9
    v_add_u32 v2, s36, v1
    v_lshlrev_b32 v2, 19, v2
    v_min_u32 v2, 0x2c00000, v2
    buffer_load_dword v110, v2, s[8:11], 0 offen
    s_mov_b32 s8, s96
    s_mov_b32 s9, s97
    s_mov_b32 s10, 5308416
    s_mov_b32 s11, 0x20000
    buffer_load_dword v111, v2, s[8:11], 0 offen
    s_mov_b32 s8, s66
    s_mov_b32 s9, s67
    s_mov_b32 s10, 2359296
    s_mov_b32 s11, 0x20000
    buffer_load_dword v112, v2, s[8:11], 0 offen
    s_lshl_b32 s36, s34, 3
    s_add_u32 s36, s36, s32
    s_mul_i32 s36, s36, 81
    s_mul_i32 s37, s33, 1152
    s_mov_b32 s8, s24
    s_mov_b32 s9, s25
    s_mov_b32 s10, 5308416
    s_mov_b32 s11, 0x20000
    s_mov_b32 s12, s26
    s_mov_b32 s13, s27
    s_mov_b32 s14, 5308416
    s_mov_b32 s15, 0x20000
    v_min_u32 v1, 40, v0
    v_add_u32 v1, 0, v1
    v_add_u32 v1, s36, v1
    v_mul_u32_u24 v2, 7282, v1
    v_lshrrev_b32 v2, 16, v2
    v_mul_u32_u24 v3, 9, v2
    v_sub_u32 v1, v1, v3
    v_mul_u32_u24 v2, 9216, v2
    v_lshl_add_u32 v1, v1, 7, v2
    buffer_load_dword v30, v1, s[8:11], s37 offen
    buffer_load_dword v31, v1, s[12:15], s37 offen
    v_min_u32 v1, 40, v0
    v_add_u32 v1, 40, v1
    v_add_u32 v1, s36, v1
    v_mul_u32_u24 v2, 7282, v1
    v_lshrrev_b32 v2, 16, v2
    v_mul_u32_u24 v3, 9, v2
    v_sub_u32 v1, v1, v3
    v_mul_u32_u24 v2, 9216, v2
    v_lshl_add_u32 v1, v1, 7, v2
    buffer_load_dword v32, v1, s[8:11], s37 offen
    buffer_load_dword v33, v1, s[12:15], s37 offen
    s_branch k1_kernel_fin
k1_kernel_sp2:
    s_endpgm
k1_kernel_fin:
k1_kernel_end:
    s_endpgm
.text
.globl k3_kernel
.p2align 8
.type k3_kernel,@function
k3_kernel:
    s_cmp_ge_u32 s2, 256
    s_cbranch_scc1 k3_kernel_end
    s_load_dwordx2 s[4:5], s[0:1], 72
    s_load_dwordx2 s[56:57], s[0:1], 0
    s_load_dwordx2 s[58:59], s[0:1], 16
    s_load_dwordx2 s[60:61], s[0:1], 48
    s_load_dwordx4 s[88:91], s[0:1], 32
    v_mov_b32 v23, v0
    v_lshrrev_b32 v1, 6, v0
    v_and_b32 v0, 63, v0
    v_readfirstlane_b32 s32, v1
    s_and_b32 s33, s2, 7
    s_lshr_b32 s34, s2, 3
    s_mul_i32 s36, s33, 30
    s_add_u32 s36, s36, s34
    s_cmp_ge_u32 s34, 30
    s_cselect_b32 s36, 240, s36
    s_mul_i32 s6, s36, 7282
    s_lshr_b32 s6, s6, 16
    s_mul_i32 s7, s6, 9
    s_sub_u32 s7, s36, s7
    s_and_b32 s92, s32, 3
    s_lshr_b32 s93, s32, 2
    s_mul_i32 s36, s32, 6144
    v_lshl_add_u32 v6, v0, 4, s36
    v_lshl_add_u32 v7, v0, 3, s36
    s_mul_i32 s36, s6, 40
    s_add_u32 s36, s36, s32
    s_mul_i32 s36, s36, 3072
    v_lshl_add_u32 v8, v0, 4, s36
    v_lshrrev_b32 v1, 3, v0
    v_lshrrev_b32 v2, 4, v0
    v_and_b32 v3, 7, v0
    v_lshlrev_b32 v4, 1, v2
    v_xor_b32 v3, v3, v4
    s_lshl_b32 s36, s7, 7
    v_lshl_add_u32 v3, v3, 4, s36
    s_mul_i32 s36, s93, 36
    s_lshr_b32 s37, s92, 1
    s_mul_i32 s38, s37, 18
    s_add_u32 s36, s36, s38
    s_and_b32 s38, s92, 1
    s_lshl_b32 s39, s38, 3
    s_add_u32 s36, s36, s39
    v_add_u32 v4, s36, v1
    v_mul_u32_u24 v4, 1152, v4
    v_add_u32 v4, v4, v3
    s_lshl_b32 s36, s93, 2
    s_lshl_b32 s37, s37, 1
    s_add_u32 s36, s36, s37
    s_mul_i32 s36, s36, 72
    s_mul_i32 s38, s38, 36
    s_add_u32 s36, s36, s38
    s_add_u32 s36, s36, 16
    v_and_b32 v5, 1, v2
    v_mul_u32_u24 v5, 72, v5
    v_lshrrev_b32 v12, 5, v0
    v_mul_u32_u24 v12, 18, v12
    v_and_b32 v13, 1, v1
    v_add3_u32 v5, v5, v12, v13
    v_add_u32 v5, s36, v5
    v_mul_u32_u24 v5, 1152, v5
    v_add_u32 v5, v5, v3
    s_lshl_b32 s35, s32, 10
    s_add_u32 s35, s35, 90112
    v_lshrrev_b32 v9, 3, v23
    s_mul_i32 s36, s6, 80
    v_add_u32 v9, s36, v9
    v_mul_u32_u24 v10, 1152, v9
    v_and_b32 v18, 7, v0
    v_lshl_add_u32 v10, v18, 4, v10
    s_lshl_b32 s36, s7, 7
    v_add_u32 v10, s36, v10
    v_add_u32 v11, 73728, v10
    s_cmp_lt_u32 s32, 2
    s_cselect_b32 s94, 0, 0x3f000000
    v_add_u32 v11, s94, v11
    v_lshlrev_b32 v19, 2, v9
    v_and_b32 v14, 15, v0
    v_cmp_gt_u32 vcc, 2, v14
    v_lshlrev_b32 v14, 6, v14
    v_lshl_add_u32 v14, v2, 4, v14
    v_mov_b32 v15, 0x10000
    s_lshl_b32 s39, s92, 7
    v_cndmask_b32 v20, v15, v14, vcc
    s_movk_i32 s38, 4096
    s_waitcnt lgkmcnt(0)
    s_add_u32 s12, s4, 2490368
    s_addc_u32 s13, s5, 0
    s_mov_b32 s14, 49152
    s_mov_b32 s15, 0x20000
    buffer_load_dwordx2 v[40:41], v7, s[12:15], s38 offen
    buffer_load_dwordx4 v[44:47], v6, s[12:15], s38 offen offset:512
    buffer_load_dwordx2 v[42:43], v7, s[12:15], s38 offen offset:1536
    buffer_load_dwordx4 v[24:27], v6, s[12:15], 0 offen offset:0
    buffer_load_dwordx4 v[28:31], v6, s[12:15], 0 offen offset:1024
    buffer_load_dwordx4 v[32:35], v6, s[12:15], 0 offen offset:2048
    buffer_load_dwordx4 v[36:39], v6, s[12:15], 0 offen offset:3072
    s_add_u32 s16, s4, 2621440
    s_addc_u32 s17, s5, 0
    s_mov_b32 s18, 3145728
    s_mov_b32 s19, 0x20000
    s_mov_b32 s36, 0
    buffer_load_dwordx4 v[80:83], v8, s[16:19], s36 offen offset:0
    buffer_load_dwordx4 v[84:87], v8, s[16:19], s36 offen offset:1024
    buffer_load_dwordx4 v[88:91], v8, s[16:19], s36 offen offset:2048
    s_mov_b32 s36, 24576
    buffer_load_dwordx4 v[92:95], v8, s[16:19], s36 offen offset:0
    buffer_load_dwordx4 v[96:99], v8, s[16:19], s36 offen offset:1024
    buffer_load_dwordx4 v[100:103], v8, s[16:19], s36 offen offset:2048
    s_mov_b32 s36, 49152
    buffer_load_dwordx4 v[104:107], v8, s[16:19], s36 offen offset:0
    buffer_load_dwordx4 v[108:111], v8, s[16:19], s36 offen offset:1024
    buffer_load_dwordx4 v[112:115], v8, s[16:19], s36 offen offset:2048
    s_mov_b32 s8, s58
    s_mov_b32 s9, s59
    s_mov_b32 s10, 663552
    s_mov_b32 s11, 0x20000
    s_add_u32 s84, s4, 2441216
    s_addc_u32 s85, s5, 0
    s_mov_b32 s86, 2304
    s_mov_b32 s87, 0x20000
    s_mov_b32 s20, s56
    s_mov_b32 s21, s57
    s_mov_b32 s22, 2359296
    s_mov_b32 s23, 0x20000
    s_add_u32 s96, s4, 2424832
    s_addc_u32 s97, s5, 0
    s_mov_b32 s98, 8192
    s_mov_b32 s99, 0x20000
    s_mov_b32 s24, s4
    s_mov_b32 s25, s5
    s_mov_b32 s26, 2359296
    s_mov_b32 s27, 0x20000
    s_add_u32 s28, s4, 2359296
    s_addc_u32 s29, s5, 0
    s_mov_b32 s30, 16384
    s_mov_b32 s31, 0x20000
    v_mov_b32 v140, 0
    v_mov_b32 v141, 0
    v_mov_b32 v142, 0
    v_mov_b32 v143, 0
    v_mov_b32 v144, 0
    v_mov_b32 v145, 0
    v_mov_b32 v146, 0
    v_mov_b32 v147, 0
    v_mov_b32 v148, 0
    v_mov_b32 v149, 0
    v_mov_b32 v150, 0
    v_mov_b32 v151, 0
    v_mov_b32 v152, 0
    v_mov_b32 v153, 0
    v_mov_b32 v154, 0
    v_mov_b32 v155, 0
    v_mov_b32 v156, 0
    v_mov_b32 v157, 0
    v_mov_b32 v158, 0
    v_mov_b32 v159, 0
    v_bfe_u32 v14, v0, 2, 2
    v_and_b32 v15, 1, v2
    v_lshrrev_b32 v16, 1, v14
    v_lshl_or_b32 v16, v15, 1, v16
    v_xor_b32 v16, s92, v16
    v_and_b32 v17, 3, v0
    v_lshlrev_b32 v17, 3, v17
    v_lshl_add_u32 v16, v16, 5, v17
    v_lshl_add_u32 v16, v14, 7, v16
    v_lshl_add_u32 v16, v15, 9, v16
    v_lshrrev_b32 v15, 1, v2
    v_lshl_add_u32 v12, v15, 10, v16
    v_add_u32 v12, 90112, v12
    v_add_u32 v13, 0x8000, v12
    v_cmp_eq_u32 s[64:65], 0, v2
    v_cmp_eq_u32 s[72:73], 0, v14
    v_cmp_eq_u32 s[66:67], 1, v2
    v_cmp_eq_u32 s[74:75], 1, v14
    v_cmp_eq_u32 s[68:69], 2, v2
    v_cmp_eq_u32 s[76:77], 2, v14
    v_cmp_eq_u32 s[70:71], 3, v2
    v_cmp_eq_u32 s[78:79], 3, v14
    v_cmp_eq_u32 s[80:81], v2, v14
    s_mul_i32 s36, s32, 10240
    v_lshl_add_u32 v14, v0, 4, s36
    s_mul_i32 s36, s93, 5120
    s_lshl_b32 s37, s92, 2
    s_add_u32 s36, s36, s37
    s_add_u32 s36, s36, 81920
    v_lshl_add_u32 v15, v0, 4, s36
    v_mov_b32 v236, 0x358637bd
    v_mov_b32 v50, 0
    v_mov_b32 v66, 0
    v_mov_b32 v52, 0
    v_mov_b32 v68, 0
    v_mov_b32 v58, 0
    v_mov_b32 v74, 0
    v_mov_b32 v60, 0
    v_mov_b32 v76, 0
    s_waitcnt vmcnt(9)
    v_cvt_pk_bf16_f32 v208, v40, v41
    v_cvt_pk_bf16_f32 v209, v42, v43
    v_cvt_pk_bf16_f32 v210, v44, v45
    v_cvt_pk_bf16_f32 v211, v46, v47
    v_cndmask_b32 v209, 0, v209, s[80:81]
    v_cndmask_b32 v64, 0, v210, s[72:73]
    v_cndmask_b32 v65, 0, v211, s[72:73]
    v_cndmask_b32 v67, 0, v209, s[72:73]
    v_cndmask_b32 v70, 0, v210, s[74:75]
    v_cndmask_b32 v71, 0, v211, s[74:75]
    v_cndmask_b32 v69, 0, v209, s[74:75]
    v_cndmask_b32 v72, 0, v210, s[76:77]
    v_cndmask_b32 v73, 0, v211, s[76:77]
    v_cndmask_b32 v75, 0, v209, s[76:77]
    v_cndmask_b32 v78, 0, v210, s[78:79]
    v_cndmask_b32 v79, 0, v211, s[78:79]
    v_cndmask_b32 v77, 0, v209, s[78:79]
    v_cvt_pk_bf16_f32 v48, v24, v25
    v_cvt_pk_bf16_f32 v49, v26, v27
    v_cndmask_b32 v51, 0, v208, s[64:65]
    v_cvt_pk_bf16_f32 v54, v28, v29
    v_cvt_pk_bf16_f32 v55, v30, v31
    v_cndmask_b32 v53, 0, v208, s[66:67]
    v_cvt_pk_bf16_f32 v56, v32, v33
    v_cvt_pk_bf16_f32 v57, v34, v35
    v_cndmask_b32 v59, 0, v208, s[68:69]
    v_cvt_pk_bf16_f32 v62, v36, v37
    v_cvt_pk_bf16_f32 v63, v38, v39
    v_cndmask_b32 v61, 0, v208, s[70:71]
    s_mov_b32 s36, 73728
    buffer_load_dwordx4 v[116:119], v8, s[16:19], s36 offen offset:0
    buffer_load_dwordx4 v[120:123], v8, s[16:19], s36 offen offset:1024
    buffer_load_dwordx4 v[124:127], v8, s[16:19], s36 offen offset:2048
    s_mov_b32 s36, 98304
    buffer_load_dwordx4 v[128:131], v8, s[16:19], s36 offen offset:0
    buffer_load_dwordx4 v[132:135], v8, s[16:19], s36 offen offset:1024
    buffer_load_dwordx4 v[136:139], v8, s[16:19], s36 offen offset:2048
    s_waitcnt vmcnt(12)
    v_mfma_f32_16x16x32_bf16 v[176:179], v[64:67], v[80:83], 0
    v_mfma_f32_16x16x32_bf16 v[176:179], v[68:71], v[82:85], v[176:179]
    v_mfma_f32_16x16x32_bf16 v[176:179], v[72:75], v[86:89], v[176:179]
    v_mfma_f32_16x16x32_bf16 v[176:179], v[76:79], v[88:91], v[176:179]
    v_mfma_f32_16x16x32_bf16 v[160:163], v[48:51], v[80:83], 0
    v_mfma_f32_16x16x32_bf16 v[164:167], v[52:55], v[82:85], 0
    v_mfma_f32_16x16x32_bf16 v[168:171], v[56:59], v[86:89], 0
    v_mfma_f32_16x16x32_bf16 v[172:175], v[60:63], v[88:91], 0
    s_waitcnt vmcnt(9)
    v_mfma_f32_16x16x32_bf16 v[196:199], v[64:67], v[92:95], 0
    v_mfma_f32_16x16x32_bf16 v[196:199], v[68:71], v[94:97], v[196:199]
    v_mfma_f32_16x16x32_bf16 v[196:199], v[72:75], v[98:101], v[196:199]
    v_mfma_f32_16x16x32_bf16 v[196:199], v[76:79], v[100:103], v[196:199]
    v_mfma_f32_16x16x32_bf16 v[180:183], v[48:51], v[92:95], 0
    v_mfma_f32_16x16x32_bf16 v[184:187], v[52:55], v[94:97], 0
    v_mfma_f32_16x16x32_bf16 v[188:191], v[56:59], v[98:101], 0
    v_mfma_f32_16x16x32_bf16 v[192:195], v[60:63], v[100:103], 0
    s_add_u32 m0, s35, 0
    s_mov_b32 s36, 0
    buffer_load_dwordx4 v4, s[8:11], s36 offen lds
    s_add_u32 m0, s35, 8192
    s_mov_b32 s36, 82944
    buffer_load_dwordx4 v4, s[8:11], s36 offen lds
    s_add_u32 m0, s35, 16384
    s_mov_b32 s36, 165888
    buffer_load_dwordx4 v4, s[8:11], s36 offen lds
    v_add_f32 v208, v236, v176
    v_rcp_f32 v208, v208
    s_nop 0
    v_mov_b32 v209, v208
    v_mul_f32 v178, v178, v208
    v_mul_f32 v179, v179, v208
    v_permlane32_swap_b32 v208, v209
    v_cvt_pk_bf16_f32 v32, v178, v179
    v_mov_b32 v210, v208
    v_mov_b32 v211, v209
    s_nop 1
    v_permlane16_swap_b32 v208, v210
    v_permlane16_swap_b32 v209, v211
    v_mul_f32 v160, v160, v208
    v_mul_f32 v161, v161, v208
    v_mul_f32 v162, v162, v208
    v_mul_f32 v163, v163, v208
    v_mul_f32 v164, v164, v210
    v_mul_f32 v165, v165, v210
    v_mul_f32 v166, v166, v210
    v_mul_f32 v167, v167, v210
    v_mul_f32 v168, v168, v209
    v_mul_f32 v169, v169, v209
    v_mul_f32 v170, v170, v209
    v_mul_f32 v171, v171, v209
    v_mul_f32 v172, v172, v211
    v_mul_f32 v173, v173, v211
    v_mul_f32 v174, v174, v211
    v_mul_f32 v175, v175, v211
    v_cvt_pk_bf16_f32 v24, v160, v161
    v_cvt_pk_bf16_f32 v25, v162, v163
    v_cvt_pk_bf16_f32 v26, v164, v165
    v_cvt_pk_bf16_f32 v27, v166, v167
    v_cvt_pk_bf16_f32 v28, v168, v169
    v_cvt_pk_bf16_f32 v29, v170, v171
    v_cvt_pk_bf16_f32 v30, v172, v173
    v_cvt_pk_bf16_f32 v31, v174, v175
    ds_write_b128 v14, v[24:27] offset:0
    ds_write_b128 v14, v[28:31] offset:5120
    ds_write_b32 v15, v32 offset:0
    s_waitcnt vmcnt(9)
    v_mfma_f32_16x16x32_bf16 v[176:179], v[64:67], v[104:107], 0
    v_mfma_f32_16x16x32_bf16 v[176:179], v[68:71], v[106:109], v[176:179]
    v_mfma_f32_16x16x32_bf16 v[176:179], v[72:75], v[110:113], v[176:179]
    v_mfma_f32_16x16x32_bf16 v[176:179], v[76:79], v[112:115], v[176:179]
    v_mfma_f32_16x16x32_bf16 v[160:163], v[48:51], v[104:107], 0
    v_mfma_f32_16x16x32_bf16 v[164:167], v[52:55], v[106:109], 0
    v_mfma_f32_16x16x32_bf16 v[168:171], v[56:59], v[110:113], 0
    v_mfma_f32_16x16x32_bf16 v[172:175], v[60:63], v[112:115], 0
    s_add_u32 m0, s35, 24576
    s_mov_b32 s36, 248832
    buffer_load_dwordx4 v4, s[8:11], s36 offen lds
    s_add_u32 m0, s35, 32768
    s_mov_b32 s36, 331776
    buffer_load_dwordx4 v4, s[8:11], s36 offen lds
    v_add_f32 v208, v236, v196
    v_rcp_f32 v208, v208
    s_nop 0
    v_mov_b32 v209, v208
    v_mul_f32 v198, v198, v208
    v_mul_f32 v199, v199, v208
    v_permlane32_swap_b32 v208, v209
    v_cvt_pk_bf16_f32 v44, v198, v199
    v_mov_b32 v210, v208
    v_mov_b32 v211, v209
    s_nop 1
    v_permlane16_swap_b32 v208, v210
    v_permlane16_swap_b32 v209, v211
    v_mul_f32 v180, v180, v208
    v_mul_f32 v181, v181, v208
    v_mul_f32 v182, v182, v208
    v_mul_f32 v183, v183, v208
    v_mul_f32 v184, v184, v210
    v_mul_f32 v185, v185, v210
    v_mul_f32 v186, v186, v210
    v_mul_f32 v187, v187, v210
    v_mul_f32 v188, v188, v209
    v_mul_f32 v189, v189, v209
    v_mul_f32 v190, v190, v209
    v_mul_f32 v191, v191, v209
    v_mul_f32 v192, v192, v211
    v_mul_f32 v193, v193, v211
    v_mul_f32 v194, v194, v211
    v_mul_f32 v195, v195, v211
    v_cvt_pk_bf16_f32 v36, v180, v181
    v_cvt_pk_bf16_f32 v37, v182, v183
    v_cvt_pk_bf16_f32 v38, v184, v185
    v_cvt_pk_bf16_f32 v39, v186, v187
    v_cvt_pk_bf16_f32 v40, v188, v189
    v_cvt_pk_bf16_f32 v41, v190, v191
    v_cvt_pk_bf16_f32 v42, v192, v193
    v_cvt_pk_bf16_f32 v43, v194, v195
    ds_write_b128 v14, v[36:39] offset:1024
    ds_write_b128 v14, v[40:43] offset:6144
    ds_write_b32 v15, v44 offset:1024
    s_waitcnt vmcnt(8)
    v_mfma_f32_16x16x32_bf16 v[196:199], v[64:67], v[116:119], 0
    v_mfma_f32_16x16x32_bf16 v[196:199], v[68:71], v[118:121], v[196:199]
    v_mfma_f32_16x16x32_bf16 v[196:199], v[72:75], v[122:125], v[196:199]
    v_mfma_f32_16x16x32_bf16 v[196:199], v[76:79], v[124:127], v[196:199]
    v_mfma_f32_16x16x32_bf16 v[180:183], v[48:51], v[116:119], 0
    v_mfma_f32_16x16x32_bf16 v[184:187], v[52:55], v[118:121], 0
    v_mfma_f32_16x16x32_bf16 v[188:191], v[56:59], v[122:125], 0
    v_mfma_f32_16x16x32_bf16 v[192:195], v[60:63], v[124:127], 0
    s_add_u32 m0, s35, 40960
    s_mov_b32 s36, 414720
    buffer_load_dwordx4 v4, s[8:11], s36 offen lds
    s_add_u32 m0, s35, 49152
    s_mov_b32 s36, 497664
    buffer_load_dwordx4 v4, s[8:11], s36 offen lds
    v_add_f32 v208, v236, v176
    v_rcp_f32 v208, v208
    s_nop 0
    v_mov_b32 v209, v208
    v_mul_f32 v178, v178, v208
    v_mul_f32 v179, v179, v208
    v_permlane32_swap_b32 v208, v209
    v_cvt_pk_bf16_f32 v32, v178, v179
    v_mov_b32 v210, v208
    v_mov_b32 v211, v209
    s_nop 1
    v_permlane16_swap_b32 v208, v210
    v_permlane16_swap_b32 v209, v211
    v_mul_f32 v160, v160, v208
    v_mul_f32 v161, v161, v208
    v_mul_f32 v162, v162, v208
    v_mul_f32 v163, v163, v208
    v_mul_f32 v164, v164, v210
    v_mul_f32 v165, v165, v210
    v_mul_f32 v166, v166, v210
    v_mul_f32 v167, v167, v210
    v_mul_f32 v168, v168, v209
    v_mul_f32 v169, v169, v209
    v_mul_f32 v170, v170, v209
    v_mul_f32 v171, v171, v209
    v_mul_f32 v172, v172, v211
    v_mul_f32 v173, v173, v211
    v_mul_f32 v174, v174, v211
    v_mul_f32 v175, v175, v211
    v_cvt_pk_bf16_f32 v24, v160, v161
    v_cvt_pk_bf16_f32 v25, v162, v163
    v_cvt_pk_bf16_f32 v26, v164, v165
    v_cvt_pk_bf16_f32 v27, v166, v167
    v_cvt_pk_bf16_f32 v28, v168, v169
    v_cvt_pk_bf16_f32 v29, v170, v171
    v_cvt_pk_bf16_f32 v30, v172, v173
    v_cvt_pk_bf16_f32 v31, v174, v175
    ds_write_b128 v14, v[24:27] offset:2048
    ds_write_b128 v14, v[28:31] offset:7168
    ds_write_b32 v15, v32 offset:2048
    s_waitcnt vmcnt(7)
    v_mfma_f32_16x16x32_bf16 v[176:179], v[64:67], v[128:131], 0
    v_mfma_f32_16x16x32_bf16 v[176:179], v[68:71], v[130:133], v[176:179]
    v_mfma_f32_16x16x32_bf16 v[176:179], v[72:75], v[134:137], v[176:179]
    v_mfma_f32_16x16x32_bf16 v[176:179], v[76:79], v[136:139], v[176:179]
    v_mfma_f32_16x16x32_bf16 v[160:163], v[48:51], v[128:131], 0
    v_mfma_f32_16x16x32_bf16 v[164:167], v[52:55], v[130:133], 0
    v_mfma_f32_16x16x32_bf16 v[168:171], v[56:59], v[134:137], 0
    v_mfma_f32_16x16x32_bf16 v[172:175], v[60:63], v[136:139], 0
    s_add_u32 m0, s35, 57344
    s_mov_b32 s36, 580608
    buffer_load_dwordx4 v4, s[8:11], s36 offen lds
    s_add_u32 m0, s35, 65536
    s_nop 0
    buffer_load_dwordx4 v5, s[8:11], 0 offen lds
    v_add_f32 v208, v236, v196
    v_rcp_f32 v208, v208
    s_nop 0
    v_mov_b32 v209, v208
    v_mul_f32 v198, v198, v208
    v_mul_f32 v199, v199, v208
    v_permlane32_swap_b32 v208, v209
    v_cvt_pk_bf16_f32 v219, v198, v199
    v_mov_b32 v210, v208
    v_mov_b32 v211, v209
    s_nop 1
    v_permlane16_swap_b32 v208, v210
    v_permlane16_swap_b32 v209, v211
    v_mul_f32 v180, v180, v208
    v_mul_f32 v181, v181, v208
    v_mul_f32 v182, v182, v208
    v_mul_f32 v183, v183, v208
    v_mul_f32 v184, v184, v210
    v_mul_f32 v185, v185, v210
    v_mul_f32 v186, v186, v210
    v_mul_f32 v187, v187, v210
    v_mul_f32 v188, v188, v209
    v_mul_f32 v189, v189, v209
    v_mul_f32 v190, v190, v209
    v_mul_f32 v191, v191, v209
    v_mul_f32 v192, v192, v211
    v_mul_f32 v193, v193, v211
    v_mul_f32 v194, v194, v211
    v_mul_f32 v195, v195, v211
    v_cvt_pk_bf16_f32 v36, v180, v181
    v_cvt_pk_bf16_f32 v37, v182, v183
    v_cvt_pk_bf16_f32 v38, v184, v185
    v_cvt_pk_bf16_f32 v39, v186, v187
    v_cvt_pk_bf16_f32 v40, v188, v189
    v_cvt_pk_bf16_f32 v41, v190, v191
    v_cvt_pk_bf16_f32 v42, v192, v193
    v_cvt_pk_bf16_f32 v43, v194, v195
    ds_write_b128 v14, v[36:39] offset:3072
    ds_write_b128 v14, v[40:43] offset:8192
    s_mov_b32 exec_lo, 0x00030003
    s_mov_b32 exec_hi, 0x00030003
    buffer_load_dwordx4 v[140:143], v20, s[84:87], s39 offen offset:0
    buffer_load_dwordx4 v[144:147], v20, s[84:87], s39 offen offset:512
    buffer_load_dwordx4 v[148:151], v20, s[84:87], s39 offen offset:1024
    buffer_load_dwordx4 v[152:155], v20, s[84:87], s39 offen offset:1536
    buffer_load_dwordx4 v[156:159], v20, s[84:87], s39 offen offset:2048
    s_mov_b64 exec, -1
    buffer_load_dwordx4 v[200:203], v10, s[20:23], 0 offen
    buffer_load_dwordx4 v[204:207], v11, s[20:23], 0 offen
    buffer_load_dword v21, v19, s[96:99], 0 offen
    buffer_load_dword v22, v19, s[96:99], 0 offen offset:256
    v_add_f32 v208, v236, v176
    v_rcp_f32 v208, v208
    s_nop 0
    v_mov_b32 v209, v208
    v_mul_f32 v178, v178, v208
    v_mul_f32 v179, v179, v208
    v_permlane32_swap_b32 v208, v209
    v_cvt_pk_bf16_f32 v220, v178, v179
    v_mov_b32 v210, v208
    v_mov_b32 v211, v209
    s_nop 1
    v_permlane16_swap_b32 v208, v210
    v_permlane16_swap_b32 v209, v211
    v_mul_f32 v160, v160, v208
    v_mul_f32 v161, v161, v208
    v_mul_f32 v162, v162, v208
    v_mul_f32 v163, v163, v208
    v_mul_f32 v164, v164, v210
    v_mul_f32 v165, v165, v210
    v_mul_f32 v166, v166, v210
    v_mul_f32 v167, v167, v210
    v_mul_f32 v168, v168, v209
    v_mul_f32 v169, v169, v209
    v_mul_f32 v170, v170, v209
    v_mul_f32 v171, v171, v209
    v_mul_f32 v172, v172, v211
    v_mul_f32 v173, v173, v211
    v_mul_f32 v174, v174, v211
    v_mul_f32 v175, v175, v211
    v_cvt_pk_bf16_f32 v24, v160, v161
    v_cvt_pk_bf16_f32 v25, v162, v163
    v_cvt_pk_bf16_f32 v26, v164, v165
    v_cvt_pk_bf16_f32 v27, v166, v167
    v_cvt_pk_bf16_f32 v28, v168, v169
    v_cvt_pk_bf16_f32 v29, v170, v171
    v_cvt_pk_bf16_f32 v30, v172, v173
    v_cvt_pk_bf16_f32 v31, v174, v175
    ds_write_b128 v14, v[24:27] offset:4096
    ds_write_b128 v14, v[28:31] offset:9216
    s_mul_i32 s36, s93, 3072
    v_lshl_add_u32 v16, v0, 4, s36
    v_add_u32 v17, 0xa000, v16
    s_waitcnt vmcnt(4) lgkmcnt(0)
    s_barrier
    s_mov_b32 s84, s60
    s_mov_b32 s85, s61
    s_mov_b32 s86, 5308416
    s_mov_b32 s87, 0x20000
    s_lshl_b32 s36, s34, 3
    s_add_u32 s36, s36, s32
    s_mul_i32 s36, s36, 21*128
    s_mul_i32 s37, s33, 663552
    s_add_u32 s36, s36, s37
    v_min_u32 v255, 20, v0
    v_lshl_add_u32 v255, v255, 7, s36
    buffer_load_dword v255, v255, s[84:87], 0 offen
    s_cmp_eq_u32 s93, 0
    s_cbranch_scc0 k3_kernel_g2
    ds_read_b64_tr_b16 v[224:225], v12 offset:0
    ds_read_b64_tr_b16 v[226:227], v12 offset:2048
    ds_read_b128 v[80:83], v16 offset:0
    ds_read_b128 v[84:87], v16 offset:1024
    ds_read_b128 v[88:91], v16 offset:2048
    ds_read_b64_tr_b16 v[228:229], v12 offset:4096
    ds_read_b64_tr_b16 v[230:231], v12 offset:6144
    ds_read_b128 v[92:95], v16 offset:5120
    ds_read_b128 v[96:99], v16 offset:6144
    ds_read_b128 v[100:103], v16 offset:7168
    s_waitcnt lgkmcnt(5)
    v_mfma_f32_16x16x32_bf16 v[160:163], v[224:227], v[80:83], 0
    ds_read_b64_tr_b16 v[232:233], v12 offset:8192
    ds_read_b64_tr_b16 v[234:235], v12 offset:10240
    ds_read_b128 v[104:107], v16 offset:10240
    ds_read_b128 v[108:111], v16 offset:11264
    ds_read_b128 v[112:115], v16 offset:12288
    v_mfma_f32_16x16x32_bf16 v[164:167], v[224:227], v[84:87], 0
    v_mfma_f32_16x16x32_bf16 v[168:171], v[224:227], v[88:91], 0
    s_cmp_lg_u32 s92, 0
    s_cbranch_scc1 k3_kernel_m_39
    v_mfma_f32_16x16x32_bf16 v[172:175], v[140:143], v[80:83], 0
    v_mfma_f32_16x16x32_bf16 v[176:179], v[140:143], v[84:87], 0
    v_mfma_f32_16x16x32_bf16 v[180:183], v[140:143], v[88:91], 0
k3_kernel_m_39:
    s_waitcnt lgkmcnt(5)
    s_barrier
    ds_write_b32 v15, v219 offset:3072
    ds_write_b32 v15, v220 offset:4096
    v_mfma_f32_16x16x32_bf16 v[160:163], v[228:231], v[92:95], v[160:163]
    ds_read_b64_tr_b16 v[224:225], v12 offset:12288
    ds_read_b64_tr_b16 v[226:227], v12 offset:14336
    ds_read_b128 v[80:83], v16 offset:15360
    ds_read_b128 v[84:87], v16 offset:16384
    ds_read_b128 v[88:91], v16 offset:17408
    v_mfma_f32_16x16x32_bf16 v[164:167], v[228:231], v[96:99], v[164:167]
    v_mfma_f32_16x16x32_bf16 v[168:171], v[228:231], v[100:103], v[168:171]
    s_cmp_lg_u32 s92, 1
    s_cbranch_scc1 k3_kernel_m_40
    v_mfma_f32_16x16x32_bf16 v[172:175], v[140:143], v[92:95], 0
    v_mfma_f32_16x16x32_bf16 v[176:179], v[140:143], v[96:99], 0
    v_mfma_f32_16x16x32_bf16 v[180:183], v[140:143], v[100:103], 0
k3_kernel_m_40:
    s_waitcnt lgkmcnt(7)
    v_mfma_f32_16x16x32_bf16 v[160:163], v[232:235], v[104:107], v[160:163]
    ds_read_b64_tr_b16 v[228:229], v12 offset:16384
    ds_read_b64_tr_b16 v[230:231], v12 offset:18432
    ds_read_b128 v[92:95], v16 offset:20480
    ds_read_b128 v[96:99], v16 offset:21504
    ds_read_b128 v[100:103], v16 offset:22528
    v_mfma_f32_16x16x32_bf16 v[164:167], v[232:235], v[108:111], v[164:167]
    v_mfma_f32_16x16x32_bf16 v[168:171], v[232:235], v[112:115], v[168:171]
    s_cmp_lg_u32 s92, 2
    s_cbranch_scc1 k3_kernel_m_41
    v_mfma_f32_16x16x32_bf16 v[172:175], v[140:143], v[104:107], 0
    v_mfma_f32_16x16x32_bf16 v[176:179], v[140:143], v[108:111], 0
    v_mfma_f32_16x16x32_bf16 v[180:183], v[140:143], v[112:115], 0
k3_kernel_m_41:
    s_waitcnt lgkmcnt(5)
    v_mfma_f32_16x16x32_bf16 v[160:163], v[224:227], v[80:83], v[160:163]
    ds_read_b64_tr_b16 v[232:233], v12 offset:20480
    ds_read_b64_tr_b16 v[234:235], v12 offset:22528
    ds_read_b128 v[104:107], v16 offset:25600
    ds_read_b128 v[108:111], v16 offset:26624
    ds_read_b128 v[112:115], v16 offset:27648
    v_mfma_f32_16x16x32_bf16 v[164:167], v[224:227], v[84:87], v[164:167]
    v_mfma_f32_16x16x32_bf16 v[168:171], v[224:227], v[88:91], v[168:171]
    s_cmp_lg_u32 s92, 3
    s_cbranch_scc1 k3_kernel_m_42
    v_mfma_f32_16x16x32_bf16 v[172:175], v[140:143], v[80:83], 0
    v_mfma_f32_16x16x32_bf16 v[176:179], v[140:143], v[84:87], 0
    v_mfma_f32_16x16x32_bf16 v[180:183], v[140:143], v[88:91], 0
k3_kernel_m_42:
    s_waitcnt lgkmcnt(5)
    v_mfma_f32_16x16x32_bf16 v[160:163], v[228:231], v[92:95], v[160:163]
    ds_read_b64_tr_b16 v[224:225], v12 offset:24576
    ds_read_b64_tr_b16 v[226:227], v12 offset:26624
    ds_read_b128 v[80:83], v16 offset:30720
    ds_read_b128 v[84:87], v16 offset:31744
    ds_read_b128 v[88:91], v16 offset:32768
    v_mfma_f32_16x16x32_bf16 v[164:167], v[228:231], v[96:99], v[164:167]
    v_mfma_f32_16x16x32_bf16 v[168:171], v[228:231], v[100:103], v[168:171]
    s_cmp_lg_u32 s92, 0
    s_cbranch_scc1 k3_kernel_m_43
    v_mfma_f32_16x16x32_bf16 v[172:175], v[144:147], v[92:95], v[172:175]
    v_mfma_f32_16x16x32_bf16 v[176:179], v[144:147], v[96:99], v[176:179]
    v_mfma_f32_16x16x32_bf16 v[180:183], v[144:147], v[100:103], v[180:183]
k3_kernel_m_43:
    s_waitcnt lgkmcnt(5)
    v_mfma_f32_16x16x32_bf16 v[160:163], v[232:235], v[104:107], v[160:163]
    ds_read_b64_tr_b16 v[228:229], v12 offset:28672
    ds_read_b64_tr_b16 v[230:231], v12 offset:30720
    ds_read_b128 v[92:95], v16 offset:35840
    ds_read_b128 v[96:99], v16 offset:36864
    ds_read_b128 v[100:103], v16 offset:37888
    v_mfma_f32_16x16x32_bf16 v[164:167], v[232:235], v[108:111], v[164:167]
    v_mfma_f32_16x16x32_bf16 v[168:171], v[232:235], v[112:115], v[168:171]
    s_cmp_lg_u32 s92, 1
    s_cbranch_scc1 k3_kernel_m_44
    v_mfma_f32_16x16x32_bf16 v[172:175], v[144:147], v[104:107], v[172:175]
    v_mfma_f32_16x16x32_bf16 v[176:179], v[144:147], v[108:111], v[176:179]
    v_mfma_f32_16x16x32_bf16 v[180:183], v[144:147], v[112:115], v[180:183]
k3_kernel_m_44:
    s_waitcnt lgkmcnt(5)
    v_mfma_f32_16x16x32_bf16 v[160:163], v[224:227], v[80:83], v[160:163]
    ds_read_b64_tr_b16 v[232:233], v13 offset:0
    ds_read_b64_tr_b16 v[234:235], v13 offset:2048
    ds_read_b128 v[104:107], v17 offset:0
    ds_read_b128 v[108:111], v17 offset:1024
    ds_read_b128 v[112:115], v17 offset:2048
    v_mfma_f32_16x16x32_bf16 v[164:167], v[224:227], v[84:87], v[164:167]
    v_mfma_f32_16x16x32_bf16 v[168:171], v[224:227], v[88:91], v[168:171]
    s_cmp_lg_u32 s92, 2
    s_cbranch_scc1 k3_kernel_m_45
    v_mfma_f32_16x16x32_bf16 v[172:175], v[144:147], v[80:83], v[172:175]
    v_mfma_f32_16x16x32_bf16 v[176:179], v[144:147], v[84:87], v[176:179]
    v_mfma_f32_16x16x32_bf16 v[180:183], v[144:147], v[88:91], v[180:183]
k3_kernel_m_45:
    s_waitcnt lgkmcnt(5)
    v_mfma_f32_16x16x32_bf16 v[160:163], v[228:231], v[92:95], v[160:163]
    ds_read_b64_tr_b16 v[224:225], v13 offset:4096
    ds_read_b64_tr_b16 v[226:227], v13 offset:6144
    ds_read_b128 v[80:83], v17 offset:5120
    ds_read_b128 v[84:87], v17 offset:6144
    ds_read_b128 v[88:91], v17 offset:7168
    v_mfma_f32_16x16x32_bf16 v[164:167], v[228:231], v[96:99], v[164:167]
    v_mfma_f32_16x16x32_bf16 v[168:171], v[228:231], v[100:103], v[168:171]
    s_cmp_lg_u32 s92, 3
    s_cbranch_scc1 k3_kernel_m_46
    v_mfma_f32_16x16x32_bf16 v[172:175], v[144:147], v[92:95], v[172:175]
    v_mfma_f32_16x16x32_bf16 v[176:179], v[144:147], v[96:99], v[176:179]
    v_mfma_f32_16x16x32_bf16 v[180:183], v[144:147], v[100:103], v[180:183]
k3_kernel_m_46:
    s_waitcnt lgkmcnt(5)
    v_mfma_f32_16x16x32_bf16 v[160:163], v[232:235], v[104:107], v[160:163]
    ds_read_b64_tr_b16 v[228:229], v13 offset:8192
    ds_read_b64_tr_b16 v[230:231], v13 offset:10240
    ds_read_b128 v[92:95], v17 offset:10240
    ds_read_b128 v[96:99], v17 offset:11264
    ds_read_b128 v[100:103], v17 offset:12288
    v_mfma_f32_16x16x32_bf16 v[164:167], v[232:235], v[108:111], v[164:167]
    v_mfma_f32_16x16x32_bf16 v[168:171], v[232:235], v[112:115], v[168:171]
    s_cmp_lg_u32 s92, 0
    s_cbranch_scc1 k3_kernel_m_47
    v_mfma_f32_16x16x32_bf16 v[172:175], v[148:151], v[104:107], v[172:175]
    v_mfma_f32_16x16x32_bf16 v[176:179], v[148:151], v[108:111], v[176:179]
    v_mfma_f32_16x16x32_bf16 v[180:183], v[148:151], v[112:115], v[180:183]
k3_kernel_m_47:
    s_waitcnt lgkmcnt(5)
    v_mfma_f32_16x16x32_bf16 v[160:163], v[224:227], v[80:83], v[160:163]
    ds_read_b64_tr_b16 v[232:233], v13 offset:12288
    ds_read_b64_tr_b16 v[234:235], v13 offset:14336
    ds_read_b128 v[104:107], v17 offset:15360
    ds_read_b128 v[108:111], v17 offset:16384
    ds_read_b128 v[112:115], v17 offset:17408
    v_mfma_f32_16x16x32_bf16 v[164:167], v[224:227], v[84:87], v[164:167]
    v_mfma_f32_16x16x32_bf16 v[168:171], v[224:227], v[88:91], v[168:171]
    s_cmp_lg_u32 s92, 1
    s_cbranch_scc1 k3_kernel_m_48
    v_mfma_f32_16x16x32_bf16 v[172:175], v[148:151], v[80:83], v[172:175]
    v_mfma_f32_16x16x32_bf16 v[176:179], v[148:151], v[84:87], v[176:179]
    v_mfma_f32_16x16x32_bf16 v[180:183], v[148:151], v[88:91], v[180:183]
k3_kernel_m_48:
    s_waitcnt lgkmcnt(5)
    v_mfma_f32_16x16x32_bf16 v[160:163], v[228:231], v[92:95], v[160:163]
    ds_read_b64_tr_b16 v[224:225], v13 offset:16384
    ds_read_b64_tr_b16 v[226:227], v13 offset:18432
    ds_read_b128 v[80:83], v17 offset:20480
    ds_read_b128 v[84:87], v17 offset:21504
    ds_read_b128 v[88:91], v17 offset:22528
    v_mfma_f32_16x16x32_bf16 v[164:167], v[228:231], v[96:99], v[164:167]
    v_mfma_f32_16x16x32_bf16 v[168:171], v[228:231], v[100:103], v[168:171]
    s_cmp_lg_u32 s92, 2
    s_cbranch_scc1 k3_kernel_m_49
    v_mfma_f32_16x16x32_bf16 v[172:175], v[148:151], v[92:95], v[172:175]
    v_mfma_f32_16x16x32_bf16 v[176:179], v[148:151], v[96:99], v[176:179]
    v_mfma_f32_16x16x32_bf16 v[180:183], v[148:151], v[100:103], v[180:183]
k3_kernel_m_49:
    s_waitcnt lgkmcnt(5)
    v_mfma_f32_16x16x32_bf16 v[160:163], v[232:235], v[104:107], v[160:163]
    ds_read_b64_tr_b16 v[228:229], v13 offset:20480
    ds_read_b64_tr_b16 v[230:231], v13 offset:22528
    ds_read_b128 v[92:95], v17 offset:25600
    ds_read_b128 v[96:99], v17 offset:26624
    ds_read_b128 v[100:103], v17 offset:27648
    v_mfma_f32_16x16x32_bf16 v[164:167], v[232:235], v[108:111], v[164:167]
    v_mfma_f32_16x16x32_bf16 v[168:171], v[232:235], v[112:115], v[168:171]
    s_cmp_lg_u32 s92, 3
    s_cbranch_scc1 k3_kernel_m_50
    v_mfma_f32_16x16x32_bf16 v[172:175], v[148:151], v[104:107], v[172:175]
    v_mfma_f32_16x16x32_bf16 v[176:179], v[148:151], v[108:111], v[176:179]
    v_mfma_f32_16x16x32_bf16 v[180:183], v[148:151], v[112:115], v[180:183]
k3_kernel_m_50:
    s_waitcnt lgkmcnt(5)
    s_barrier
    v_mfma_f32_16x16x32_bf16 v[160:163], v[224:227], v[80:83], v[160:163]
    ds_read_b64_tr_b16 v[232:233], v13 offset:24576
    ds_read_b64_tr_b16 v[234:235], v13 offset:26624
    ds_read_b128 v[104:107], v17 offset:30720
    ds_read_b128 v[108:111], v17 offset:31744
    ds_read_b128 v[112:115], v17 offset:32768
    v_mfma_f32_16x16x32_bf16 v[164:167], v[224:227], v[84:87], v[164:167]
    v_mfma_f32_16x16x32_bf16 v[168:171], v[224:227], v[88:91], v[168:171]
    s_cmp_lg_u32 s92, 0
    s_cbranch_scc1 k3_kernel_m_51
    v_mfma_f32_16x16x32_bf16 v[172:175], v[152:155], v[80:83], v[172:175]
    v_mfma_f32_16x16x32_bf16 v[176:179], v[152:155], v[84:87], v[176:179]
    v_mfma_f32_16x16x32_bf16 v[180:183], v[152:155], v[88:91], v[180:183]
k3_kernel_m_51:
    s_waitcnt lgkmcnt(5)
    v_mfma_f32_16x16x32_bf16 v[160:163], v[228:231], v[92:95], v[160:163]
    ds_read_b64_tr_b16 v[224:225], v13 offset:28672
    ds_read_b64_tr_b16 v[226:227], v13 offset:30720
    ds_read_b128 v[80:83], v17 offset:35840
    ds_read_b128 v[84:87], v17 offset:36864
    ds_read_b128 v[88:91], v17 offset:37888
    v_mfma_f32_16x16x32_bf16 v[164:167], v[228:231], v[96:99], v[164:167]
    v_mfma_f32_16x16x32_bf16 v[168:171], v[228:231], v[100:103], v[168:171]
    s_cmp_lg_u32 s92, 1
    s_cbranch_scc1 k3_kernel_m_52
    v_mfma_f32_16x16x32_bf16 v[172:175], v[152:155], v[92:95], v[172:175]
    v_mfma_f32_16x16x32_bf16 v[176:179], v[152:155], v[96:99], v[176:179]
    v_mfma_f32_16x16x32_bf16 v[180:183], v[152:155], v[100:103], v[180:183]
k3_kernel_m_52:
    s_waitcnt lgkmcnt(5)
    v_mfma_f32_16x16x32_bf16 v[160:163], v[232:235], v[104:107], v[160:163]
    ds_read_b64_tr_b16 v[228:229], v13 offset:32768
    ds_read_b64_tr_b16 v[230:231], v13 offset:34816
    ds_read_b128 v[92:95], v17 offset:40960
    ds_read_b128 v[96:99], v17 offset:41984
    ds_read_b128 v[100:103], v17 offset:43008
    v_mfma_f32_16x16x32_bf16 v[164:167], v[232:235], v[108:111], v[164:167]
    v_mfma_f32_16x16x32_bf16 v[168:171], v[232:235], v[112:115], v[168:171]
    s_cmp_lg_u32 s92, 2
    s_cbranch_scc1 k3_kernel_m_53
    v_mfma_f32_16x16x32_bf16 v[172:175], v[152:155], v[104:107], v[172:175]
    v_mfma_f32_16x16x32_bf16 v[176:179], v[152:155], v[108:111], v[176:179]
    v_mfma_f32_16x16x32_bf16 v[180:183], v[152:155], v[112:115], v[180:183]
k3_kernel_m_53:
    s_waitcnt lgkmcnt(5)
    v_mfma_f32_16x16x32_bf16 v[160:163], v[224:227], v[80:83], v[160:163]
    ds_read_b64_tr_b16 v[232:233], v13 offset:36864
    ds_read_b64_tr_b16 v[234:235], v13 offset:38912
    ds_read_b128 v[104:107], v17 offset:46080
    ds_read_b128 v[108:111], v17 offset:47104
    ds_read_b128 v[112:115], v17 offset:48128
    v_mfma_f32_16x16x32_bf16 v[164:167], v[224:227], v[84:87], v[164:167]
    v_mfma_f32_16x16x32_bf16 v[168:171], v[224:227], v[88:91], v[168:171]
    s_cmp_lg_u32 s92, 3
    s_cbranch_scc1 k3_kernel_m_54
    v_mfma_f32_16x16x32_bf16 v[172:175], v[152:155], v[80:83], v[172:175]
    v_mfma_f32_16x16x32_bf16 v[176:179], v[152:155], v[84:87], v[176:179]
    v_mfma_f32_16x16x32_bf16 v[180:183], v[152:155], v[88:91], v[180:183]
k3_kernel_m_54:
    s_waitcnt lgkmcnt(5)
    v_mfma_f32_16x16x32_bf16 v[160:163], v[228:231], v[92:95], v[160:163]
    v_mfma_f32_16x16x32_bf16 v[164:167], v[228:231], v[96:99], v[164:167]
    v_mfma_f32_16x16x32_bf16 v[168:171], v[228:231], v[100:103], v[168:171]
    s_cmp_lg_u32 s92, 0
    s_cbranch_scc1 k3_kernel_m_55
    v_mfma_f32_16x16x32_bf16 v[172:175], v[156:159], v[92:95], v[172:175]
    v_mfma_f32_16x16x32_bf16 v[176:179], v[156:159], v[96:99], v[176:179]
    v_mfma_f32_16x16x32_bf16 v[180:183], v[156:159], v[100:103], v[180:183]
k3_kernel_m_55:
    s_waitcnt lgkmcnt(0)
    v_mfma_f32_16x16x32_bf16 v[160:163], v[232:235], v[104:107], v[160:163]
    v_mfma_f32_16x16x32_bf16 v[164:167], v[232:235], v[108:111], v[164:167]
    v_mfma_f32_16x16x32_bf16 v[168:171], v[232:235], v[112:115], v[168:171]
    s_cmp_lg_u32 s92, 1
    s_cbranch_scc1 k3_kernel_m_56
    v_mfma_f32_16x16x32_bf16 v[172:175], v[156:159], v[104:107], v[172:175]
    v_mfma_f32_16x16x32_bf16 v[176:179], v[156:159], v[108:111], v[176:179]
    v_mfma_f32_16x16x32_bf16 v[180:183], v[156:159], v[112:115], v[180:183]
k3_kernel_m_56:
    s_branch k3_kernel_gd
k3_kernel_g2:
    ds_read_b64_tr_b16 v[224:225], v12 offset:0
    ds_read_b64_tr_b16 v[226:227], v12 offset:2048
    ds_read_b128 v[80:83], v16 offset:0
    ds_read_b128 v[84:87], v16 offset:1024
    ds_read_b64_tr_b16 v[228:229], v12 offset:4096
    ds_read_b64_tr_b16 v[230:231], v12 offset:6144
    ds_read_b128 v[92:95], v16 offset:5120
    ds_read_b128 v[96:99], v16 offset:6144
    s_waitcnt lgkmcnt(4)
    v_mfma_f32_16x16x32_bf16 v[160:163], v[224:227], v[80:83], 0
    ds_read_b64_tr_b16 v[232:233], v12 offset:8192
    ds_read_b64_tr_b16 v[234:235], v12 offset:10240
    ds_read_b128 v[104:107], v16 offset:10240
    ds_read_b128 v[108:111], v16 offset:11264
    v_mfma_f32_16x16x32_bf16 v[164:167], v[224:227], v[84:87], 0
    s_cmp_lg_u32 s92, 0
    s_cbranch_scc1 k3_kernel_m_57
    v_mfma_f32_16x16x32_bf16 v[172:175], v[140:143], v[80:83], 0
    v_mfma_f32_16x16x32_bf16 v[176:179], v[140:143], v[84:87], 0
k3_kernel_m_57:
    s_waitcnt lgkmcnt(4)
    s_barrier
    ds_write_b32 v15, v219 offset:3072
    ds_write_b32 v15, v220 offset:4096
    v_mfma_f32_16x16x32_bf16 v[160:163], v[228:231], v[92:95], v[160:163]
    ds_read_b64_tr_b16 v[224:225], v12 offset:12288
    ds_read_b64_tr_b16 v[226:227], v12 offset:14336
    ds_read_b128 v[80:83], v16 offset:15360
    ds_read_b128 v[84:87], v16 offset:16384
    v_mfma_f32_16x16x32_bf16 v[164:167], v[228:231], v[96:99], v[164:167]
    s_cmp_lg_u32 s92, 1
    s_cbranch_scc1 k3_kernel_m_58
    v_mfma_f32_16x16x32_bf16 v[172:175], v[140:143], v[92:95], 0
    v_mfma_f32_16x16x32_bf16 v[176:179], v[140:143], v[96:99], 0
k3_kernel_m_58:
    s_waitcnt lgkmcnt(6)
    v_mfma_f32_16x16x32_bf16 v[160:163], v[232:235], v[104:107], v[160:163]
    ds_read_b64_tr_b16 v[228:229], v12 offset:16384
    ds_read_b64_tr_b16 v[230:231], v12 offset:18432
    ds_read_b128 v[92:95], v16 offset:20480
    ds_read_b128 v[96:99], v16 offset:21504
    v_mfma_f32_16x16x32_bf16 v[164:167], v[232:235], v[108:111], v[164:167]
    s_cmp_lg_u32 s92, 2
    s_cbranch_scc1 k3_kernel_m_59
    v_mfma_f32_16x16x32_bf16 v[172:175], v[140:143], v[104:107], 0
    v_mfma_f32_16x16x32_bf16 v[176:179], v[140:143], v[108:111], 0
k3_kernel_m_59:
    s_waitcnt lgkmcnt(4)
    v_mfma_f32_16x16x32_bf16 v[160:163], v[224:227], v[80:83], v[160:163]
    ds_read_b64_tr_b16 v[232:233], v12 offset:20480
    ds_read_b64_tr_b16 v[234:235], v12 offset:22528
    ds_read_b128 v[104:107], v16 offset:25600
    ds_read_b128 v[108:111], v16 offset:26624
    v_mfma_f32_16x16x32_bf16 v[164:167], v[224:227], v[84:87], v[164:167]
    s_cmp_lg_u32 s92, 3
    s_cbranch_scc1 k3_kernel_m_60
    v_mfma_f32_16x16x32_bf16 v[172:175], v[140:143], v[80:83], 0
    v_mfma_f32_16x16x32_bf16 v[176:179], v[140:143], v[84:87], 0
k3_kernel_m_60:
    s_waitcnt lgkmcnt(4)
    v_mfma_f32_16x16x32_bf16 v[160:163], v[228:231], v[92:95], v[160:163]
    ds_read_b64_tr_b16 v[224:225], v12 offset:24576
    ds_read_b64_tr_b16 v[226:227], v12 offset:26624
    ds_read_b128 v[80:83], v16 offset:30720
    ds_read_b128 v[84:87], v16 offset:31744
    v_mfma_f32_16x16x32_bf16 v[164:167], v[228:231], v[96:99], v[164:167]
    s_cmp_lg_u32 s92, 0
    s_cbranch_scc1 k3_kernel_m_61
    v_mfma_f32_16x16x32_bf16 v[172:175], v[144:147], v[92:95], v[172:175]
    v_mfma_f32_16x16x32_bf16 v[176:179], v[144:147], v[96:99], v[176:179]
k3_kernel_m_61:
    s_waitcnt lgkmcnt(4)
    v_mfma_f32_16x16x32_bf16 v[160:163], v[232:235], v[104:107], v[160:163]
    ds_read_b64_tr_b16 v[228:229], v12 offset:28672
    ds_read_b64_tr_b16 v[230:231], v12 offset:30720
    ds_read_b128 v[92:95], v16 offset:35840
    ds_read_b128 v[96:99], v16 offset:36864
    v_mfma_f32_16x16x32_bf16 v[164:167], v[232:235], v[108:111], v[164:167]
    s_cmp_lg_u32 s92, 1
    s_cbranch_scc1 k3_kernel_m_62
    v_mfma_f32_16x16x32_bf16 v[172:175], v[144:147], v[104:107], v[172:175]
    v_mfma_f32_16x16x32_bf16 v[176:179], v[144:147], v[108:111], v[176:179]
k3_kernel_m_62:
    s_waitcnt lgkmcnt(4)
    v_mfma_f32_16x16x32_bf16 v[160:163], v[224:227], v[80:83], v[160:163]
    ds_read_b64_tr_b16 v[232:233], v13 offset:0
    ds_read_b64_tr_b16 v[234:235], v13 offset:2048
    ds_read_b128 v[104:107], v17 offset:0
    ds_read_b128 v[108:111], v17 offset:1024
    v_mfma_f32_16x16x32_bf16 v[164:167], v[224:227], v[84:87], v[164:167]
    s_cmp_lg_u32 s92, 2
    s_cbranch_scc1 k3_kernel_m_63
    v_mfma_f32_16x16x32_bf16 v[172:175], v[144:147], v[80:83], v[172:175]
    v_mfma_f32_16x16x32_bf16 v[176:179], v[144:147], v[84:87], v[176:179]
k3_kernel_m_63:
    s_waitcnt lgkmcnt(4)
    v_mfma_f32_16x16x32_bf16 v[160:163], v[228:231], v[92:95], v[160:163]
    ds_read_b64_tr_b16 v[224:225], v13 offset:4096
    ds_read_b64_tr_b16 v[226:227], v13 offset:6144
    ds_read_b128 v[80:83], v17 offset:5120
    ds_read_b128 v[84:87], v17 offset:6144
    v_mfma_f32_16x16x32_bf16 v[164:167], v[228:231], v[96:99], v[164:167]
    s_cmp_lg_u32 s92, 3
    s_cbranch_scc1 k3_kernel_m_64
    v_mfma_f32_16x16x32_bf16 v[172:175], v[144:147], v[92:95], v[172:175]
    v_mfma_f32_16x16x32_bf16 v[176:179], v[144:147], v[96:99], v[176:179]
k3_kernel_m_64:
    s_waitcnt lgkmcnt(4)
    v_mfma_f32_16x16x32_bf16 v[160:163], v[232:235], v[104:107], v[160:163]
    ds_read_b64_tr_b16 v[228:229], v13 offset:8192
    ds_read_b64_tr_b16 v[230:231], v13 offset:10240
    ds_read_b128 v[92:95], v17 offset:10240
    ds_read_b128 v[96:99], v17 offset:11264
    v_mfma_f32_16x16x32_bf16 v[164:167], v[232:235], v[108:111], v[164:167]
    s_cmp_lg_u32 s92, 0
    s_cbranch_scc1 k3_kernel_m_65
    v_mfma_f32_16x16x32_bf16 v[172:175], v[148:151], v[104:107], v[172:175]
    v_mfma_f32_16x16x32_bf16 v[176:179], v[148:151], v[108:111], v[176:179]
k3_kernel_m_65:
    s_waitcnt lgkmcnt(4)
    v_mfma_f32_16x16x32_bf16 v[160:163], v[224:227], v[80:83], v[160:163]
    ds_read_b64_tr_b16 v[232:233], v13 offset:12288
    ds_read_b64_tr_b16 v[234:235], v13 offset:14336
    ds_read_b128 v[104:107], v17 offset:15360
    ds_read_b128 v[108:111], v17 offset:16384
    v_mfma_f32_16x16x32_bf16 v[164:167], v[224:227], v[84:87], v[164:167]
    s_cmp_lg_u32 s92, 1
    s_cbranch_scc1 k3_kernel_m_66
    v_mfma_f32_16x16x32_bf16 v[172:175], v[148:151], v[80:83], v[172:175]
    v_mfma_f32_16x16x32_bf16 v[176:179], v[148:151], v[84:87], v[176:179]
k3_kernel_m_66:
    s_waitcnt lgkmcnt(4)
    v_mfma_f32_16x16x32_bf16 v[160:163], v[228:231], v[92:95], v[160:163]
    ds_read_b64_tr_b16 v[224:225], v13 offset:16384
    ds_read_b64_tr_b16 v[226:227], v13 offset:18432
    ds_read_b128 v[80:83], v17 offset:20480
    ds_read_b128 v[84:87], v17 offset:21504
    v_mfma_f32_16x16x32_bf16 v[164:167], v[228:231], v[96:99], v[164:167]
    s_cmp_lg_u32 s92, 2
    s_cbranch_scc1 k3_kernel_m_67
    v_mfma_f32_16x16x32_bf16 v[172:175], v[148:151], v[92:95], v[172:175]
    v_mfma_f32_16x16x32_bf16 v[176:179], v[148:151], v[96:99], v[176:179]
k3_kernel_m_67:
    s_waitcnt lgkmcnt(4)
    v_mfma_f32_16x16x32_bf16 v[160:163], v[232:235], v[104:107], v[160:163]
    ds_read_b64_tr_b16 v[228:229], v13 offset:20480
    ds_read_b64_tr_b16 v[230:231], v13 offset:22528
    ds_read_b128 v[92:95], v17 offset:25600
    ds_read_b128 v[96:99], v17 offset:26624
    v_mfma_f32_16x16x32_bf16 v[164:167], v[232:235], v[108:111], v[164:167]
    s_cmp_lg_u32 s92, 3
    s_cbranch_scc1 k3_kernel_m_68
    v_mfma_f32_16x16x32_bf16 v[172:175], v[148:151], v[104:107], v[172:175]
    v_mfma_f32_16x16x32_bf16 v[176:179], v[148:151], v[108:111], v[176:179]
k3_kernel_m_68:
    s_waitcnt lgkmcnt(4)
    s_barrier
    v_mfma_f32_16x16x32_bf16 v[160:163], v[224:227], v[80:83], v[160:163]
    ds_read_b64_tr_b16 v[232:233], v13 offset:24576
    ds_read_b64_tr_b16 v[234:235], v13 offset:26624
    ds_read_b128 v[104:107], v17 offset:30720
    ds_read_b128 v[108:111], v17 offset:31744
    v_mfma_f32_16x16x32_bf16 v[164:167], v[224:227], v[84:87], v[164:167]
    s_cmp_lg_u32 s92, 0
    s_cbranch_scc1 k3_kernel_m_69
    v_mfma_f32_16x16x32_bf16 v[172:175], v[152:155], v[80:83], v[172:175]
    v_mfma_f32_16x16x32_bf16 v[176:179], v[152:155], v[84:87], v[176:179]
k3_kernel_m_69:
    s_waitcnt lgkmcnt(4)
    v_mfma_f32_16x16x32_bf16 v[160:163], v[228:231], v[92:95], v[160:163]
    ds_read_b64_tr_b16 v[224:225], v13 offset:28672
    ds_read_b64_tr_b16 v[226:227], v13 offset:30720
    ds_read_b128 v[80:83], v17 offset:35840
    ds_read_b128 v[84:87], v17 offset:36864
    v_mfma_f32_16x16x32_bf16 v[164:167], v[228:231], v[96:99], v[164:167]
    s_cmp_lg_u32 s92, 1
    s_cbranch_scc1 k3_kernel_m_70
    v_mfma_f32_16x16x32_bf16 v[172:175], v[152:155], v[92:95], v[172:175]
    v_mfma_f32_16x16x32_bf16 v[176:179], v[152:155], v[96:99], v[176:179]
k3_kernel_m_70:
    s_waitcnt lgkmcnt(4)
    v_mfma_f32_16x16x32_bf16 v[160:163], v[232:235], v[104:107], v[160:163]
    ds_read_b64_tr_b16 v[228:229], v13 offset:32768
    ds_read_b64_tr_b16 v[230:231], v13 offset:34816
    ds_read_b128 v[92:95], v17 offset:40960
    ds_read_b128 v[96:99], v17 offset:41984
    v_mfma_f32_16x16x32_bf16 v[164:167], v[232:235], v[108:111], v[164:167]
    s_cmp_lg_u32 s92, 2
    s_cbranch_scc1 k3_kernel_m_71
    v_mfma_f32_16x16x32_bf16 v[172:175], v[152:155], v[104:107], v[172:175]
    v_mfma_f32_16x16x32_bf16 v[176:179], v[152:155], v[108:111], v[176:179]
k3_kernel_m_71:
    s_waitcnt lgkmcnt(4)
    v_mfma_f32_16x16x32_bf16 v[160:163], v[224:227], v[80:83], v[160:163]
    ds_read_b64_tr_b16 v[232:233], v13 offset:36864
    ds_read_b64_tr_b16 v[234:235], v13 offset:38912
    ds_read_b128 v[104:107], v17 offset:46080
    ds_read_b128 v[108:111], v17 offset:47104
    v_mfma_f32_16x16x32_bf16 v[164:167], v[224:227], v[84:87], v[164:167]
    s_cmp_lg_u32 s92, 3
    s_cbranch_scc1 k3_kernel_m_72
    v_mfma_f32_16x16x32_bf16 v[172:175], v[152:155], v[80:83], v[172:175]
    v_mfma_f32_16x16x32_bf16 v[176:179], v[152:155], v[84:87], v[176:179]
k3_kernel_m_72:
    s_waitcnt lgkmcnt(4)
    v_mfma_f32_16x16x32_bf16 v[160:163], v[228:231], v[92:95], v[160:163]
    v_mfma_f32_16x16x32_bf16 v[164:167], v[228:231], v[96:99], v[164:167]
    s_cmp_lg_u32 s92, 0
    s_cbranch_scc1 k3_kernel_m_73
    v_mfma_f32_16x16x32_bf16 v[172:175], v[156:159], v[92:95], v[172:175]
    v_mfma_f32_16x16x32_bf16 v[176:179], v[156:159], v[96:99], v[176:179]
k3_kernel_m_73:
    s_waitcnt lgkmcnt(0)
    v_mfma_f32_16x16x32_bf16 v[160:163], v[232:235], v[104:107], v[160:163]
    v_mfma_f32_16x16x32_bf16 v[164:167], v[232:235], v[108:111], v[164:167]
    s_cmp_lg_u32 s92, 1
    s_cbranch_scc1 k3_kernel_m_74
    v_mfma_f32_16x16x32_bf16 v[172:175], v[156:159], v[104:107], v[172:175]
    v_mfma_f32_16x16x32_bf16 v[176:179], v[156:159], v[108:111], v[176:179]
k3_kernel_m_74:
k3_kernel_gd:
    v_and_b32 v16, 15, v0
    v_mul_u32_u24 v16, 272, v16
    v_lshl_add_u32 v16, v2, 4, v16
    s_mul_i32 s36, s93, 48*272
    s_lshl_b32 s37, s92, 6
    s_add_u32 s36, s36, s37
    v_add_u32 v16, s36, v16
    v_lshrrev_b32 v13, 3, v23
    v_mul_u32_u24 v17, 272, v13
    v_lshl_add_u32 v17, v18, 5, v17
    v_lshlrev_b32 v13, 4, v13
    v_lshlrev_b32 v12, 4, v0
    s_mul_i32 s36, s93, 48*16
    s_lshl_b32 s37, s92, 2
    s_add_u32 s36, s36, s37
    s_add_u32 s36, s36, 36864
    v_cmp_gt_u32 vcc, 16, v0
    v_add_u32 v12, s36, v12
    v_mov_b32 v14, 40960
    v_add_f32 v172, v172, v173
    v_add_f32 v176, v176, v177
    v_add_f32 v180, v180, v181
    v_cndmask_b32 v12, v14, v12, vcc
    ds_write_b128 v16, v[160:163] offset:0
    ds_write_b128 v16, v[164:167] offset:4352
    ds_write_b128 v16, v[168:171] offset:8704
    ds_write_b32 v12, v172 offset:0
    ds_write_b32 v12, v176 offset:256
    ds_write_b32 v12, v180 offset:512
    v_lshlrev_b32 v19, 3, v9
    v_add_u32 v19, 4, v19
    v_cmp_eq_u32 vcc, 1, v18
    v_mov_b32 v20, 0x3f000000
    s_cmp_eq_u32 s7, 0
    s_cselect_b32 s36, 0, 0x3f000000
    v_cndmask_b32 v19, v20, v19, vcc
    v_add_u32 v20, 512, v19
    v_add_u32 v20, s94, v20
    v_lshlrev_b32 v14, 3, v9
    v_add_u32 v14, s36, v14
    v_add_u32 v15, 512, v14
    v_add_u32 v15, s94, v15
    s_waitcnt vmcnt(1)
    v_lshlrev_b32 v24, 16, v200
    v_and_b32 v25, 0xffff0000, v200
    v_lshlrev_b32 v26, 16, v201
    v_and_b32 v27, 0xffff0000, v201
    v_lshlrev_b32 v28, 16, v202
    v_and_b32 v29, 0xffff0000, v202
    v_lshlrev_b32 v30, 16, v203
    v_and_b32 v31, 0xffff0000, v203
    v_lshlrev_b32 v32, 16, v204
    v_and_b32 v33, 0xffff0000, v204
    v_lshlrev_b32 v34, 16, v205
    v_and_b32 v35, 0xffff0000, v205
    v_lshlrev_b32 v36, 16, v206
    v_and_b32 v37, 0xffff0000, v206
    v_lshlrev_b32 v38, 16, v207
    v_and_b32 v39, 0xffff0000, v207
    s_waitcnt lgkmcnt(0)
    s_barrier
    ds_read_b128 v[96:99], v13 offset:36864
    ds_read_b128 v[80:83], v17 offset:0
    ds_read_b128 v[84:87], v17 offset:16
    ds_read_b128 v[100:103], v13 offset:37888
    ds_read_b128 v[88:91], v17 offset:17408
    ds_read_b128 v[92:95], v17 offset:17424
    s_waitcnt lgkmcnt(3)
    v_add_f32 v96, v96, v97
    v_add_f32 v98, v98, v99
    v_add_f32 v80, v80, v24
    v_add_f32 v81, v81, v25
    v_add_f32 v82, v82, v26
    v_add_f32 v83, v83, v27
    v_add_f32 v84, v84, v28
    v_add_f32 v85, v85, v29
    v_add_f32 v86, v86, v30
    v_add_f32 v87, v87, v31
    v_add_f32 v96, v96, v98
    v_add_f32 v21, v21, v96
    v_sub_f32 v80, v80, v21
    v_sub_f32 v81, v81, v21
    v_sub_f32 v82, v82, v21
    v_sub_f32 v83, v83, v21
    v_sub_f32 v84, v84, v21
    v_sub_f32 v85, v85, v21
    v_sub_f32 v86, v86, v21
    v_sub_f32 v87, v87, v21
    v_cvt_pk_bf16_f32 v200, v80, v81
    v_cvt_pk_bf16_f32 v201, v82, v83
    v_cvt_pk_bf16_f32 v202, v84, v85
    v_cvt_pk_bf16_f32 v203, v86, v87
    buffer_store_dwordx4 v[200:203], v10, s[24:27], 0 offen sc1
    buffer_store_dword v21, v14, s[28:31], 0 offen sc1
    v_mul_f32 v212, v80, v80
    v_fmac_f32 v212, v81, v81
    v_fmac_f32 v212, v82, v82
    v_fmac_f32 v212, v83, v83
    v_fmac_f32 v212, v84, v84
    v_fmac_f32 v212, v85, v85
    v_fmac_f32 v212, v86, v86
    v_fmac_f32 v212, v87, v87
    s_waitcnt lgkmcnt(0)
    v_add_f32 v100, v100, v101
    v_add_f32 v102, v102, v103
    v_add_f32 v88, v88, v32
    v_add_f32 v89, v89, v33
    v_add_f32 v90, v90, v34
    v_add_f32 v91, v91, v35
    v_add_f32 v92, v92, v36
    v_add_f32 v93, v93, v37
    v_add_f32 v94, v94, v38
    v_add_f32 v95, v95, v39
    v_add_f32 v100, v100, v102
    v_add_f32 v22, v22, v100
    v_sub_f32 v88, v88, v22
    v_sub_f32 v89, v89, v22
    v_sub_f32 v90, v90, v22
    v_sub_f32 v91, v91, v22
    v_sub_f32 v92, v92, v22
    v_sub_f32 v93, v93, v22
    v_sub_f32 v94, v94, v22
    v_sub_f32 v95, v95, v22
    v_cvt_pk_bf16_f32 v204, v88, v89
    v_cvt_pk_bf16_f32 v205, v90, v91
    v_cvt_pk_bf16_f32 v206, v92, v93
    v_cvt_pk_bf16_f32 v207, v94, v95
    buffer_store_dwordx4 v[204:207], v11, s[24:27], 0 offen sc1
    buffer_store_dword v22, v15, s[28:31], 0 offen sc1
    v_mul_f32 v213, v88, v88
    v_fmac_f32 v213, v89, v89
    v_fmac_f32 v213, v90, v90
    v_fmac_f32 v213, v91, v91
    v_fmac_f32 v213, v92, v92
    v_fmac_f32 v213, v93, v93
    v_fmac_f32 v213, v94, v94
    v_fmac_f32 v213, v95, v95
    s_nop 1
    v_add_f32_dpp v212, v212, v212 quad_perm:[1,0,3,2] row_mask:0xf bank_mask:0xf
    v_add_f32_dpp v213, v213, v213 quad_perm:[1,0,3,2] row_mask:0xf bank_mask:0xf
    s_nop 1
    v_add_f32_dpp v212, v212, v212 quad_perm:[2,3,0,1] row_mask:0xf bank_mask:0xf
    v_add_f32_dpp v213, v213, v213 quad_perm:[2,3,0,1] row_mask:0xf bank_mask:0xf
    s_nop 1
    v_add_f32_dpp v212, v212, v212 row_half_mirror row_mask:0xf bank_mask:0xf
    v_add_f32_dpp v213, v213, v213 row_half_mirror row_mask:0xf bank_mask:0xf
    buffer_atomic_add_f32 v212, v19, s[28:31], 0 offen
    buffer_atomic_add_f32 v213, v20, s[28:31], 0 offen
k3_kernel_end:
    s_endpgm
.text
.globl ffn_kernel
.p2align 8
.type ffn_kernel,@function
ffn_kernel:
    s_cmp_ge_u32 s2, 256
    s_cbranch_scc1 ffn_kernel_end
    s_load_dwordx4 s[56:59], s[0:1], 32
    s_load_dwordx2 s[60:61], s[0:1], 48
    s_load_dwordx2 s[4:5], s[0:1], 72
    v_lshrrev_b32 v38, 6, v0
    v_and_b32 v0, 63, v0
    v_readfirstlane_b32 s32, v38
    s_and_b32 s33, s2, 7
    s_lshr_b32 s34, s2, 4
    s_bfe_u32 s3, s2, 0x10003
    s_and_b32 s6, s34, 3
    s_lshl_b32 s35, s32, 10
    s_add_u32 s35, s35, 4096
    s_lshr_b32 s92, s32, 1
    s_and_b32 s93, s32, 1
    s_movk_i32 s38, 1152
    v_lshrrev_b32 v104, 3, v0
    v_and_b32 v105, 7, v0
    v_lshrrev_b32 v106, 4, v0
    v_and_b32 v107, 15, v0
    s_lshl_b32 s36, s34, 7
    s_lshl_b32 s37, s32, 5
    s_add_u32 s36, s36, s37
    v_add_u32 v109, s36, v104
    v_mul_lo_u32 v109, v109, s38
    v_xor_b32 v110, v105, v106
    v_lshl_add_u32 v3, v110, 4, v109
    v_xor_b32 v110, 4, v110
    v_lshl_add_u32 v4, v110, 4, v109
    v_add_u32 v4, 9216, v4
    s_lshl_b32 s36, s32, 3
    v_add_u32 v109, s36, v104
    s_movk_i32 s37, 9216
    v_mul_lo_u32 v1, v109, s37
    v_and_b32 v110, 1, v106
    s_lshl_b32 s39, s93, 1
    v_or_b32 v110, s39, v110
    v_lshlrev_b32 v110, 1, v110
    v_xor_b32 v110, v110, v105
    v_lshl_add_u32 v1, v110, 4, v1
    s_mul_i32 s39, s33, 1152
    s_mul_i32 s62, s3, 640
    s_add_u32 s62, s62, s39
    s_lshl_b32 s63, s6, 7
    s_add_u32 s63, s63, s62
    v_add_u32 v1, s63, v1
    s_mov_b32 s7, s6
    s_mul_i32 s63, s33, 576
    v_add_u32 v109, s63, v109
    v_mul_lo_u32 v36, v109, s38
    v_lshlrev_b32 v110, 1, v106
    v_xor_b32 v110, v110, v105
    v_lshl_add_u32 v36, v110, 4, v36
    s_mul_i32 s36, s3, 640
    v_add_u32 v36, s36, v36
    v_lshrrev_b32 v109, 2, v0
    s_lshl_b32 s36, s93, 4
    v_add_u32 v109, s36, v109
    v_mul_lo_u32 v2, v109, s37
    v_lshrrev_b32 v110, 5, v0
    v_lshlrev_b32 v110, 1, v110
    v_and_b32 v111, 3, v0
    v_xor_b32 v110, v110, v111
    v_lshl_add_u32 v2, v110, 4, v2
    s_lshl_b32 s36, s3, 6
    s_add_u32 s36, s36, s39
    s_add_u32 s36, s36, 512
    v_add_u32 v2, s36, v2
    s_mov_b32 s64, 0
    s_mov_b32 s65, 294912
    s_mov_b32 s66, 589824
    s_mov_b32 s67, 884736
    s_mov_b32 s68, 1179648
    s_mov_b32 s69, 1474560
    s_mov_b32 s70, 1769472
    s_mov_b32 s71, 2064384
    s_mov_b32 s72, 2359296
    s_mov_b32 s73, 2654208
    s_mov_b32 s74, 2949120
    s_mov_b32 s75, 3244032
    s_mov_b32 s76, 3538944
    s_mov_b32 s77, 3833856
    s_mov_b32 s78, 4128768
    s_mov_b32 s79, 4423680
    s_mov_b32 s80, 4718592
    s_mov_b32 s81, 5013504
    s_movk_i32 s101, -384
    s_lshl_b32 s39, s32, 12
    s_add_u32 s39, s39, 90112
    s_mul_i32 s82, s3, 36864
    s_add_u32 s82, s82, 294912
    s_add_u32 s36, s6, 0
    s_and_b32 s36, s36, 3
    s_mul_i32 s37, s3, 5
    s_add_u32 s36, s36, s37
    s_mul_i32 s83, s36, 73728
    s_add_u32 s84, s83, 36864
    s_add_u32 s36, s6, 1
    s_and_b32 s36, s36, 3
    s_mul_i32 s37, s3, 5
    s_add_u32 s36, s36, s37
    s_mul_i32 s85, s36, 73728
    s_add_u32 s86, s85, 36864
    s_add_u32 s36, s6, 2
    s_and_b32 s36, s36, 3
    s_mul_i32 s37, s3, 5
    s_add_u32 s36, s36, s37
    s_mul_i32 s87, s36, 73728
    s_add_u32 s88, s87, 36864
    s_add_u32 s36, s6, 3
    s_and_b32 s36, s36, 3
    s_mul_i32 s37, s3, 5
    s_add_u32 s36, s36, s37
    s_mul_i32 s89, s36, 73728
    s_add_u32 s90, s89, 36864
    v_bfe_u32 v108, v0, 2, 2
    v_and_b32 v111, 3, v0
    v_lshlrev_b32 v111, 3, v111
    v_lshrrev_b32 v109, 1, v108
    v_and_b32 v110, 1, v106
    v_lshl_or_b32 v109, v110, 1, v109
    s_lshl_b32 s36, s93, 1
    v_xor_b32 v109, s36, v109
    v_lshl_add_u32 v109, v109, 5, v111
    v_lshl_add_u32 v109, v108, 7, v109
    v_lshl_add_u32 v9, v106, 10, v109
    v_add_u32 v9, 4096, v9
    v_add_u32 v10, 0x10000, v9
    v_xor_b32 v11, 32, v9
    v_add_u32 v12, 0x10000, v11
    v_xor_b32 v110, s93, v110
    v_lshl_add_u32 v110, v110, 5, v111
    v_lshl_add_u32 v110, v108, 6, v110
    v_lshl_add_u32 v7, v106, 9, v110
    v_add_u32 v7, 4096, v7
    v_add_u32 v8, 0x10000, v7
    v_lshrrev_b32 v109, 1, v107
    v_xor_b32 v109, v109, v106
    v_lshlrev_b32 v109, 4, v109
    v_lshl_add_u32 v109, v107, 7, v109
    s_lshl_b32 s36, s92, 13
    s_add_u32 s36, s36, 90112
    v_add_u32 v5, s36, v109
    v_xor_b32 v109, 64, v109
    v_add_u32 v6, s36, v109
    s_lshl_b32 s36, s92, 12
    s_add_u32 s36, s36, 90112
    s_lshl_b32 s37, s93, 3
    s_add_u32 s37, s37, s36
    v_lshl_add_u32 v37, v0, 4, s37
    s_lshl_b32 s37, s93, 13
    s_add_u32 s37, s37, s36
    s_add_u32 s37, s37, 8192
    v_lshl_add_u32 v13, v0, 4, s37
    v_lshl_add_u32 v14, v0, 4, s36
    s_waitcnt lgkmcnt(0)
    s_mov_b32 s20, s4
    s_mov_b32 s21, s5
    s_mov_b32 s22, 2359296
    s_mov_b32 s23, 0x20000
    s_mov_b32 s8, s56
    s_mov_b32 s9, s57
    s_mov_b32 s10, 5308416
    s_mov_b32 s11, 0x20000
    s_mov_b32 s12, s58
    s_mov_b32 s13, s59
    s_mov_b32 s14, 5308416
    s_mov_b32 s15, 0x20000
    s_cmp_eq_u32 s92, 0
    s_cselect_b32 s24, s56, s58
    s_cselect_b32 s25, s57, s59
    s_mov_b32 s26, 5308416
    s_mov_b32 s27, 0x20000
    s_movk_i32 s62, 0
    s_add_u32 m0, s39, 0
    s_nop 0
    buffer_load_dwordx4 v3, s[20:23], s62 offen lds
    s_movk_i32 s62, 0
    s_add_u32 m0, s39, 1024
    s_nop 0
    buffer_load_dwordx4 v4, s[20:23], s62 offen lds
    s_movk_i32 s62, 18432
    s_add_u32 m0, s39, 2048
    s_nop 0
    buffer_load_dwordx4 v3, s[20:23], s62 offen lds
    s_movk_i32 s62, 18432
    s_add_u32 m0, s39, 3072
    s_nop 0
    buffer_load_dwordx4 v4, s[20:23], s62 offen lds
    s_add_u32 m0, s35, 0
    s_nop 0
    buffer_load_dwordx4 v1, s[8:11], s64 offen lds
    s_add_u32 m0, s35, 4096
    s_nop 0
    buffer_load_dwordx4 v1, s[12:15], s64 offen lds
    s_add_u32 m0, s35, 8192
    s_nop 0
    buffer_load_dwordx4 v1, s[8:11], s65 offen lds
    s_movk_i32 s62, 128
    s_add_u32 m0, s39, 16384
    s_nop 0
    buffer_load_dwordx4 v3, s[20:23], s62 offen lds
    s_movk_i32 s62, 128
    s_add_u32 m0, s39, 17408
    s_nop 0
    buffer_load_dwordx4 v4, s[20:23], s62 offen lds
    s_movk_i32 s62, 18560
    s_add_u32 m0, s39, 18432
    s_nop 0
    buffer_load_dwordx4 v3, s[20:23], s62 offen lds
    s_movk_i32 s62, 18560
    s_add_u32 m0, s39, 19456
    s_nop 0
    buffer_load_dwordx4 v4, s[20:23], s62 offen lds
    s_add_u32 m0, s35, 12288
    s_nop 0
    buffer_load_dwordx4 v1, s[12:15], s65 offen lds
    s_add_u32 m0, s35, 16384
    s_nop 0
    buffer_load_dwordx4 v1, s[8:11], s66 offen lds
    s_add_u32 m0, s35, 20480
    s_nop 0
    buffer_load_dwordx4 v1, s[12:15], s66 offen lds
    s_add_u32 m0, s35, 24576
    s_nop 0
    buffer_load_dwordx4 v1, s[8:11], s67 offen lds
    s_movk_i32 s62, 256
    s_add_u32 m0, s39, 32768
    s_nop 0
    buffer_load_dwordx4 v3, s[20:23], s62 offen lds
    s_movk_i32 s62, 256
    s_add_u32 m0, s39, 33792
    s_nop 0
    buffer_load_dwordx4 v4, s[20:23], s62 offen lds
    s_movk_i32 s62, 18688
    s_add_u32 m0, s39, 34816
    s_nop 0
    buffer_load_dwordx4 v3, s[20:23], s62 offen lds
    s_movk_i32 s62, 18688
    s_add_u32 m0, s39, 35840
    s_nop 0
    buffer_load_dwordx4 v4, s[20:23], s62 offen lds
    s_mov_b32 s16, s60
    s_mov_b32 s17, s61
    s_mov_b32 s18, 5308416
    s_mov_b32 s19, 0x20000
    s_waitcnt vmcnt(12)
    s_barrier
    ds_read_b128 a[0:3], v5 offset:0
    ds_read_b128 a[4:7], v5 offset:2048
    ds_read_b128 a[8:11], v5 offset:4096
    ds_read_b128 a[12:15], v5 offset:6144
    ds_read_b128 a[16:19], v6 offset:0
    ds_read_b128 a[20:23], v6 offset:2048
    ds_read_b128 a[24:27], v6 offset:4096
    ds_read_b128 a[28:31], v6 offset:6144
    ds_read_b64_tr_b16 v[200:201], v9 offset:0
    ds_read_b64_tr_b16 v[202:203], v9 offset:512
    ds_read_b64_tr_b16 v[204:205], v11 offset:0
    ds_read_b64_tr_b16 v[206:207], v11 offset:512
    ds_read_b64_tr_b16 v[208:209], v9 offset:4096
    ds_read_b64_tr_b16 v[210:211], v9 offset:4608
    ds_read_b64_tr_b16 v[212:213], v11 offset:4096
    ds_read_b64_tr_b16 v[214:215], v11 offset:4608
    s_waitcnt lgkmcnt(4)
    v_mfma_f32_16x16x32_bf16 v[40:43], v[200:203], a[0:3], 0
    ds_read_b64_tr_b16 v[216:217], v9 offset:8192
    s_movk_i32 s62, 384
    v_mfma_f32_16x16x32_bf16 v[44:47], v[200:203], a[4:7], 0
    s_add_u32 m0, s39, 49152
    v_mfma_f32_16x16x32_bf16 v[48:51], v[200:203], a[8:11], 0
    ds_read_b64_tr_b16 v[218:219], v9 offset:8704
    buffer_load_dwordx4 v3, s[20:23], s62 offen lds
    v_mfma_f32_16x16x32_bf16 v[52:55], v[200:203], a[12:15], 0
    s_movk_i32 s62, 384
    s_add_u32 m0, s39, 50176
    v_mfma_f32_16x16x32_bf16 v[56:59], v[204:207], a[0:3], 0
    ds_read_b64_tr_b16 v[220:221], v11 offset:8192
    buffer_load_dwordx4 v4, s[20:23], s62 offen lds
    v_mfma_f32_16x16x32_bf16 v[60:63], v[204:207], a[4:7], 0
    s_movk_i32 s62, 18816
    s_add_u32 m0, s39, 51200
    v_mfma_f32_16x16x32_bf16 v[64:67], v[204:207], a[8:11], 0
    ds_read_b64_tr_b16 v[222:223], v11 offset:8704
    buffer_load_dwordx4 v3, s[20:23], s62 offen lds
    v_mfma_f32_16x16x32_bf16 v[68:71], v[204:207], a[12:15], 0
    s_waitcnt vmcnt(7) lgkmcnt(4)
    s_barrier
    v_mfma_f32_16x16x32_bf16 v[72:75], v[208:211], a[0:3], 0
    ds_read_b64_tr_b16 v[200:201], v9 offset:12288
    s_add_u32 m0, s35, 28672
    v_mfma_f32_16x16x32_bf16 v[76:79], v[208:211], a[4:7], 0
    ds_read_b128 a[32:35], v5 offset:16384
    buffer_load_dwordx4 v1, s[12:15], s67 offen lds
    v_mfma_f32_16x16x32_bf16 v[80:83], v[208:211], a[8:11], 0
    ds_read_b64_tr_b16 v[202:203], v9 offset:12800
    s_add_u32 m0, s35, 32768
    v_mfma_f32_16x16x32_bf16 v[84:87], v[208:211], a[12:15], 0
    ds_read_b128 a[36:39], v5 offset:18432
    buffer_load_dwordx4 v1, s[8:11], s68 offen lds
    v_mfma_f32_16x16x32_bf16 v[88:91], v[212:215], a[0:3], 0
    ds_read_b64_tr_b16 v[204:205], v11 offset:12288
    s_add_u32 m0, s35, 36864
    v_mfma_f32_16x16x32_bf16 v[92:95], v[212:215], a[4:7], 0
    ds_read_b128 a[40:43], v5 offset:20480
    buffer_load_dwordx4 v1, s[12:15], s68 offen lds
    v_mfma_f32_16x16x32_bf16 v[96:99], v[212:215], a[8:11], 0
    ds_read_b64_tr_b16 v[206:207], v11 offset:12800
    v_mfma_f32_16x16x32_bf16 v[100:103], v[212:215], a[12:15], 0
    ds_read_b128 a[44:47], v5 offset:22528
    s_waitcnt lgkmcnt(8)
    v_mfma_f32_16x16x32_bf16 v[40:43], v[216:219], a[16:19], v[40:43]
    ds_read_b64_tr_b16 v[208:209], v9 offset:16384
    s_add_u32 m0, s35, 40960
    v_mfma_f32_16x16x32_bf16 v[44:47], v[216:219], a[20:23], v[44:47]
    ds_read_b128 a[48:51], v6 offset:16384
    buffer_load_dwordx4 v1, s[8:11], s69 offen lds
    v_mfma_f32_16x16x32_bf16 v[48:51], v[216:219], a[24:27], v[48:51]
    ds_read_b64_tr_b16 v[210:211], v9 offset:16896
    s_movk_i32 s62, 18816
    v_mfma_f32_16x16x32_bf16 v[52:55], v[216:219], a[28:31], v[52:55]
    ds_read_b128 a[52:55], v6 offset:18432
    s_add_u32 m0, s39, 52224
    v_mfma_f32_16x16x32_bf16 v[56:59], v[220:223], a[16:19], v[56:59]
    ds_read_b64_tr_b16 v[212:213], v11 offset:16384
    buffer_load_dwordx4 v4, s[20:23], s62 offen lds
    v_mfma_f32_16x16x32_bf16 v[60:63], v[220:223], a[20:23], v[60:63]
    ds_read_b128 a[56:59], v6 offset:20480
    s_movk_i32 s62, 512
    v_mfma_f32_16x16x32_bf16 v[64:67], v[220:223], a[24:27], v[64:67]
    ds_read_b64_tr_b16 v[214:215], v11 offset:16896
    s_add_u32 m0, s39, 0
    v_mfma_f32_16x16x32_bf16 v[68:71], v[220:223], a[28:31], v[68:71]
    ds_read_b128 a[60:63], v6 offset:22528
    s_waitcnt lgkmcnt(9)
    v_mfma_f32_16x16x32_bf16 v[72:75], v[200:203], a[16:19], v[72:75]
    ds_read_b64_tr_b16 v[216:217], v9 offset:20480
    buffer_load_dwordx4 v3, s[20:23], s62 offen lds
    v_mfma_f32_16x16x32_bf16 v[76:79], v[200:203], a[20:23], v[76:79]
    s_movk_i32 s62, 512
    s_add_u32 m0, s39, 1024
    v_mfma_f32_16x16x32_bf16 v[80:83], v[200:203], a[24:27], v[80:83]
    ds_read_b64_tr_b16 v[218:219], v9 offset:20992
    buffer_load_dwordx4 v4, s[20:23], s62 offen lds
    v_mfma_f32_16x16x32_bf16 v[84:87], v[200:203], a[28:31], v[84:87]
    s_movk_i32 s62, 18944
    s_add_u32 m0, s39, 2048
    v_mfma_f32_16x16x32_bf16 v[88:91], v[204:207], a[16:19], v[88:91]
    ds_read_b64_tr_b16 v[220:221], v11 offset:20480
    buffer_load_dwordx4 v3, s[20:23], s62 offen lds
    v_mfma_f32_16x16x32_bf16 v[92:95], v[204:207], a[20:23], v[92:95]
    v_mfma_f32_16x16x32_bf16 v[96:99], v[204:207], a[24:27], v[96:99]
    ds_read_b64_tr_b16 v[222:223], v11 offset:20992
    v_mfma_f32_16x16x32_bf16 v[100:103], v[204:207], a[28:31], v[100:103]
    s_waitcnt lgkmcnt(4)
    v_mfma_f32_16x16x32_bf16 v[40:43], v[208:211], a[32:35], v[40:43]
    ds_read_b64_tr_b16 v[200:201], v9 offset:24576
    s_movk_i32 s62, 18944
    v_mfma_f32_16x16x32_bf16 v[44:47], v[208:211], a[36:39], v[44:47]
    s_add_u32 m0, s39, 3072
    v_mfma_f32_16x16x32_bf16 v[48:51], v[208:211], a[40:43], v[48:51]
    ds_read_b64_tr_b16 v[202:203], v9 offset:25088
    buffer_load_dwordx4 v4, s[20:23], s62 offen lds
    v_mfma_f32_16x16x32_bf16 v[52:55], v[208:211], a[44:47], v[52:55]
    s_add_u32 m0, s35, 45056
    v_mfma_f32_16x16x32_bf16 v[56:59], v[212:215], a[32:35], v[56:59]
    ds_read_b64_tr_b16 v[204:205], v11 offset:24576
    buffer_load_dwordx4 v1, s[12:15], s69 offen lds
    v_mfma_f32_16x16x32_bf16 v[60:63], v[212:215], a[36:39], v[60:63]
    s_add_u32 m0, s35, 49152
    v_mfma_f32_16x16x32_bf16 v[64:67], v[212:215], a[40:43], v[64:67]
    ds_read_b64_tr_b16 v[206:207], v11 offset:25088
    buffer_load_dwordx4 v1, s[8:11], s70 offen lds
    v_mfma_f32_16x16x32_bf16 v[68:71], v[212:215], a[44:47], v[68:71]
    s_waitcnt vmcnt(7) lgkmcnt(4)
    s_barrier
    v_mfma_f32_16x16x32_bf16 v[72:75], v[216:219], a[32:35], v[72:75]
    ds_read_b64_tr_b16 v[208:209], v9 offset:28672
    s_add_u32 m0, s35, 53248
    v_mfma_f32_16x16x32_bf16 v[76:79], v[216:219], a[36:39], v[76:79]
    ds_read_b128 a[64:67], v5 offset:32768
    buffer_load_dwordx4 v1, s[12:15], s70 offen lds
    v_mfma_f32_16x16x32_bf16 v[80:83], v[216:219], a[40:43], v[80:83]
    ds_read_b64_tr_b16 v[210:211], v9 offset:29184
    s_add_u32 m0, s35, 57344
    v_mfma_f32_16x16x32_bf16 v[84:87], v[216:219], a[44:47], v[84:87]
    ds_read_b128 a[68:71], v5 offset:34816
    buffer_load_dwordx4 v1, s[8:11], s71 offen lds
    v_mfma_f32_16x16x32_bf16 v[88:91], v[220:223], a[32:35], v[88:91]
    ds_read_b64_tr_b16 v[212:213], v11 offset:28672
    s_movk_i32 s62, 640
    v_mfma_f32_16x16x32_bf16 v[92:95], v[220:223], a[36:39], v[92:95]
    ds_read_b128 a[72:75], v5 offset:36864
    s_add_u32 m0, s39, 16384
    v_mfma_f32_16x16x32_bf16 v[96:99], v[220:223], a[40:43], v[96:99]
    ds_read_b64_tr_b16 v[214:215], v11 offset:29184
    buffer_load_dwordx4 v3, s[20:23], s62 offen lds
    v_mfma_f32_16x16x32_bf16 v[100:103], v[220:223], a[44:47], v[100:103]
    ds_read_b128 a[76:79], v5 offset:38912
    s_waitcnt lgkmcnt(8)
    v_mfma_f32_16x16x32_bf16 v[40:43], v[200:203], a[48:51], v[40:43]
    ds_read_b64_tr_b16 v[216:217], v9 offset:32768
    s_movk_i32 s62, 640
    v_mfma_f32_16x16x32_bf16 v[44:47], v[200:203], a[52:55], v[44:47]
    ds_read_b128 a[80:83], v6 offset:32768
    s_add_u32 m0, s39, 17408
    v_mfma_f32_16x16x32_bf16 v[48:51], v[200:203], a[56:59], v[48:51]
    ds_read_b64_tr_b16 v[218:219], v9 offset:33280
    buffer_load_dwordx4 v4, s[20:23], s62 offen lds
    v_mfma_f32_16x16x32_bf16 v[52:55], v[200:203], a[60:63], v[52:55]
    ds_read_b128 a[84:87], v6 offset:34816
    s_movk_i32 s62, 19072
    v_mfma_f32_16x16x32_bf16 v[56:59], v[204:207], a[48:51], v[56:59]
    ds_read_b64_tr_b16 v[220:221], v11 offset:32768
    s_add_u32 m0, s39, 18432
    v_mfma_f32_16x16x32_bf16 v[60:63], v[204:207], a[52:55], v[60:63]
    ds_read_b128 a[88:91], v6 offset:36864
    buffer_load_dwordx4 v3, s[20:23], s62 offen lds
    v_mfma_f32_16x16x32_bf16 v[64:67], v[204:207], a[56:59], v[64:67]
    ds_read_b64_tr_b16 v[222:223], v11 offset:33280
    s_movk_i32 s62, 19072
    v_mfma_f32_16x16x32_bf16 v[68:71], v[204:207], a[60:63], v[68:71]
    ds_read_b128 a[92:95], v6 offset:38912
    s_waitcnt lgkmcnt(9)
    v_mfma_f32_16x16x32_bf16 v[72:75], v[208:211], a[48:51], v[72:75]
    ds_read_b64_tr_b16 v[200:201], v9 offset:36864
    s_add_u32 m0, s39, 19456
    v_mfma_f32_16x16x32_bf16 v[76:79], v[208:211], a[52:55], v[76:79]
    buffer_load_dwordx4 v4, s[20:23], s62 offen lds
    v_mfma_f32_16x16x32_bf16 v[80:83], v[208:211], a[56:59], v[80:83]
    ds_read_b64_tr_b16 v[202:203], v9 offset:37376
    s_add_u32 m0, s35, 61440
    v_mfma_f32_16x16x32_bf16 v[84:87], v[208:211], a[60:63], v[84:87]
    buffer_load_dwordx4 v1, s[12:15], s71 offen lds
    v_mfma_f32_16x16x32_bf16 v[88:91], v[212:215], a[48:51], v[88:91]
    ds_read_b64_tr_b16 v[204:205], v11 offset:36864
    s_add_u32 m0, s35, 65536
    v_mfma_f32_16x16x32_bf16 v[92:95], v[212:215], a[52:55], v[92:95]
    buffer_load_dwordx4 v1, s[8:11], s72 offen lds
    v_mfma_f32_16x16x32_bf16 v[96:99], v[212:215], a[56:59], v[96:99]
    ds_read_b64_tr_b16 v[206:207], v11 offset:37376
    v_mfma_f32_16x16x32_bf16 v[100:103], v[212:215], a[60:63], v[100:103]
    s_waitcnt lgkmcnt(4)
    v_mfma_f32_16x16x32_bf16 v[40:43], v[216:219], a[64:67], v[40:43]
    ds_read_b64_tr_b16 v[208:209], v9 offset:40960
    s_add_u32 m0, s35, 69632
    v_mfma_f32_16x16x32_bf16 v[44:47], v[216:219], a[68:71], v[44:47]
    buffer_load_dwordx4 v1, s[12:15], s72 offen lds
    v_mfma_f32_16x16x32_bf16 v[48:51], v[216:219], a[72:75], v[48:51]
    ds_read_b64_tr_b16 v[210:211], v9 offset:41472
    s_add_u32 m0, s35, 73728
    v_mfma_f32_16x16x32_bf16 v[52:55], v[216:219], a[76:79], v[52:55]
    buffer_load_dwordx4 v1, s[8:11], s73 offen lds
    v_mfma_f32_16x16x32_bf16 v[56:59], v[220:223], a[64:67], v[56:59]
    ds_read_b64_tr_b16 v[212:213], v11 offset:40960
    s_add_u32 m0, s35, 77824
    v_mfma_f32_16x16x32_bf16 v[60:63], v[220:223], a[68:71], v[60:63]
    buffer_load_dwordx4 v1, s[12:15], s73 offen lds
    v_mfma_f32_16x16x32_bf16 v[64:67], v[220:223], a[72:75], v[64:67]
    ds_read_b64_tr_b16 v[214:215], v11 offset:41472
    v_mfma_f32_16x16x32_bf16 v[68:71], v[220:223], a[76:79], v[68:71]
    s_waitcnt vmcnt(9) lgkmcnt(4)
    s_barrier
    v_mfma_f32_16x16x32_bf16 v[72:75], v[200:203], a[64:67], v[72:75]
    ds_read_b64_tr_b16 v[216:217], v9 offset:45056
    s_movk_i32 s62, 768
    v_mfma_f32_16x16x32_bf16 v[76:79], v[200:203], a[68:71], v[76:79]
    ds_read_b128 a[96:99], v5 offset:49152
    s_add_u32 m0, s39, 32768
    v_mfma_f32_16x16x32_bf16 v[80:83], v[200:203], a[72:75], v[80:83]
    ds_read_b64_tr_b16 v[218:219], v9 offset:45568
    buffer_load_dwordx4 v3, s[20:23], s62 offen lds
    v_mfma_f32_16x16x32_bf16 v[84:87], v[200:203], a[76:79], v[84:87]
    ds_read_b128 a[100:103], v5 offset:51200
    s_movk_i32 s62, 768
    v_mfma_f32_16x16x32_bf16 v[88:91], v[204:207], a[64:67], v[88:91]
    ds_read_b64_tr_b16 v[220:221], v11 offset:45056
    s_add_u32 m0, s39, 33792
    v_mfma_f32_16x16x32_bf16 v[92:95], v[204:207], a[68:71], v[92:95]
    ds_read_b128 a[104:107], v5 offset:53248
    buffer_load_dwordx4 v4, s[20:23], s62 offen lds
    v_mfma_f32_16x16x32_bf16 v[96:99], v[204:207], a[72:75], v[96:99]
    ds_read_b64_tr_b16 v[222:223], v11 offset:45568
    s_movk_i32 s62, 19200
    v_mfma_f32_16x16x32_bf16 v[100:103], v[204:207], a[76:79], v[100:103]
    ds_read_b128 a[108:111], v5 offset:55296
    s_waitcnt lgkmcnt(8)
    v_mfma_f32_16x16x32_bf16 v[40:43], v[208:211], a[80:83], v[40:43]
    ds_read_b64_tr_b16 v[200:201], v9 offset:49152
    s_add_u32 m0, s39, 34816
    v_mfma_f32_16x16x32_bf16 v[44:47], v[208:211], a[84:87], v[44:47]
    ds_read_b128 a[112:115], v6 offset:49152
    buffer_load_dwordx4 v3, s[20:23], s62 offen lds
    v_mfma_f32_16x16x32_bf16 v[48:51], v[208:211], a[88:91], v[48:51]
    ds_read_b64_tr_b16 v[202:203], v9 offset:49664
    s_movk_i32 s62, 19200
    v_mfma_f32_16x16x32_bf16 v[52:55], v[208:211], a[92:95], v[52:55]
    ds_read_b128 a[116:119], v6 offset:51200
    s_add_u32 m0, s39, 35840
    v_mfma_f32_16x16x32_bf16 v[56:59], v[212:215], a[80:83], v[56:59]
    ds_read_b64_tr_b16 v[204:205], v11 offset:49152
    buffer_load_dwordx4 v4, s[20:23], s62 offen lds
    v_mfma_f32_16x16x32_bf16 v[60:63], v[212:215], a[84:87], v[60:63]
    ds_read_b128 a[120:123], v6 offset:53248
    s_add_u32 m0, s35, 81920
    v_mfma_f32_16x16x32_bf16 v[64:67], v[212:215], a[88:91], v[64:67]
    ds_read_b64_tr_b16 v[206:207], v11 offset:49664
    buffer_load_dwordx4 v1, s[8:11], s74 offen lds
    v_mfma_f32_16x16x32_bf16 v[68:71], v[212:215], a[92:95], v[68:71]
    ds_read_b128 a[124:127], v6 offset:55296
    s_waitcnt lgkmcnt(9)
    v_mfma_f32_16x16x32_bf16 v[72:75], v[216:219], a[80:83], v[72:75]
    ds_read_b64_tr_b16 v[208:209], v9 offset:53248
    s_add_u32 m0, s35, 0
    v_mfma_f32_16x16x32_bf16 v[76:79], v[216:219], a[84:87], v[76:79]
    buffer_load_dwordx4 v1, s[12:15], s74 offen lds
    v_mfma_f32_16x16x32_bf16 v[80:83], v[216:219], a[88:91], v[80:83]
    ds_read_b64_tr_b16 v[210:211], v9 offset:53760
    s_add_u32 m0, s35, 4096
    v_mfma_f32_16x16x32_bf16 v[84:87], v[216:219], a[92:95], v[84:87]
    buffer_load_dwordx4 v1, s[8:11], s75 offen lds
    v_mfma_f32_16x16x32_bf16 v[88:91], v[220:223], a[80:83], v[88:91]
    ds_read_b64_tr_b16 v[212:213], v11 offset:53248
    v_mfma_f32_16x16x32_bf16 v[92:95], v[220:223], a[84:87], v[92:95]
    v_mfma_f32_16x16x32_bf16 v[96:99], v[220:223], a[88:91], v[96:99]
    ds_read_b64_tr_b16 v[214:215], v11 offset:53760
    v_mfma_f32_16x16x32_bf16 v[100:103], v[220:223], a[92:95], v[100:103]
    s_waitcnt lgkmcnt(4)
    v_mfma_f32_16x16x32_bf16 v[40:43], v[200:203], a[96:99], v[40:43]
    ds_read_b64_tr_b16 v[216:217], v9 offset:57344
    s_add_u32 m0, s35, 8192
    v_mfma_f32_16x16x32_bf16 v[44:47], v[200:203], a[100:103], v[44:47]
    buffer_load_dwordx4 v1, s[12:15], s75 offen lds
    v_mfma_f32_16x16x32_bf16 v[48:51], v[200:203], a[104:107], v[48:51]
    ds_read_b64_tr_b16 v[218:219], v9 offset:57856
    v_mfma_f32_16x16x32_bf16 v[52:55], v[200:203], a[108:111], v[52:55]
    v_mfma_f32_16x16x32_bf16 v[56:59], v[204:207], a[96:99], v[56:59]
    ds_read_b64_tr_b16 v[220:221], v11 offset:57344
    v_mfma_f32_16x16x32_bf16 v[60:63], v[204:207], a[100:103], v[60:63]
    v_mfma_f32_16x16x32_bf16 v[64:67], v[204:207], a[104:107], v[64:67]
    ds_read_b64_tr_b16 v[222:223], v11 offset:57856
    v_mfma_f32_16x16x32_bf16 v[68:71], v[204:207], a[108:111], v[68:71]
    s_waitcnt vmcnt(9) lgkmcnt(4)
    s_barrier
    v_mfma_f32_16x16x32_bf16 v[72:75], v[208:211], a[96:99], v[72:75]
    ds_read_b64_tr_b16 v[200:201], v9 offset:61440
    s_movk_i32 s62, 896
    v_mfma_f32_16x16x32_bf16 v[76:79], v[208:211], a[100:103], v[76:79]
    ds_read_b128 a[128:131], v5 offset:0
    s_add_u32 m0, s39, 49152
    v_mfma_f32_16x16x32_bf16 v[80:83], v[208:211], a[104:107], v[80:83]
    ds_read_b64_tr_b16 v[202:203], v9 offset:61952
    buffer_load_dwordx4 v3, s[20:23], s62 offen lds
    v_mfma_f32_16x16x32_bf16 v[84:87], v[208:211], a[108:111], v[84:87]
    ds_read_b128 a[132:135], v5 offset:2048
    s_movk_i32 s62, 896
    v_mfma_f32_16x16x32_bf16 v[88:91], v[212:215], a[96:99], v[88:91]
    ds_read_b64_tr_b16 v[204:205], v11 offset:61440
    s_add_u32 m0, s39, 50176
    v_mfma_f32_16x16x32_bf16 v[92:95], v[212:215], a[100:103], v[92:95]
    ds_read_b128 a[136:139], v5 offset:4096
    buffer_load_dwordx4 v4, s[20:23], s62 offen lds
    v_mfma_f32_16x16x32_bf16 v[96:99], v[212:215], a[104:107], v[96:99]
    ds_read_b64_tr_b16 v[206:207], v11 offset:61952
    s_movk_i32 s62, 19328
    v_mfma_f32_16x16x32_bf16 v[100:103], v[212:215], a[108:111], v[100:103]
    ds_read_b128 a[140:143], v5 offset:6144
    s_waitcnt lgkmcnt(8)
    v_mfma_f32_16x16x32_bf16 v[40:43], v[216:219], a[112:115], v[40:43]
    ds_read_b64_tr_b16 v[208:209], v10 offset:0
    s_add_u32 m0, s39, 51200
    v_mfma_f32_16x16x32_bf16 v[44:47], v[216:219], a[116:119], v[44:47]
    ds_read_b128 a[144:147], v6 offset:0
    buffer_load_dwordx4 v3, s[20:23], s62 offen lds
    v_mfma_f32_16x16x32_bf16 v[48:51], v[216:219], a[120:123], v[48:51]
    ds_read_b64_tr_b16 v[210:211], v10 offset:512
    s_movk_i32 s62, 19328
    v_mfma_f32_16x16x32_bf16 v[52:55], v[216:219], a[124:127], v[52:55]
    ds_read_b128 a[148:151], v6 offset:2048
    s_add_u32 m0, s39, 52224
    v_mfma_f32_16x16x32_bf16 v[56:59], v[220:223], a[112:115], v[56:59]
    ds_read_b64_tr_b16 v[212:213], v12 offset:0
    buffer_load_dwordx4 v4, s[20:23], s62 offen lds
    v_mfma_f32_16x16x32_bf16 v[60:63], v[220:223], a[116:119], v[60:63]
    ds_read_b128 a[152:155], v6 offset:4096
    s_add_u32 m0, s35, 12288
    v_mfma_f32_16x16x32_bf16 v[64:67], v[220:223], a[120:123], v[64:67]
    ds_read_b64_tr_b16 v[214:215], v12 offset:512
    buffer_load_dwordx4 v1, s[8:11], s76 offen lds
    v_mfma_f32_16x16x32_bf16 v[68:71], v[220:223], a[124:127], v[68:71]
    ds_read_b128 a[156:159], v6 offset:6144
    s_waitcnt lgkmcnt(9)
    v_mfma_f32_16x16x32_bf16 v[72:75], v[200:203], a[112:115], v[72:75]
    ds_read_b64_tr_b16 v[216:217], v10 offset:4096
    s_add_u32 m0, s35, 16384
    v_mfma_f32_16x16x32_bf16 v[76:79], v[200:203], a[116:119], v[76:79]
    buffer_load_dwordx4 v1, s[12:15], s76 offen lds
    v_mfma_f32_16x16x32_bf16 v[80:83], v[200:203], a[120:123], v[80:83]
    ds_read_b64_tr_b16 v[218:219], v10 offset:4608
    s_add_u32 m0, s35, 20480
    v_mfma_f32_16x16x32_bf16 v[84:87], v[200:203], a[124:127], v[84:87]
    buffer_load_dwordx4 v1, s[8:11], s77 offen lds
    v_mfma_f32_16x16x32_bf16 v[88:91], v[204:207], a[112:115], v[88:91]
    ds_read_b64_tr_b16 v[220:221], v12 offset:4096
    v_mfma_f32_16x16x32_bf16 v[92:95], v[204:207], a[116:119], v[92:95]
    v_mfma_f32_16x16x32_bf16 v[96:99], v[204:207], a[120:123], v[96:99]
    ds_read_b64_tr_b16 v[222:223], v12 offset:4608
    v_mfma_f32_16x16x32_bf16 v[100:103], v[204:207], a[124:127], v[100:103]
    s_waitcnt lgkmcnt(4)
    v_mfma_f32_16x16x32_bf16 v[40:43], v[208:211], a[128:131], v[40:43]
    ds_read_b64_tr_b16 v[200:201], v10 offset:8192
    s_add_u32 m0, s35, 24576
    v_mfma_f32_16x16x32_bf16 v[44:47], v[208:211], a[132:135], v[44:47]
    buffer_load_dwordx4 v1, s[12:15], s77 offen lds
    v_mfma_f32_16x16x32_bf16 v[48:51], v[208:211], a[136:139], v[48:51]
    ds_read_b64_tr_b16 v[202:203], v10 offset:8704
    v_mfma_f32_16x16x32_bf16 v[52:55], v[208:211], a[140:143], v[52:55]
    v_mfma_f32_16x16x32_bf16 v[56:59], v[212:215], a[128:131], v[56:59]
    ds_read_b64_tr_b16 v[204:205], v12 offset:8192
    v_mfma_f32_16x16x32_bf16 v[60:63], v[212:215], a[132:135], v[60:63]
    v_mfma_f32_16x16x32_bf16 v[64:67], v[212:215], a[136:139], v[64:67]
    ds_read_b64_tr_b16 v[206:207], v12 offset:8704
    v_mfma_f32_16x16x32_bf16 v[68:71], v[212:215], a[140:143], v[68:71]
    s_waitcnt vmcnt(9) lgkmcnt(4)
    s_barrier
    v_mfma_f32_16x16x32_bf16 v[72:75], v[216:219], a[128:131], v[72:75]
    ds_read_b64_tr_b16 v[208:209], v10 offset:12288
    s_movk_i32 s62, 1024
    v_mfma_f32_16x16x32_bf16 v[76:79], v[216:219], a[132:135], v[76:79]
    ds_read_b128 a[160:163], v5 offset:16384
    s_add_u32 m0, s39, 0
    v_mfma_f32_16x16x32_bf16 v[80:83], v[216:219], a[136:139], v[80:83]
    ds_read_b64_tr_b16 v[210:211], v10 offset:12800
    buffer_load_dwordx4 v3, s[20:23], s62 offen lds
    v_mfma_f32_16x16x32_bf16 v[84:87], v[216:219], a[140:143], v[84:87]
    ds_read_b128 a[164:167], v5 offset:18432
    s_movk_i32 s62, 1024
    v_mfma_f32_16x16x32_bf16 v[88:91], v[220:223], a[128:131], v[88:91]
    ds_read_b64_tr_b16 v[212:213], v12 offset:12288
    s_add_u32 m0, s39, 1024
    v_mfma_f32_16x16x32_bf16 v[92:95], v[220:223], a[132:135], v[92:95]
    ds_read_b128 a[168:171], v5 offset:20480
    buffer_load_dwordx4 v4, s[20:23], s62 offen lds
    v_mfma_f32_16x16x32_bf16 v[96:99], v[220:223], a[136:139], v[96:99]
    ds_read_b64_tr_b16 v[214:215], v12 offset:12800
    s_movk_i32 s62, 19456
    v_mfma_f32_16x16x32_bf16 v[100:103], v[220:223], a[140:143], v[100:103]
    ds_read_b128 a[172:175], v5 offset:22528
    s_waitcnt lgkmcnt(8)
    v_mfma_f32_16x16x32_bf16 v[40:43], v[200:203], a[144:147], v[40:43]
    ds_read_b64_tr_b16 v[216:217], v10 offset:16384
    s_add_u32 m0, s39, 2048
    v_mfma_f32_16x16x32_bf16 v[44:47], v[200:203], a[148:151], v[44:47]
    ds_read_b128 a[176:179], v6 offset:16384
    buffer_load_dwordx4 v3, s[20:23], s62 offen lds
    v_mfma_f32_16x16x32_bf16 v[48:51], v[200:203], a[152:155], v[48:51]
    ds_read_b64_tr_b16 v[218:219], v10 offset:16896
    s_movk_i32 s62, 19456
    v_mfma_f32_16x16x32_bf16 v[52:55], v[200:203], a[156:159], v[52:55]
    ds_read_b128 a[180:183], v6 offset:18432
    s_add_u32 m0, s39, 3072
    v_mfma_f32_16x16x32_bf16 v[56:59], v[204:207], a[144:147], v[56:59]
    ds_read_b64_tr_b16 v[220:221], v12 offset:16384
    buffer_load_dwordx4 v4, s[20:23], s62 offen lds
    v_mfma_f32_16x16x32_bf16 v[60:63], v[204:207], a[148:151], v[60:63]
    ds_read_b128 a[184:187], v6 offset:20480
    s_add_u32 m0, s35, 28672
    v_mfma_f32_16x16x32_bf16 v[64:67], v[204:207], a[152:155], v[64:67]
    ds_read_b64_tr_b16 v[222:223], v12 offset:16896
    buffer_load_dwordx4 v1, s[8:11], s78 offen lds
    v_mfma_f32_16x16x32_bf16 v[68:71], v[204:207], a[156:159], v[68:71]
    ds_read_b128 a[188:191], v6 offset:22528
    s_waitcnt lgkmcnt(9)
    v_mfma_f32_16x16x32_bf16 v[72:75], v[208:211], a[144:147], v[72:75]
    ds_read_b64_tr_b16 v[200:201], v9 offset:0
    s_add_u32 m0, s35, 32768
    v_mfma_f32_16x16x32_bf16 v[76:79], v[208:211], a[148:151], v[76:79]
    buffer_load_dwordx4 v1, s[12:15], s78 offen lds
    v_mfma_f32_16x16x32_bf16 v[80:83], v[208:211], a[152:155], v[80:83]
    ds_read_b64_tr_b16 v[202:203], v9 offset:512
    s_add_u32 m0, s35, 36864
    v_mfma_f32_16x16x32_bf16 v[84:87], v[208:211], a[156:159], v[84:87]
    buffer_load_dwordx4 v1, s[8:11], s79 offen lds
    v_mfma_f32_16x16x32_bf16 v[88:91], v[212:215], a[144:147], v[88:91]
    ds_read_b64_tr_b16 v[204:205], v11 offset:0
    v_mfma_f32_16x16x32_bf16 v[92:95], v[212:215], a[148:151], v[92:95]
    v_mfma_f32_16x16x32_bf16 v[96:99], v[212:215], a[152:155], v[96:99]
    ds_read_b64_tr_b16 v[206:207], v11 offset:512
    v_mfma_f32_16x16x32_bf16 v[100:103], v[212:215], a[156:159], v[100:103]
    s_waitcnt lgkmcnt(4)
    v_mfma_f32_16x16x32_bf16 v[40:43], v[216:219], a[160:163], v[40:43]
    ds_read_b64_tr_b16 v[208:209], v9 offset:4096
    s_add_u32 m0, s35, 40960
    v_mfma_f32_16x16x32_bf16 v[44:47], v[216:219], a[164:167], v[44:47]
    buffer_load_dwordx4 v1, s[12:15], s79 offen lds
    v_mfma_f32_16x16x32_bf16 v[48:51], v[216:219], a[168:171], v[48:51]
    ds_read_b64_tr_b16 v[210:211], v9 offset:4608
    v_mfma_f32_16x16x32_bf16 v[52:55], v[216:219], a[172:175], v[52:55]
    v_mfma_f32_16x16x32_bf16 v[56:59], v[220:223], a[160:163], v[56:59]
    ds_read_b64_tr_b16 v[212:213], v11 offset:4096
    v_mfma_f32_16x16x32_bf16 v[60:63], v[220:223], a[164:167], v[60:63]
    v_mfma_f32_16x16x32_bf16 v[64:67], v[220:223], a[168:171], v[64:67]
    ds_read_b64_tr_b16 v[214:215], v11 offset:4608
    v_mfma_f32_16x16x32_bf16 v[68:71], v[220:223], a[172:175], v[68:71]
    s_waitcnt vmcnt(9) lgkmcnt(4)
    s_barrier
    v_mfma_f32_16x16x32_bf16 v[72:75], v[200:203], a[160:163], v[72:75]
    ds_read_b64_tr_b16 v[216:217], v9 offset:8192
    s_add_u32 m0, s35, 45056
    v_mfma_f32_16x16x32_bf16 v[76:79], v[200:203], a[164:167], v[76:79]
    ds_read_b128 a[192:195], v5 offset:32768
    buffer_load_dwordx4 v1, s[8:11], s80 offen lds
    v_mfma_f32_16x16x32_bf16 v[80:83], v[200:203], a[168:171], v[80:83]
    ds_read_b64_tr_b16 v[218:219], v9 offset:8704
    v_mfma_f32_16x16x32_bf16 v[84:87], v[200:203], a[172:175], v[84:87]
    ds_read_b128 a[196:199], v5 offset:34816
    v_mfma_f32_16x16x32_bf16 v[88:91], v[204:207], a[160:163], v[88:91]
    ds_read_b64_tr_b16 v[220:221], v11 offset:8192
    v_mfma_f32_16x16x32_bf16 v[92:95], v[204:207], a[164:167], v[92:95]
    ds_read_b128 a[200:203], v5 offset:36864
    v_mfma_f32_16x16x32_bf16 v[96:99], v[204:207], a[168:171], v[96:99]
    ds_read_b64_tr_b16 v[222:223], v11 offset:8704
    v_mfma_f32_16x16x32_bf16 v[100:103], v[204:207], a[172:175], v[100:103]
    ds_read_b128 a[204:207], v5 offset:38912
    s_waitcnt lgkmcnt(8)
    v_mfma_f32_16x16x32_bf16 v[40:43], v[208:211], a[176:179], v[40:43]
    ds_read_b64_tr_b16 v[200:201], v9 offset:12288
    s_add_u32 m0, s35, 49152
    v_mfma_f32_16x16x32_bf16 v[44:47], v[208:211], a[180:183], v[44:47]
    ds_read_b128 a[208:211], v6 offset:32768
    buffer_load_dwordx4 v1, s[12:15], s80 offen lds
    v_mfma_f32_16x16x32_bf16 v[48:51], v[208:211], a[184:187], v[48:51]
    ds_read_b64_tr_b16 v[202:203], v9 offset:12800
    v_mfma_f32_16x16x32_bf16 v[52:55], v[208:211], a[188:191], v[52:55]
    ds_read_b128 a[212:215], v6 offset:34816
    v_mfma_f32_16x16x32_bf16 v[56:59], v[212:215], a[176:179], v[56:59]
    ds_read_b64_tr_b16 v[204:205], v11 offset:12288
    v_mfma_f32_16x16x32_bf16 v[60:63], v[212:215], a[180:183], v[60:63]
    ds_read_b128 a[216:219], v6 offset:36864
    v_mfma_f32_16x16x32_bf16 v[64:67], v[212:215], a[184:187], v[64:67]
    ds_read_b64_tr_b16 v[206:207], v11 offset:12800
    v_mfma_f32_16x16x32_bf16 v[68:71], v[212:215], a[188:191], v[68:71]
    ds_read_b128 a[220:223], v6 offset:38912
    s_waitcnt lgkmcnt(9)
    v_mfma_f32_16x16x32_bf16 v[72:75], v[216:219], a[176:179], v[72:75]
    ds_read_b64_tr_b16 v[208:209], v9 offset:16384
    s_add_u32 m0, s35, 53248
    v_mfma_f32_16x16x32_bf16 v[76:79], v[216:219], a[180:183], v[76:79]
    buffer_load_dwordx4 v1, s[8:11], s81 offen lds
    v_mfma_f32_16x16x32_bf16 v[80:83], v[216:219], a[184:187], v[80:83]
    ds_read_b64_tr_b16 v[210:211], v9 offset:16896
    v_mfma_f32_16x16x32_bf16 v[84:87], v[216:219], a[188:191], v[84:87]
    v_mfma_f32_16x16x32_bf16 v[88:91], v[220:223], a[176:179], v[88:91]
    ds_read_b64_tr_b16 v[212:213], v11 offset:16384
    v_mfma_f32_16x16x32_bf16 v[92:95], v[220:223], a[180:183], v[92:95]
    v_mfma_f32_16x16x32_bf16 v[96:99], v[220:223], a[184:187], v[96:99]
    ds_read_b64_tr_b16 v[214:215], v11 offset:16896
    v_mfma_f32_16x16x32_bf16 v[100:103], v[220:223], a[188:191], v[100:103]
    s_waitcnt lgkmcnt(4)
    v_mfma_f32_16x16x32_bf16 v[40:43], v[200:203], a[192:195], v[40:43]
    ds_read_b64_tr_b16 v[216:217], v9 offset:20480
    s_add_u32 m0, s35, 57344
    v_mfma_f32_16x16x32_bf16 v[44:47], v[200:203], a[196:199], v[44:47]
    buffer_load_dwordx4 v1, s[12:15], s81 offen lds
    v_mfma_f32_16x16x32_bf16 v[48:51], v[200:203], a[200:203], v[48:51]
    ds_read_b64_tr_b16 v[218:219], v9 offset:20992
    v_mfma_f32_16x16x32_bf16 v[52:55], v[200:203], a[204:207], v[52:55]
    v_mfma_f32_16x16x32_bf16 v[56:59], v[204:207], a[192:195], v[56:59]
    ds_read_b64_tr_b16 v[220:221], v11 offset:20480
    v_mfma_f32_16x16x32_bf16 v[60:63], v[204:207], a[196:199], v[60:63]
    v_mfma_f32_16x16x32_bf16 v[64:67], v[204:207], a[200:203], v[64:67]
    ds_read_b64_tr_b16 v[222:223], v11 offset:20992
    v_mfma_f32_16x16x32_bf16 v[68:71], v[204:207], a[204:207], v[68:71]
    s_waitcnt vmcnt(5) lgkmcnt(4)
    s_barrier
    v_mfma_f32_16x16x32_bf16 v[72:75], v[208:211], a[192:195], v[72:75]
    ds_read_b64_tr_b16 v[200:201], v9 offset:24576
    s_add_u32 s7, s7, 1
    v_mfma_f32_16x16x32_bf16 v[76:79], v[208:211], a[196:199], v[76:79]
    ds_read_b128 a[224:227], v5 offset:49152
    v_mfma_f32_16x16x32_bf16 v[80:83], v[208:211], a[200:203], v[80:83]
    ds_read_b64_tr_b16 v[202:203], v9 offset:25088
    v_mfma_f32_16x16x32_bf16 v[84:87], v[208:211], a[204:207], v[84:87]
    ds_read_b128 a[228:231], v5 offset:51200
    v_mfma_f32_16x16x32_bf16 v[88:91], v[212:215], a[192:195], v[88:91]
    ds_read_b64_tr_b16 v[204:205], v11 offset:24576
    v_mfma_f32_16x16x32_bf16 v[92:95], v[212:215], a[196:199], v[92:95]
    ds_read_b128 a[232:235], v5 offset:53248
    v_mfma_f32_16x16x32_bf16 v[96:99], v[212:215], a[200:203], v[96:99]
    ds_read_b64_tr_b16 v[206:207], v11 offset:25088
    v_mfma_f32_16x16x32_bf16 v[100:103], v[212:215], a[204:207], v[100:103]
    ds_read_b128 a[236:239], v5 offset:55296
    s_waitcnt lgkmcnt(8)
    v_mfma_f32_16x16x32_bf16 v[40:43], v[216:219], a[208:211], v[40:43]
    ds_read_b64_tr_b16 v[208:209], v9 offset:28672
    v_mfma_f32_16x16x32_bf16 v[44:47], v[216:219], a[212:215], v[44:47]
    ds_read_b128 a[240:243], v6 offset:49152
    v_mfma_f32_16x16x32_bf16 v[48:51], v[216:219], a[216:219], v[48:51]
    ds_read_b64_tr_b16 v[210:211], v9 offset:29184
    v_mfma_f32_16x16x32_bf16 v[52:55], v[216:219], a[220:223], v[52:55]
    ds_read_b128 a[244:247], v6 offset:51200
    v_mfma_f32_16x16x32_bf16 v[56:59], v[220:223], a[208:211], v[56:59]
    ds_read_b64_tr_b16 v[212:213], v11 offset:28672
    v_mfma_f32_16x16x32_bf16 v[60:63], v[220:223], a[212:215], v[60:63]
    ds_read_b128 a[248:251], v6 offset:53248
    v_mfma_f32_16x16x32_bf16 v[64:67], v[220:223], a[216:219], v[64:67]
    ds_read_b64_tr_b16 v[214:215], v11 offset:29184
    v_mfma_f32_16x16x32_bf16 v[68:71], v[220:223], a[220:223], v[68:71]
    ds_read_b128 a[252:255], v6 offset:55296
    s_waitcnt lgkmcnt(9)
    v_mfma_f32_16x16x32_bf16 v[72:75], v[200:203], a[208:211], v[72:75]
    ds_read_b64_tr_b16 v[216:217], v9 offset:32768
    v_mfma_f32_16x16x32_bf16 v[76:79], v[200:203], a[212:215], v[76:79]
    s_cmp_eq_u32 s7, 4
    s_cselect_b32 s100, s101, 0x80
    v_mfma_f32_16x16x32_bf16 v[80:83], v[200:203], a[216:219], v[80:83]
    ds_read_b64_tr_b16 v[218:219], v9 offset:33280
    v_add_u32 v1, s100, v1
    v_mfma_f32_16x16x32_bf16 v[84:87], v[200:203], a[220:223], v[84:87]
    s_add_u32 m0, s35, 61440
    v_mfma_f32_16x16x32_bf16 v[88:91], v[204:207], a[208:211], v[88:91]
    ds_read_b64_tr_b16 v[220:221], v11 offset:32768
    buffer_load_dwordx4 v1, s[8:11], s64 offen lds
    v_mfma_f32_16x16x32_bf16 v[92:95], v[204:207], a[212:215], v[92:95]
    s_add_u32 m0, s35, 65536
    v_mfma_f32_16x16x32_bf16 v[96:99], v[204:207], a[216:219], v[96:99]
    ds_read_b64_tr_b16 v[222:223], v11 offset:33280
    buffer_load_dwordx4 v1, s[12:15], s64 offen lds
    v_mfma_f32_16x16x32_bf16 v[100:103], v[204:207], a[220:223], v[100:103]
    s_add_u32 m0, s35, 69632
    s_waitcnt lgkmcnt(4)
    v_mfma_f32_16x16x32_bf16 v[40:43], v[208:211], a[224:227], v[40:43]
    ds_read_b64_tr_b16 v[200:201], v9 offset:36864
    buffer_load_dwordx4 v2, s[24:27], s64 offen lds
    v_mfma_f32_16x16x32_bf16 v[44:47], v[208:211], a[228:231], v[44:47]
    s_add_u32 m0, s35, 73728
    v_mfma_f32_16x16x32_bf16 v[48:51], v[208:211], a[232:235], v[48:51]
    ds_read_b64_tr_b16 v[202:203], v9 offset:37376
    buffer_load_dwordx4 v1, s[8:11], s65 offen lds
    v_mfma_f32_16x16x32_bf16 v[52:55], v[208:211], a[236:239], v[52:55]
    v_mfma_f32_16x16x32_bf16 v[56:59], v[212:215], a[224:227], v[56:59]
    ds_read_b64_tr_b16 v[204:205], v11 offset:36864
    v_mfma_f32_16x16x32_bf16 v[60:63], v[212:215], a[228:231], v[60:63]
    v_mfma_f32_16x16x32_bf16 v[64:67], v[212:215], a[232:235], v[64:67]
    ds_read_b64_tr_b16 v[206:207], v11 offset:37376
    v_mfma_f32_16x16x32_bf16 v[68:71], v[212:215], a[236:239], v[68:71]
    s_waitcnt vmcnt(5) lgkmcnt(4)
    s_barrier
    v_mfma_f32_16x16x32_bf16 v[72:75], v[216:219], a[224:227], v[72:75]
    ds_read_b64_tr_b16 v[208:209], v9 offset:40960
    s_add_u32 m0, s35, 77824
    v_mfma_f32_16x16x32_bf16 v[76:79], v[216:219], a[228:231], v[76:79]
    ds_read_b128 v[224:227], v5 offset:0
    buffer_load_dwordx4 v1, s[12:15], s65 offen lds
    v_mfma_f32_16x16x32_bf16 v[80:83], v[216:219], a[232:235], v[80:83]
    ds_read_b64_tr_b16 v[210:211], v9 offset:41472
    v_mfma_f32_16x16x32_bf16 v[84:87], v[216:219], a[236:239], v[84:87]
    ds_read_b128 v[228:231], v5 offset:2048
    v_mfma_f32_16x16x32_bf16 v[88:91], v[220:223], a[224:227], v[88:91]
    ds_read_b64_tr_b16 v[212:213], v11 offset:40960
    v_mfma_f32_16x16x32_bf16 v[92:95], v[220:223], a[228:231], v[92:95]
    ds_read_b128 v[232:235], v5 offset:4096
    v_mfma_f32_16x16x32_bf16 v[96:99], v[220:223], a[232:235], v[96:99]
    ds_read_b64_tr_b16 v[214:215], v11 offset:41472
    v_mfma_f32_16x16x32_bf16 v[100:103], v[220:223], a[236:239], v[100:103]
    ds_read_b128 v[236:239], v5 offset:6144
    s_waitcnt lgkmcnt(8)
    v_mfma_f32_16x16x32_bf16 v[40:43], v[200:203], a[240:243], v[40:43]
    ds_read_b64_tr_b16 v[216:217], v9 offset:45056
    s_add_u32 m0, s35, 81920
    v_mfma_f32_16x16x32_bf16 v[44:47], v[200:203], a[244:247], v[44:47]
    ds_read_b128 v[240:243], v6 offset:0
    buffer_load_dwordx4 v2, s[24:27], s65 offen lds
    v_mfma_f32_16x16x32_bf16 v[48:51], v[200:203], a[248:251], v[48:51]
    ds_read_b64_tr_b16 v[218:219], v9 offset:45568
    v_mfma_f32_16x16x32_bf16 v[52:55], v[200:203], a[252:255], v[52:55]
    ds_read_b128 v[244:247], v6 offset:2048
    v_mfma_f32_16x16x32_bf16 v[56:59], v[204:207], a[240:243], v[56:59]
    ds_read_b64_tr_b16 v[220:221], v11 offset:45056
    v_mfma_f32_16x16x32_bf16 v[60:63], v[204:207], a[244:247], v[60:63]
    ds_read_b128 v[248:251], v6 offset:4096
    v_mfma_f32_16x16x32_bf16 v[64:67], v[204:207], a[248:251], v[64:67]
    ds_read_b64_tr_b16 v[222:223], v11 offset:45568
    v_mfma_f32_16x16x32_bf16 v[68:71], v[204:207], a[252:255], v[68:71]
    ds_read_b128 v[252:255], v6 offset:6144
    s_waitcnt lgkmcnt(9)
    v_mfma_f32_16x16x32_bf16 v[72:75], v[208:211], a[240:243], v[72:75]
    ds_read_b64_tr_b16 v[200:201], v9 offset:49152
    s_add_u32 m0, s35, 0
    v_mfma_f32_16x16x32_bf16 v[76:79], v[208:211], a[244:247], v[76:79]
    buffer_load_dwordx4 v1, s[8:11], s66 offen lds
    v_mfma_f32_16x16x32_bf16 v[80:83], v[208:211], a[248:251], v[80:83]
    ds_read_b64_tr_b16 v[202:203], v9 offset:49664
    v_mfma_f32_16x16x32_bf16 v[84:87], v[208:211], a[252:255], v[84:87]
    v_mfma_f32_16x16x32_bf16 v[88:91], v[212:215], a[240:243], v[88:91]
    ds_read_b64_tr_b16 v[204:205], v11 offset:49152
    v_mfma_f32_16x16x32_bf16 v[92:95], v[212:215], a[244:247], v[92:95]
    v_mfma_f32_16x16x32_bf16 v[96:99], v[212:215], a[248:251], v[96:99]
    ds_read_b64_tr_b16 v[206:207], v11 offset:49664
    v_mfma_f32_16x16x32_bf16 v[100:103], v[212:215], a[252:255], v[100:103]
    s_waitcnt lgkmcnt(4)
    v_mfma_f32_16x16x32_bf16 v[40:43], v[216:219], v[224:227], v[40:43]
    ds_read_b64_tr_b16 v[208:209], v9 offset:53248
    s_add_u32 m0, s35, 4096
    v_mfma_f32_16x16x32_bf16 v[44:47], v[216:219], v[228:231], v[44:47]
    buffer_load_dwordx4 v1, s[12:15], s66 offen lds
    v_mfma_f32_16x16x32_bf16 v[48:51], v[216:219], v[232:235], v[48:51]
    ds_read_b64_tr_b16 v[210:211], v9 offset:53760
    v_mfma_f32_16x16x32_bf16 v[52:55], v[216:219], v[236:239], v[52:55]
    v_mfma_f32_16x16x32_bf16 v[56:59], v[220:223], v[224:227], v[56:59]
    ds_read_b64_tr_b16 v[212:213], v11 offset:53248
    v_mfma_f32_16x16x32_bf16 v[60:63], v[220:223], v[228:231], v[60:63]
    v_mfma_f32_16x16x32_bf16 v[64:67], v[220:223], v[232:235], v[64:67]
    ds_read_b64_tr_b16 v[214:215], v11 offset:53760
    v_mfma_f32_16x16x32_bf16 v[68:71], v[220:223], v[236:239], v[68:71]
    s_waitcnt vmcnt(5) lgkmcnt(4)
    s_barrier
    v_mfma_f32_16x16x32_bf16 v[72:75], v[200:203], v[224:227], v[72:75]
    ds_read_b64_tr_b16 v[216:217], v9 offset:57344
    s_add_u32 m0, s35, 8192
    v_mfma_f32_16x16x32_bf16 v[76:79], v[200:203], v[228:231], v[76:79]
    buffer_load_dwordx4 v2, s[24:27], s66 offen lds
    v_mfma_f32_16x16x32_bf16 v[80:83], v[200:203], v[232:235], v[80:83]
    ds_read_b64_tr_b16 v[218:219], v9 offset:57856
    v_mfma_f32_16x16x32_bf16 v[84:87], v[200:203], v[236:239], v[84:87]
    v_mfma_f32_16x16x32_bf16 v[88:91], v[204:207], v[224:227], v[88:91]
    ds_read_b64_tr_b16 v[220:221], v11 offset:57344
    v_mfma_f32_16x16x32_bf16 v[92:95], v[204:207], v[228:231], v[92:95]
    v_mfma_f32_16x16x32_bf16 v[96:99], v[204:207], v[232:235], v[96:99]
    ds_read_b64_tr_b16 v[222:223], v11 offset:57856
    v_mfma_f32_16x16x32_bf16 v[100:103], v[204:207], v[236:239], v[100:103]
    s_waitcnt lgkmcnt(4)
    v_mfma_f32_16x16x32_bf16 v[40:43], v[208:211], v[240:243], v[40:43]
    ds_read_b64_tr_b16 v[200:201], v9 offset:61440
    s_add_u32 m0, s35, 12288
    v_mfma_f32_16x16x32_bf16 v[44:47], v[208:211], v[244:247], v[44:47]
    buffer_load_dwordx4 v1, s[8:11], s67 offen lds
    v_mfma_f32_16x16x32_bf16 v[48:51], v[208:211], v[248:251], v[48:51]
    ds_read_b64_tr_b16 v[202:203], v9 offset:61952
    v_mfma_f32_16x16x32_bf16 v[52:55], v[208:211], v[252:255], v[52:55]
    v_mfma_f32_16x16x32_bf16 v[56:59], v[212:215], v[240:243], v[56:59]
    ds_read_b64_tr_b16 v[204:205], v11 offset:61440
    v_mfma_f32_16x16x32_bf16 v[60:63], v[212:215], v[244:247], v[60:63]
    v_mfma_f32_16x16x32_bf16 v[64:67], v[212:215], v[248:251], v[64:67]
    ds_read_b64_tr_b16 v[206:207], v11 offset:61952
    v_mfma_f32_16x16x32_bf16 v[68:71], v[212:215], v[252:255], v[68:71]
    s_waitcnt lgkmcnt(4)
    v_mfma_f32_16x16x32_bf16 v[72:75], v[216:219], v[240:243], v[72:75]
    ds_read_b64_tr_b16 v[208:209], v10 offset:0
    s_add_u32 m0, s35, 16384
    v_mfma_f32_16x16x32_bf16 v[76:79], v[216:219], v[244:247], v[76:79]
    buffer_load_dwordx4 v1, s[12:15], s67 offen lds
    v_mfma_f32_16x16x32_bf16 v[80:83], v[216:219], v[248:251], v[80:83]
    ds_read_b64_tr_b16 v[210:211], v10 offset:512
    v_mfma_f32_16x16x32_bf16 v[84:87], v[216:219], v[252:255], v[84:87]
    v_mfma_f32_16x16x32_bf16 v[88:91], v[220:223], v[240:243], v[88:91]
    ds_read_b64_tr_b16 v[212:213], v12 offset:0
    v_mfma_f32_16x16x32_bf16 v[92:95], v[220:223], v[244:247], v[92:95]
    v_mfma_f32_16x16x32_bf16 v[96:99], v[220:223], v[248:251], v[96:99]
    ds_read_b64_tr_b16 v[214:215], v12 offset:512
    v_mfma_f32_16x16x32_bf16 v[100:103], v[220:223], v[252:255], v[100:103]
    s_waitcnt lgkmcnt(4)
    v_mfma_f32_16x16x32_bf16 v[104:107], v[200:203], a[0:3], 0
    ds_read_b64_tr_b16 v[216:217], v8 offset:4096
    s_add_u32 m0, s35, 20480
    v_mfma_f32_16x16x32_bf16 v[108:111], v[200:203], a[4:7], 0
    buffer_load_dwordx4 v2, s[24:27], s67 offen lds
    v_mfma_f32_16x16x32_bf16 v[112:115], v[200:203], a[8:11], 0
    ds_read_b64_tr_b16 v[218:219], v8 offset:4352
    s_add_u32 m0, s35, 24576
    v_mfma_f32_16x16x32_bf16 v[116:119], v[200:203], a[12:15], 0
    buffer_load_dwordx4 v1, s[8:11], s68 offen lds
    v_mfma_f32_16x16x32_bf16 v[120:123], v[204:207], a[0:3], 0
    ds_read_b64_tr_b16 v[220:221], v8 offset:6144
    s_add_u32 m0, s35, 28672
    v_mfma_f32_16x16x32_bf16 v[124:127], v[204:207], a[4:7], 0
    buffer_load_dwordx4 v1, s[12:15], s68 offen lds
    v_mfma_f32_16x16x32_bf16 v[128:131], v[204:207], a[8:11], 0
    ds_read_b64_tr_b16 v[222:223], v8 offset:6400
    v_mfma_f32_16x16x32_bf16 v[132:135], v[204:207], a[12:15], 0
    s_waitcnt vmcnt(5) lgkmcnt(4)
    s_barrier
    v_mfma_f32_16x16x32_bf16 v[136:139], v[208:211], a[0:3], 0
    ds_read_b64_tr_b16 v[200:201], v10 offset:8192
    s_add_u32 m0, s35, 32768
    v_mfma_f32_16x16x32_bf16 v[140:143], v[208:211], a[4:7], 0
    buffer_load_dwordx4 v2, s[24:27], s68 offen lds
    v_mfma_f32_16x16x32_bf16 v[144:147], v[208:211], a[8:11], 0
    ds_read_b64_tr_b16 v[202:203], v10 offset:8704
    s_add_u32 m0, s35, 36864
    v_mfma_f32_16x16x32_bf16 v[148:151], v[208:211], a[12:15], 0
    buffer_load_dwordx4 v1, s[8:11], s69 offen lds
    v_mfma_f32_16x16x32_bf16 v[152:155], v[212:215], a[0:3], 0
    ds_read_b64_tr_b16 v[204:205], v12 offset:8192
    v_mfma_f32_16x16x32_bf16 v[156:159], v[212:215], a[4:7], 0
    v_mfma_f32_16x16x32_bf16 v[160:163], v[212:215], a[8:11], 0
    ds_read_b64_tr_b16 v[206:207], v12 offset:8704
    v_mfma_f32_16x16x32_bf16 v[164:167], v[212:215], a[12:15], 0
    s_waitcnt lgkmcnt(4)
    v_mfma_f32_16x16x32_bf16 v[168:171], v[216:219], a[0:3], 0
    ds_read_b64_tr_b16 v[208:209], v10 offset:12288
    s_add_u32 m0, s35, 40960
    v_mfma_f32_16x16x32_bf16 v[172:175], v[216:219], a[4:7], 0
    buffer_load_dwordx4 v1, s[12:15], s69 offen lds
    v_lshrrev_b32 v38, 4, v0
    v_mfma_f32_16x16x32_bf16 v[176:179], v[216:219], a[8:11], 0
    ds_read_b64_tr_b16 v[210:211], v10 offset:12800
    s_add_u32 m0, s35, 45056
    v_mfma_f32_16x16x32_bf16 v[180:183], v[216:219], a[12:15], 0
    buffer_load_dwordx4 v2, s[24:27], s69 offen lds
    v_lshlrev_b32 v39, 10, v38
    v_mfma_f32_16x16x32_bf16 v[184:187], v[220:223], a[0:3], 0
    ds_read_b64_tr_b16 v[212:213], v12 offset:12288
    s_add_u32 m0, s35, 49152
    v_mfma_f32_16x16x32_bf16 v[188:191], v[220:223], a[4:7], 0
    buffer_load_dwordx4 v1, s[8:11], s70 offen lds
    v_sub_u32 v3, v9, v39
    v_mfma_f32_16x16x32_bf16 v[192:195], v[220:223], a[8:11], 0
    ds_read_b64_tr_b16 v[214:215], v12 offset:12800
    s_add_u32 m0, s35, 53248
    v_mfma_f32_16x16x32_bf16 v[196:199], v[220:223], a[12:15], 0
    buffer_load_dwordx4 v1, s[12:15], s70 offen lds
    s_waitcnt lgkmcnt(4)
    v_mfma_f32_16x16x32_bf16 v[104:107], v[200:203], a[16:19], v[104:107]
    ds_read_b64_tr_b16 v[216:217], v8 offset:16384
    s_add_u32 m0, s35, 57344
    v_mfma_f32_16x16x32_bf16 v[108:111], v[200:203], a[20:23], v[108:111]
    buffer_load_dwordx4 v2, s[24:27], s70 offen lds
    v_and_b32 v39, 1, v38
    v_mfma_f32_16x16x32_bf16 v[112:115], v[200:203], a[24:27], v[112:115]
    ds_read_b64_tr_b16 v[218:219], v8 offset:16640
    s_add_u32 m0, s35, 61440
    v_mfma_f32_16x16x32_bf16 v[116:119], v[200:203], a[28:31], v[116:119]
    buffer_load_dwordx4 v1, s[8:11], s71 offen lds
    v_lshl_add_u32 v3, v39, 9, v3
    v_mfma_f32_16x16x32_bf16 v[120:123], v[204:207], a[16:19], v[120:123]
    ds_read_b64_tr_b16 v[220:221], v8 offset:18432
    s_add_u32 m0, s35, 65536
    v_mfma_f32_16x16x32_bf16 v[124:127], v[204:207], a[20:23], v[124:127]
    buffer_load_dwordx4 v1, s[12:15], s71 offen lds
    v_lshrrev_b32 v39, 1, v38
    v_mfma_f32_16x16x32_bf16 v[128:131], v[204:207], a[24:27], v[128:131]
    ds_read_b64_tr_b16 v[222:223], v8 offset:18688
    v_lshl_add_u32 v3, v39, 10, v3
    v_mfma_f32_16x16x32_bf16 v[132:135], v[204:207], a[28:31], v[132:135]
    v_add_u32 v4, 0x10000, v3
    s_waitcnt lgkmcnt(4)
    v_mfma_f32_16x16x32_bf16 v[136:139], v[208:211], a[16:19], v[136:139]
    ds_read_b64_tr_b16 v[200:201], v9 offset:0
    v_xor_b32 v5, 32, v3
    v_mfma_f32_16x16x32_bf16 v[140:143], v[208:211], a[20:23], v[140:143]
    v_add_u32 v6, 0x10000, v5
    v_mfma_f32_16x16x32_bf16 v[144:147], v[208:211], a[24:27], v[144:147]
    ds_read_b64_tr_b16 v[202:203], v9 offset:512
    v_mfma_f32_16x16x32_bf16 v[148:151], v[208:211], a[28:31], v[148:151]
    s_mul_i32 s36, s2, 73728
    s_add_u32 s36, s36, 26124288
    v_mfma_f32_16x16x32_bf16 v[152:155], v[212:215], a[16:19], v[152:155]
    ds_read_b64_tr_b16 v[204:205], v11 offset:0
    v_mfma_f32_16x16x32_bf16 v[156:159], v[212:215], a[20:23], v[156:159]
    s_add_u32 s96, s4, s36
    s_addc_u32 s97, s5, 0
    v_mfma_f32_16x16x32_bf16 v[160:163], v[212:215], a[24:27], v[160:163]
    ds_read_b64_tr_b16 v[206:207], v11 offset:512
    v_mfma_f32_16x16x32_bf16 v[164:167], v[212:215], a[28:31], v[164:167]
    s_mov_b32 s98, 163840
    s_mov_b32 s99, 0x20000
    s_waitcnt lgkmcnt(4)
    v_mfma_f32_16x16x32_bf16 v[168:171], v[216:219], a[16:19], v[168:171]
    ds_read_b64_tr_b16 v[208:209], v9 offset:4096
    v_mfma_f32_16x16x32_bf16 v[172:175], v[216:219], a[20:23], v[172:175]
    s_xor_b32 s37, s2, 8
    s_mul_i32 s36, s37, 73728
    v_mfma_f32_16x16x32_bf16 v[176:179], v[216:219], a[24:27], v[176:179]
    ds_read_b64_tr_b16 v[210:211], v9 offset:4608
    s_add_u32 s36, s36, 26124288
    v_mfma_f32_16x16x32_bf16 v[180:183], v[216:219], a[28:31], v[180:183]
    s_add_u32 s28, s4, s36
    s_addc_u32 s29, s5, 0
    v_mfma_f32_16x16x32_bf16 v[184:187], v[220:223], a[16:19], v[184:187]
    ds_read_b64_tr_b16 v[212:213], v11 offset:4096
    v_mfma_f32_16x16x32_bf16 v[188:191], v[220:223], a[20:23], v[188:191]
    s_mov_b32 s30, 163840
    s_mov_b32 s31, 0x20000
    v_mfma_f32_16x16x32_bf16 v[192:195], v[220:223], a[24:27], v[192:195]
    ds_read_b64_tr_b16 v[214:215], v11 offset:4608
    v_mfma_f32_16x16x32_bf16 v[196:199], v[220:223], a[28:31], v[196:199]
    s_add_u32 s20, s4, 2555904
    s_addc_u32 s21, s5, 0
    s_waitcnt lgkmcnt(4)
    v_mfma_f32_16x16x32_bf16 v[104:107], v[200:203], a[32:35], v[104:107]
    ds_read_b64_tr_b16 v[216:217], v7 offset:8192
    v_mfma_f32_16x16x32_bf16 v[108:111], v[200:203], a[36:39], v[108:111]
    s_mov_b32 s22, 16384
    s_mov_b32 s23, 0x20000
    v_mfma_f32_16x16x32_bf16 v[112:115], v[200:203], a[40:43], v[112:115]
    ds_read_b64_tr_b16 v[218:219], v7 offset:8448
    v_mfma_f32_16x16x32_bf16 v[116:119], v[200:203], a[44:47], v[116:119]
    s_lshl_b32 s56, s2, 4
    s_add_u32 s56, s56, s32
    v_mfma_f32_16x16x32_bf16 v[120:123], v[204:207], a[32:35], v[120:123]
    ds_read_b64_tr_b16 v[220:221], v7 offset:10240
    s_lshl_b32 s56, s56, 2
    v_mfma_f32_16x16x32_bf16 v[124:127], v[204:207], a[36:39], v[124:127]
    v_mul_f32 v40, v40, v72
    v_mul_f32 v41, v41, v73
    v_mfma_f32_16x16x32_bf16 v[128:131], v[204:207], a[40:43], v[128:131]
    ds_read_b64_tr_b16 v[222:223], v7 offset:10496
    v_mfma_f32_16x16x32_bf16 v[132:135], v[204:207], a[44:47], v[132:135]
    s_waitcnt vmcnt(8) lgkmcnt(4)
    s_barrier
    v_mfma_f32_16x16x32_bf16 v[136:139], v[208:211], a[32:35], v[136:139]
    ds_read_b64_tr_b16 v[200:201], v9 offset:12288
    s_add_u32 m0, s35, 69632
    v_mfma_f32_16x16x32_bf16 v[140:143], v[208:211], a[36:39], v[140:143]
    buffer_load_dwordx4 v2, s[24:27], s71 offen lds
    v_mul_f32 v42, v42, v74
    v_mfma_f32_16x16x32_bf16 v[144:147], v[208:211], a[40:43], v[144:147]
    ds_read_b64_tr_b16 v[202:203], v9 offset:12800
    s_add_u32 m0, s35, 73728
    v_mfma_f32_16x16x32_bf16 v[148:151], v[208:211], a[44:47], v[148:151]
    buffer_load_dwordx4 v1, s[8:11], s72 offen lds
    v_mul_f32 v43, v43, v75
    v_mfma_f32_16x16x32_bf16 v[152:155], v[212:215], a[32:35], v[152:155]
    ds_read_b64_tr_b16 v[204:205], v11 offset:12288
    s_add_u32 m0, s35, 77824
    v_mfma_f32_16x16x32_bf16 v[156:159], v[212:215], a[36:39], v[156:159]
    buffer_load_dwordx4 v1, s[12:15], s72 offen lds
    v_mul_f32 v56, v56, v88
    v_mfma_f32_16x16x32_bf16 v[160:163], v[212:215], a[40:43], v[160:163]
    ds_read_b64_tr_b16 v[206:207], v11 offset:12800
    s_add_u32 m0, s35, 81920
    v_mfma_f32_16x16x32_bf16 v[164:167], v[212:215], a[44:47], v[164:167]
    buffer_load_dwordx4 v2, s[24:27], s72 offen lds
    s_waitcnt lgkmcnt(4)
    v_mfma_f32_16x16x32_bf16 v[168:171], v[216:219], a[32:35], v[168:171]
    ds_read_b64_tr_b16 v[208:209], v9 offset:16384
    s_add_u32 m0, s35, 0
    v_mfma_f32_16x16x32_bf16 v[172:175], v[216:219], a[36:39], v[172:175]
    buffer_load_dwordx4 v1, s[8:11], s73 offen lds
    v_mul_f32 v57, v57, v89
    v_mfma_f32_16x16x32_bf16 v[176:179], v[216:219], a[40:43], v[176:179]
    ds_read_b64_tr_b16 v[210:211], v9 offset:16896
    s_add_u32 m0, s35, 4096
    v_mfma_f32_16x16x32_bf16 v[180:183], v[216:219], a[44:47], v[180:183]
    buffer_load_dwordx4 v1, s[12:15], s73 offen lds
    v_mul_f32 v58, v58, v90
    v_mfma_f32_16x16x32_bf16 v[184:187], v[220:223], a[32:35], v[184:187]
    ds_read_b64_tr_b16 v[212:213], v11 offset:16384
    v_mul_f32 v59, v59, v91
    v_mfma_f32_16x16x32_bf16 v[188:191], v[220:223], a[36:39], v[188:191]
    v_cvt_pk_bf16_f32 v72, v40, v41
    v_cvt_pk_bf16_f32 v73, v42, v43
    v_mfma_f32_16x16x32_bf16 v[192:195], v[220:223], a[40:43], v[192:195]
    ds_read_b64_tr_b16 v[214:215], v11 offset:16896
    v_mfma_f32_16x16x32_bf16 v[196:199], v[220:223], a[44:47], v[196:199]
    s_waitcnt lgkmcnt(4)
    v_mfma_f32_16x16x32_bf16 v[104:107], v[200:203], a[48:51], v[104:107]
    ds_read_b64_tr_b16 v[216:217], v7 offset:20480
    v_cvt_pk_bf16_f32 v74, v56, v57
    v_mfma_f32_16x16x32_bf16 v[108:111], v[200:203], a[52:55], v[108:111]
    v_cvt_pk_bf16_f32 v75, v58, v59
    ds_write_b128 v13, v[72:75] offset:0
    v_mfma_f32_16x16x32_bf16 v[112:115], v[200:203], a[56:59], v[112:115]
    ds_read_b64_tr_b16 v[218:219], v7 offset:20736
    s_mov_b32 s91, 0
    v_mfma_f32_16x16x32_bf16 v[116:119], v[200:203], a[60:63], v[116:119]
    buffer_store_dwordx4 v[72:75], v13, s[96:99], s91 offen offset:0 sc1
    v_mfma_f32_16x16x32_bf16 v[120:123], v[204:207], a[48:51], v[120:123]
    ds_read_b64_tr_b16 v[220:221], v7 offset:22528
    v_mfma_f32_16x16x32_bf16 v[124:127], v[204:207], a[52:55], v[124:127]
    v_mfma_f32_16x16x32_bf16 v[128:131], v[204:207], a[56:59], v[128:131]
    ds_read_b64_tr_b16 v[222:223], v7 offset:22784
    v_mfma_f32_16x16x32_bf16 v[132:135], v[204:207], a[60:63], v[132:135]
    s_waitcnt lgkmcnt(5)
    v_mfma_f32_16x16x32_bf16 v[136:139], v[208:211], a[48:51], v[136:139]
    ds_read_b64_tr_b16 v[200:201], v9 offset:24576
    v_mul_f32 v44, v44, v76
    v_mfma_f32_16x16x32_bf16 v[140:143], v[208:211], a[52:55], v[140:143]
    v_mul_f32 v45, v45, v77
    v_mul_f32 v46, v46, v78
    v_mfma_f32_16x16x32_bf16 v[144:147], v[208:211], a[56:59], v[144:147]
    ds_read_b64_tr_b16 v[202:203], v9 offset:25088
    v_mul_f32 v47, v47, v79
    v_mfma_f32_16x16x32_bf16 v[148:151], v[208:211], a[60:63], v[148:151]
    v_mul_f32 v60, v60, v92
    v_mfma_f32_16x16x32_bf16 v[152:155], v[212:215], a[48:51], v[152:155]
    ds_read_b64_tr_b16 v[204:205], v11 offset:24576
    v_mfma_f32_16x16x32_bf16 v[156:159], v[212:215], a[52:55], v[156:159]
    v_mfma_f32_16x16x32_bf16 v[160:163], v[212:215], a[56:59], v[160:163]
    ds_read_b64_tr_b16 v[206:207], v11 offset:25088
    v_mfma_f32_16x16x32_bf16 v[164:167], v[212:215], a[60:63], v[164:167]
    s_waitcnt lgkmcnt(4)
    v_mfma_f32_16x16x32_bf16 v[168:171], v[216:219], a[48:51], v[168:171]
    ds_read_b64_tr_b16 v[208:209], v9 offset:28672
    v_mul_f32 v61, v61, v93
    v_mfma_f32_16x16x32_bf16 v[172:175], v[216:219], a[52:55], v[172:175]
    v_mul_f32 v62, v62, v94
    v_mul_f32 v63, v63, v95
    v_mfma_f32_16x16x32_bf16 v[176:179], v[216:219], a[56:59], v[176:179]
    ds_read_b64_tr_b16 v[210:211], v9 offset:29184
    v_cvt_pk_bf16_f32 v76, v44, v45
    v_mfma_f32_16x16x32_bf16 v[180:183], v[216:219], a[60:63], v[180:183]
    v_cvt_pk_bf16_f32 v77, v46, v47
    v_mfma_f32_16x16x32_bf16 v[184:187], v[220:223], a[48:51], v[184:187]
    ds_read_b64_tr_b16 v[212:213], v11 offset:28672
    v_mfma_f32_16x16x32_bf16 v[188:191], v[220:223], a[52:55], v[188:191]
    v_mfma_f32_16x16x32_bf16 v[192:195], v[220:223], a[56:59], v[192:195]
    ds_read_b64_tr_b16 v[214:215], v11 offset:29184
    v_mfma_f32_16x16x32_bf16 v[196:199], v[220:223], a[60:63], v[196:199]
    s_waitcnt lgkmcnt(4)
    v_mfma_f32_16x16x32_bf16 v[104:107], v[200:203], a[64:67], v[104:107]
    ds_read_b64_tr_b16 v[216:217], v7 offset:32768
    v_cvt_pk_bf16_f32 v78, v60, v61
    v_mfma_f32_16x16x32_bf16 v[108:111], v[200:203], a[68:71], v[108:111]
    v_cvt_pk_bf16_f32 v79, v62, v63
    ds_write_b128 v13, v[76:79] offset:1024
    v_mfma_f32_16x16x32_bf16 v[112:115], v[200:203], a[72:75], v[112:115]
    ds_read_b64_tr_b16 v[218:219], v7 offset:33024
    buffer_store_dwordx4 v[76:79], v13, s[96:99], s91 offen offset:1024 sc1
    v_mfma_f32_16x16x32_bf16 v[116:119], v[200:203], a[76:79], v[116:119]
    v_mul_f32 v48, v48, v80
    v_mfma_f32_16x16x32_bf16 v[120:123], v[204:207], a[64:67], v[120:123]
    ds_read_b64_tr_b16 v[220:221], v7 offset:34816
    v_mfma_f32_16x16x32_bf16 v[124:127], v[204:207], a[68:71], v[124:127]
    v_mfma_f32_16x16x32_bf16 v[128:131], v[204:207], a[72:75], v[128:131]
    ds_read_b64_tr_b16 v[222:223], v7 offset:35072
    v_mfma_f32_16x16x32_bf16 v[132:135], v[204:207], a[76:79], v[132:135]
    s_waitcnt vmcnt(10) lgkmcnt(5)
    s_barrier
    v_mfma_f32_16x16x32_bf16 v[136:139], v[208:211], a[64:67], v[136:139]
    ds_read_b64_tr_b16 v[200:201], v9 offset:36864
    s_add_u32 m0, s35, 8192
    v_mfma_f32_16x16x32_bf16 v[140:143], v[208:211], a[68:71], v[140:143]
    buffer_load_dwordx4 v2, s[24:27], s73 offen lds
    v_mul_f32 v49, v49, v81
    v_mfma_f32_16x16x32_bf16 v[144:147], v[208:211], a[72:75], v[144:147]
    ds_read_b64_tr_b16 v[202:203], v9 offset:37376
    s_add_u32 m0, s35, 12288
    v_mfma_f32_16x16x32_bf16 v[148:151], v[208:211], a[76:79], v[148:151]
    buffer_load_dwordx4 v1, s[8:11], s74 offen lds
    v_mul_f32 v50, v50, v82
    v_mfma_f32_16x16x32_bf16 v[152:155], v[212:215], a[64:67], v[152:155]
    ds_read_b64_tr_b16 v[204:205], v11 offset:36864
    s_add_u32 m0, s35, 16384
    v_mfma_f32_16x16x32_bf16 v[156:159], v[212:215], a[68:71], v[156:159]
    buffer_load_dwordx4 v1, s[12:15], s74 offen lds
    v_mul_f32 v51, v51, v83
    v_mfma_f32_16x16x32_bf16 v[160:163], v[212:215], a[72:75], v[160:163]
    ds_read_b64_tr_b16 v[206:207], v11 offset:37376
    s_add_u32 m0, s35, 20480
    v_mfma_f32_16x16x32_bf16 v[164:167], v[212:215], a[76:79], v[164:167]
    buffer_load_dwordx4 v2, s[24:27], s74 offen lds
    s_waitcnt lgkmcnt(4)
    v_mfma_f32_16x16x32_bf16 v[168:171], v[216:219], a[64:67], v[168:171]
    ds_read_b64_tr_b16 v[208:209], v9 offset:40960
    s_add_u32 m0, s35, 24576
    v_mfma_f32_16x16x32_bf16 v[172:175], v[216:219], a[68:71], v[172:175]
    buffer_load_dwordx4 v1, s[8:11], s75 offen lds
    v_mul_f32 v64, v64, v96
    v_mfma_f32_16x16x32_bf16 v[176:179], v[216:219], a[72:75], v[176:179]
    ds_read_b64_tr_b16 v[210:211], v9 offset:41472
    s_add_u32 m0, s35, 28672
    v_mfma_f32_16x16x32_bf16 v[180:183], v[216:219], a[76:79], v[180:183]
    buffer_load_dwordx4 v1, s[12:15], s75 offen lds
    v_mul_f32 v65, v65, v97
    v_mfma_f32_16x16x32_bf16 v[184:187], v[220:223], a[64:67], v[184:187]
    ds_read_b64_tr_b16 v[212:213], v11 offset:40960
    v_mul_f32 v66, v66, v98
    v_mfma_f32_16x16x32_bf16 v[188:191], v[220:223], a[68:71], v[188:191]
    v_mul_f32 v67, v67, v99
    v_cvt_pk_bf16_f32 v80, v48, v49
    v_mfma_f32_16x16x32_bf16 v[192:195], v[220:223], a[72:75], v[192:195]
    ds_read_b64_tr_b16 v[214:215], v11 offset:41472
    v_mfma_f32_16x16x32_bf16 v[196:199], v[220:223], a[76:79], v[196:199]
    s_waitcnt lgkmcnt(4)
    v_mfma_f32_16x16x32_bf16 v[104:107], v[200:203], a[80:83], v[104:107]
    ds_read_b64_tr_b16 v[216:217], v7 offset:45056
    v_cvt_pk_bf16_f32 v81, v50, v51
    v_mfma_f32_16x16x32_bf16 v[108:111], v[200:203], a[84:87], v[108:111]
    v_cvt_pk_bf16_f32 v82, v64, v65
    v_cvt_pk_bf16_f32 v83, v66, v67
    v_mfma_f32_16x16x32_bf16 v[112:115], v[200:203], a[88:91], v[112:115]
    ds_read_b64_tr_b16 v[218:219], v7 offset:45312
    v_mfma_f32_16x16x32_bf16 v[116:119], v[200:203], a[92:95], v[116:119]
    ds_write_b128 v13, v[80:83] offset:2048
    buffer_store_dwordx4 v[80:83], v13, s[96:99], s91 offen offset:2048 sc1
    v_mfma_f32_16x16x32_bf16 v[120:123], v[204:207], a[80:83], v[120:123]
    ds_read_b64_tr_b16 v[220:221], v7 offset:47104
    v_mfma_f32_16x16x32_bf16 v[124:127], v[204:207], a[84:87], v[124:127]
    v_mfma_f32_16x16x32_bf16 v[128:131], v[204:207], a[88:91], v[128:131]
    ds_read_b64_tr_b16 v[222:223], v7 offset:47360
    v_mfma_f32_16x16x32_bf16 v[132:135], v[204:207], a[92:95], v[132:135]
    s_waitcnt lgkmcnt(5)
    v_mfma_f32_16x16x32_bf16 v[136:139], v[208:211], a[80:83], v[136:139]
    ds_read_b64_tr_b16 v[200:201], v9 offset:49152
    v_mul_f32 v52, v52, v84
    v_mfma_f32_16x16x32_bf16 v[140:143], v[208:211], a[84:87], v[140:143]
    v_mul_f32 v53, v53, v85
    v_mul_f32 v54, v54, v86
    v_mfma_f32_16x16x32_bf16 v[144:147], v[208:211], a[88:91], v[144:147]
    ds_read_b64_tr_b16 v[202:203], v9 offset:49664
    v_mul_f32 v55, v55, v87
    v_mfma_f32_16x16x32_bf16 v[148:151], v[208:211], a[92:95], v[148:151]
    v_mul_f32 v68, v68, v100
    v_mfma_f32_16x16x32_bf16 v[152:155], v[212:215], a[80:83], v[152:155]
    ds_read_b64_tr_b16 v[204:205], v11 offset:49152
    v_mfma_f32_16x16x32_bf16 v[156:159], v[212:215], a[84:87], v[156:159]
    v_mfma_f32_16x16x32_bf16 v[160:163], v[212:215], a[88:91], v[160:163]
    ds_read_b64_tr_b16 v[206:207], v11 offset:49664
    v_mfma_f32_16x16x32_bf16 v[164:167], v[212:215], a[92:95], v[164:167]
    s_waitcnt lgkmcnt(4)
    v_mfma_f32_16x16x32_bf16 v[168:171], v[216:219], a[80:83], v[168:171]
    ds_read_b64_tr_b16 v[208:209], v9 offset:53248
    v_mul_f32 v69, v69, v101
    v_mfma_f32_16x16x32_bf16 v[172:175], v[216:219], a[84:87], v[172:175]
    v_mul_f32 v70, v70, v102
    v_mul_f32 v71, v71, v103
    v_mfma_f32_16x16x32_bf16 v[176:179], v[216:219], a[88:91], v[176:179]
    ds_read_b64_tr_b16 v[210:211], v9 offset:53760
    v_cvt_pk_bf16_f32 v84, v52, v53
    v_mfma_f32_16x16x32_bf16 v[180:183], v[216:219], a[92:95], v[180:183]
    v_cvt_pk_bf16_f32 v85, v54, v55
    v_mfma_f32_16x16x32_bf16 v[184:187], v[220:223], a[80:83], v[184:187]
    ds_read_b64_tr_b16 v[212:213], v11 offset:53248
    v_mfma_f32_16x16x32_bf16 v[188:191], v[220:223], a[84:87], v[188:191]
    v_mfma_f32_16x16x32_bf16 v[192:195], v[220:223], a[88:91], v[192:195]
    ds_read_b64_tr_b16 v[214:215], v11 offset:53760
    v_mfma_f32_16x16x32_bf16 v[196:199], v[220:223], a[92:95], v[196:199]
    s_waitcnt lgkmcnt(4)
    v_mfma_f32_16x16x32_bf16 v[104:107], v[200:203], a[96:99], v[104:107]
    ds_read_b64_tr_b16 v[216:217], v7 offset:57344
    v_cvt_pk_bf16_f32 v86, v68, v69
    v_mfma_f32_16x16x32_bf16 v[108:111], v[200:203], a[100:103], v[108:111]
    v_cvt_pk_bf16_f32 v87, v70, v71
    ds_write_b128 v13, v[84:87] offset:3072
    v_mfma_f32_16x16x32_bf16 v[112:115], v[200:203], a[104:107], v[112:115]
    ds_read_b64_tr_b16 v[218:219], v7 offset:57600
    buffer_store_dwordx4 v[84:87], v13, s[96:99], s91 offen offset:3072 sc1
    v_mfma_f32_16x16x32_bf16 v[116:119], v[200:203], a[108:111], v[116:119]
    v_mfma_f32_16x16x32_bf16 v[120:123], v[204:207], a[96:99], v[120:123]
    ds_read_b64_tr_b16 v[220:221], v7 offset:59392
    v_mfma_f32_16x16x32_bf16 v[124:127], v[204:207], a[100:103], v[124:127]
    v_mfma_f32_16x16x32_bf16 v[128:131], v[204:207], a[104:107], v[128:131]
    ds_read_b64_tr_b16 v[222:223], v7 offset:59648
    v_mfma_f32_16x16x32_bf16 v[132:135], v[204:207], a[108:111], v[132:135]
    s_waitcnt vmcnt(12) lgkmcnt(5)
    s_barrier
    v_mfma_f32_16x16x32_bf16 v[136:139], v[208:211], a[96:99], v[136:139]
    ds_read_b64_tr_b16 v[200:201], v9 offset:61440
    s_add_u32 m0, s35, 32768
    v_mfma_f32_16x16x32_bf16 v[140:143], v[208:211], a[100:103], v[140:143]
    buffer_load_dwordx4 v2, s[24:27], s75 offen lds
    v_mfma_f32_16x16x32_bf16 v[144:147], v[208:211], a[104:107], v[144:147]
    ds_read_b64_tr_b16 v[202:203], v9 offset:61952
    s_add_u32 m0, s35, 36864
    v_mfma_f32_16x16x32_bf16 v[148:151], v[208:211], a[108:111], v[148:151]
    buffer_load_dwordx4 v1, s[8:11], s76 offen lds
    v_mfma_f32_16x16x32_bf16 v[152:155], v[212:215], a[96:99], v[152:155]
    ds_read_b64_tr_b16 v[204:205], v11 offset:61440
    s_add_u32 m0, s35, 40960
    v_mfma_f32_16x16x32_bf16 v[156:159], v[212:215], a[100:103], v[156:159]
    buffer_load_dwordx4 v1, s[12:15], s76 offen lds
    v_mfma_f32_16x16x32_bf16 v[160:163], v[212:215], a[104:107], v[160:163]
    ds_read_b64_tr_b16 v[206:207], v11 offset:61952
    s_add_u32 m0, s35, 45056
    v_mfma_f32_16x16x32_bf16 v[164:167], v[212:215], a[108:111], v[164:167]
    buffer_load_dwordx4 v2, s[24:27], s76 offen lds
    s_waitcnt lgkmcnt(4)
    v_mfma_f32_16x16x32_bf16 v[168:171], v[216:219], a[96:99], v[168:171]
    ds_read_b64_tr_b16 v[208:209], v10 offset:0
    s_add_u32 m0, s35, 49152
    v_mfma_f32_16x16x32_bf16 v[172:175], v[216:219], a[100:103], v[172:175]
    buffer_load_dwordx4 v1, s[8:11], s77 offen lds
    v_mfma_f32_16x16x32_bf16 v[176:179], v[216:219], a[104:107], v[176:179]
    ds_read_b64_tr_b16 v[210:211], v10 offset:512
    s_add_u32 m0, s35, 53248
    v_mfma_f32_16x16x32_bf16 v[180:183], v[216:219], a[108:111], v[180:183]
    buffer_load_dwordx4 v1, s[12:15], s77 offen lds
    v_mfma_f32_16x16x32_bf16 v[184:187], v[220:223], a[96:99], v[184:187]
    ds_read_b64_tr_b16 v[212:213], v12 offset:0
    v_mfma_f32_16x16x32_bf16 v[188:191], v[220:223], a[100:103], v[188:191]
    v_mfma_f32_16x16x32_bf16 v[192:195], v[220:223], a[104:107], v[192:195]
    ds_read_b64_tr_b16 v[214:215], v12 offset:512
    v_mfma_f32_16x16x32_bf16 v[196:199], v[220:223], a[108:111], v[196:199]
    s_waitcnt lgkmcnt(4)
    v_mfma_f32_16x16x32_bf16 v[104:107], v[200:203], a[112:115], v[104:107]
    ds_read_b64_tr_b16 v[216:217], v8 offset:4096
    v_mfma_f32_16x16x32_bf16 v[108:111], v[200:203], a[116:119], v[108:111]
    v_mfma_f32_16x16x32_bf16 v[112:115], v[200:203], a[120:123], v[112:115]
    ds_read_b64_tr_b16 v[218:219], v8 offset:4352
    v_mfma_f32_16x16x32_bf16 v[116:119], v[200:203], a[124:127], v[116:119]
    v_mfma_f32_16x16x32_bf16 v[120:123], v[204:207], a[112:115], v[120:123]
    ds_read_b64_tr_b16 v[220:221], v8 offset:6144
    v_mfma_f32_16x16x32_bf16 v[124:127], v[204:207], a[116:119], v[124:127]
    v_mfma_f32_16x16x32_bf16 v[128:131], v[204:207], a[120:123], v[128:131]
    ds_read_b64_tr_b16 v[222:223], v8 offset:6400
    v_mfma_f32_16x16x32_bf16 v[132:135], v[204:207], a[124:127], v[132:135]
    s_waitcnt lgkmcnt(4)
    v_mfma_f32_16x16x32_bf16 v[136:139], v[208:211], a[112:115], v[136:139]
    ds_read_b64_tr_b16 v[200:201], v10 offset:8192
    v_mfma_f32_16x16x32_bf16 v[140:143], v[208:211], a[116:119], v[140:143]
    v_mfma_f32_16x16x32_bf16 v[144:147], v[208:211], a[120:123], v[144:147]
    ds_read_b64_tr_b16 v[202:203], v10 offset:8704
    v_mfma_f32_16x16x32_bf16 v[148:151], v[208:211], a[124:127], v[148:151]
    v_mfma_f32_16x16x32_bf16 v[152:155], v[212:215], a[112:115], v[152:155]
    ds_read_b64_tr_b16 v[204:205], v12 offset:8192
    v_mfma_f32_16x16x32_bf16 v[156:159], v[212:215], a[116:119], v[156:159]
    v_mfma_f32_16x16x32_bf16 v[160:163], v[212:215], a[120:123], v[160:163]
    ds_read_b64_tr_b16 v[206:207], v12 offset:8704
    v_mfma_f32_16x16x32_bf16 v[164:167], v[212:215], a[124:127], v[164:167]
    s_waitcnt lgkmcnt(4)
    v_mfma_f32_16x16x32_bf16 v[168:171], v[216:219], a[112:115], v[168:171]
    ds_read_b64_tr_b16 v[208:209], v10 offset:12288
    v_mfma_f32_16x16x32_bf16 v[172:175], v[216:219], a[116:119], v[172:175]
    v_mfma_f32_16x16x32_bf16 v[176:179], v[216:219], a[120:123], v[176:179]
    ds_read_b64_tr_b16 v[210:211], v10 offset:12800
    v_mfma_f32_16x16x32_bf16 v[180:183], v[216:219], a[124:127], v[180:183]
    v_mfma_f32_16x16x32_bf16 v[184:187], v[220:223], a[112:115], v[184:187]
    ds_read_b64_tr_b16 v[212:213], v12 offset:12288
    v_mfma_f32_16x16x32_bf16 v[188:191], v[220:223], a[116:119], v[188:191]
    v_mfma_f32_16x16x32_bf16 v[192:195], v[220:223], a[120:123], v[192:195]
    ds_read_b64_tr_b16 v[214:215], v12 offset:12800
    v_mfma_f32_16x16x32_bf16 v[196:199], v[220:223], a[124:127], v[196:199]
    s_waitcnt lgkmcnt(4)
    v_mfma_f32_16x16x32_bf16 v[104:107], v[200:203], a[128:131], v[104:107]
    ds_read_b64_tr_b16 v[216:217], v8 offset:16384
    v_mfma_f32_16x16x32_bf16 v[108:111], v[200:203], a[132:135], v[108:111]
    v_mfma_f32_16x16x32_bf16 v[112:115], v[200:203], a[136:139], v[112:115]
    ds_read_b64_tr_b16 v[218:219], v8 offset:16640
    v_mfma_f32_16x16x32_bf16 v[116:119], v[200:203], a[140:143], v[116:119]
    v_mfma_f32_16x16x32_bf16 v[120:123], v[204:207], a[128:131], v[120:123]
    ds_read_b64_tr_b16 v[220:221], v8 offset:18432
    v_mfma_f32_16x16x32_bf16 v[124:127], v[204:207], a[132:135], v[124:127]
    v_mfma_f32_16x16x32_bf16 v[128:131], v[204:207], a[136:139], v[128:131]
    ds_read_b64_tr_b16 v[222:223], v8 offset:18688
    v_mfma_f32_16x16x32_bf16 v[132:135], v[204:207], a[140:143], v[132:135]
    s_waitcnt vmcnt(10) lgkmcnt(4)
    s_barrier
    v_mfma_f32_16x16x32_bf16 v[136:139], v[208:211], a[128:131], v[136:139]
    ds_read_b64_tr_b16 v[200:201], v9 offset:0
    s_add_u32 m0, s35, 57344
    v_mfma_f32_16x16x32_bf16 v[140:143], v[208:211], a[132:135], v[140:143]
    buffer_load_dwordx4 v2, s[24:27], s77 offen lds
    v_mfma_f32_16x16x32_bf16 v[144:147], v[208:211], a[136:139], v[144:147]
    ds_read_b64_tr_b16 v[202:203], v9 offset:512
    s_add_u32 m0, s35, 61440
    v_mfma_f32_16x16x32_bf16 v[148:151], v[208:211], a[140:143], v[148:151]
    buffer_load_dwordx4 v1, s[8:11], s78 offen lds
    v_mfma_f32_16x16x32_bf16 v[152:155], v[212:215], a[128:131], v[152:155]
    ds_read_b64_tr_b16 v[204:205], v11 offset:0
    s_add_u32 m0, s35, 65536
    v_mfma_f32_16x16x32_bf16 v[156:159], v[212:215], a[132:135], v[156:159]
    buffer_load_dwordx4 v1, s[12:15], s78 offen lds
    v_mfma_f32_16x16x32_bf16 v[160:163], v[212:215], a[136:139], v[160:163]
    ds_read_b64_tr_b16 v[206:207], v11 offset:512
    s_add_u32 m0, s35, 69632
    v_mfma_f32_16x16x32_bf16 v[164:167], v[212:215], a[140:143], v[164:167]
    buffer_load_dwordx4 v2, s[24:27], s78 offen lds
    s_waitcnt lgkmcnt(4)
    v_mfma_f32_16x16x32_bf16 v[168:171], v[216:219], a[128:131], v[168:171]
    ds_read_b64_tr_b16 v[208:209], v9 offset:4096
    s_add_u32 m0, s35, 73728
    v_mfma_f32_16x16x32_bf16 v[172:175], v[216:219], a[132:135], v[172:175]
    buffer_load_dwordx4 v1, s[8:11], s79 offen lds
    v_mfma_f32_16x16x32_bf16 v[176:179], v[216:219], a[136:139], v[176:179]
    ds_read_b64_tr_b16 v[210:211], v9 offset:4608
    s_add_u32 m0, s35, 77824
    v_mfma_f32_16x16x32_bf16 v[180:183], v[216:219], a[140:143], v[180:183]
    buffer_load_dwordx4 v1, s[12:15], s79 offen lds
    v_mfma_f32_16x16x32_bf16 v[184:187], v[220:223], a[128:131], v[184:187]
    ds_read_b64_tr_b16 v[212:213], v11 offset:4096
    v_mfma_f32_16x16x32_bf16 v[188:191], v[220:223], a[132:135], v[188:191]
    v_mfma_f32_16x16x32_bf16 v[192:195], v[220:223], a[136:139], v[192:195]
    ds_read_b64_tr_b16 v[214:215], v11 offset:4608
    v_mfma_f32_16x16x32_bf16 v[196:199], v[220:223], a[140:143], v[196:199]
    s_waitcnt lgkmcnt(4)
    v_mfma_f32_16x16x32_bf16 v[104:107], v[200:203], a[144:147], v[104:107]
    ds_read_b64_tr_b16 v[216:217], v7 offset:8192
    v_mfma_f32_16x16x32_bf16 v[108:111], v[200:203], a[148:151], v[108:111]
    v_mfma_f32_16x16x32_bf16 v[112:115], v[200:203], a[152:155], v[112:115]
    ds_read_b64_tr_b16 v[218:219], v7 offset:8448
    v_mfma_f32_16x16x32_bf16 v[116:119], v[200:203], a[156:159], v[116:119]
    v_mfma_f32_16x16x32_bf16 v[120:123], v[204:207], a[144:147], v[120:123]
    ds_read_b64_tr_b16 v[220:221], v7 offset:10240
    v_mfma_f32_16x16x32_bf16 v[124:127], v[204:207], a[148:151], v[124:127]
    v_mfma_f32_16x16x32_bf16 v[128:131], v[204:207], a[152:155], v[128:131]
    ds_read_b64_tr_b16 v[222:223], v7 offset:10496
    v_mfma_f32_16x16x32_bf16 v[132:135], v[204:207], a[156:159], v[132:135]
    s_waitcnt lgkmcnt(4)
    v_mfma_f32_16x16x32_bf16 v[136:139], v[208:211], a[144:147], v[136:139]
    ds_read_b64_tr_b16 v[200:201], v9 offset:12288
    v_mfma_f32_16x16x32_bf16 v[140:143], v[208:211], a[148:151], v[140:143]
    v_mfma_f32_16x16x32_bf16 v[144:147], v[208:211], a[152:155], v[144:147]
    ds_read_b64_tr_b16 v[202:203], v9 offset:12800
    v_mfma_f32_16x16x32_bf16 v[148:151], v[208:211], a[156:159], v[148:151]
    v_mfma_f32_16x16x32_bf16 v[152:155], v[212:215], a[144:147], v[152:155]
    ds_read_b64_tr_b16 v[204:205], v11 offset:12288
    v_mfma_f32_16x16x32_bf16 v[156:159], v[212:215], a[148:151], v[156:159]
    v_mfma_f32_16x16x32_bf16 v[160:163], v[212:215], a[152:155], v[160:163]
    ds_read_b64_tr_b16 v[206:207], v11 offset:12800
    v_mfma_f32_16x16x32_bf16 v[164:167], v[212:215], a[156:159], v[164:167]
    s_waitcnt lgkmcnt(4)
    v_mfma_f32_16x16x32_bf16 v[168:171], v[216:219], a[144:147], v[168:171]
    ds_read_b64_tr_b16 v[208:209], v9 offset:16384
    v_mfma_f32_16x16x32_bf16 v[172:175], v[216:219], a[148:151], v[172:175]
    v_mfma_f32_16x16x32_bf16 v[176:179], v[216:219], a[152:155], v[176:179]
    ds_read_b64_tr_b16 v[210:211], v9 offset:16896
    v_mfma_f32_16x16x32_bf16 v[180:183], v[216:219], a[156:159], v[180:183]
    v_mfma_f32_16x16x32_bf16 v[184:187], v[220:223], a[144:147], v[184:187]
    ds_read_b64_tr_b16 v[212:213], v11 offset:16384
    v_mfma_f32_16x16x32_bf16 v[188:191], v[220:223], a[148:151], v[188:191]
    v_mfma_f32_16x16x32_bf16 v[192:195], v[220:223], a[152:155], v[192:195]
    ds_read_b64_tr_b16 v[214:215], v11 offset:16896
    v_mfma_f32_16x16x32_bf16 v[196:199], v[220:223], a[156:159], v[196:199]
    s_waitcnt lgkmcnt(4)
    v_mfma_f32_16x16x32_bf16 v[104:107], v[200:203], a[160:163], v[104:107]
    ds_read_b64_tr_b16 v[216:217], v7 offset:20480
    v_mfma_f32_16x16x32_bf16 v[108:111], v[200:203], a[164:167], v[108:111]
    v_mfma_f32_16x16x32_bf16 v[112:115], v[200:203], a[168:171], v[112:115]
    ds_read_b64_tr_b16 v[218:219], v7 offset:20736
    v_mfma_f32_16x16x32_bf16 v[116:119], v[200:203], a[172:175], v[116:119]
    v_mfma_f32_16x16x32_bf16 v[120:123], v[204:207], a[160:163], v[120:123]
    ds_read_b64_tr_b16 v[220:221], v7 offset:22528
    v_mfma_f32_16x16x32_bf16 v[124:127], v[204:207], a[164:167], v[124:127]
    v_mfma_f32_16x16x32_bf16 v[128:131], v[204:207], a[168:171], v[128:131]
    ds_read_b64_tr_b16 v[222:223], v7 offset:22784
    v_mfma_f32_16x16x32_bf16 v[132:135], v[204:207], a[172:175], v[132:135]
    s_waitcnt vmcnt(8) lgkmcnt(4)
    s_barrier
    v_mfma_f32_16x16x32_bf16 v[136:139], v[208:211], a[160:163], v[136:139]
    ds_read_b64_tr_b16 v[200:201], v9 offset:24576
    s_add_u32 m0, s35, 81920
    v_mfma_f32_16x16x32_bf16 v[140:143], v[208:211], a[164:167], v[140:143]
    buffer_load_dwordx4 v2, s[24:27], s79 offen lds
    v_mfma_f32_16x16x32_bf16 v[144:147], v[208:211], a[168:171], v[144:147]
    ds_read_b64_tr_b16 v[202:203], v9 offset:25088
    s_add_u32 m0, s35, 0
    v_mfma_f32_16x16x32_bf16 v[148:151], v[208:211], a[172:175], v[148:151]
    buffer_load_dwordx4 v1, s[8:11], s80 offen lds
    v_mfma_f32_16x16x32_bf16 v[152:155], v[212:215], a[160:163], v[152:155]
    ds_read_b64_tr_b16 v[204:205], v11 offset:24576
    s_add_u32 m0, s35, 4096
    v_mfma_f32_16x16x32_bf16 v[156:159], v[212:215], a[164:167], v[156:159]
    buffer_load_dwordx4 v1, s[12:15], s80 offen lds
    v_mfma_f32_16x16x32_bf16 v[160:163], v[212:215], a[168:171], v[160:163]
    ds_read_b64_tr_b16 v[206:207], v11 offset:25088
    s_add_u32 m0, s35, 8192
    v_mfma_f32_16x16x32_bf16 v[164:167], v[212:215], a[172:175], v[164:167]
    buffer_load_dwordx4 v2, s[24:27], s80 offen lds
    s_waitcnt lgkmcnt(4)
    v_mfma_f32_16x16x32_bf16 v[168:171], v[216:219], a[160:163], v[168:171]
    ds_read_b64_tr_b16 v[208:209], v9 offset:28672
    s_add_u32 m0, s35, 12288
    v_mfma_f32_16x16x32_bf16 v[172:175], v[216:219], a[164:167], v[172:175]
    buffer_load_dwordx4 v1, s[8:11], s81 offen lds
    v_mfma_f32_16x16x32_bf16 v[176:179], v[216:219], a[168:171], v[176:179]
    ds_read_b64_tr_b16 v[210:211], v9 offset:29184
    s_add_u32 m0, s35, 16384
    v_mfma_f32_16x16x32_bf16 v[180:183], v[216:219], a[172:175], v[180:183]
    buffer_load_dwordx4 v1, s[12:15], s81 offen lds
    v_mfma_f32_16x16x32_bf16 v[184:187], v[220:223], a[160:163], v[184:187]
    ds_read_b64_tr_b16 v[212:213], v11 offset:28672
    v_mfma_f32_16x16x32_bf16 v[188:191], v[220:223], a[164:167], v[188:191]
    v_mfma_f32_16x16x32_bf16 v[192:195], v[220:223], a[168:171], v[192:195]
    ds_read_b64_tr_b16 v[214:215], v11 offset:29184
    v_mfma_f32_16x16x32_bf16 v[196:199], v[220:223], a[172:175], v[196:199]
    s_waitcnt lgkmcnt(4)
    v_mfma_f32_16x16x32_bf16 v[104:107], v[200:203], a[176:179], v[104:107]
    ds_read_b64_tr_b16 v[216:217], v7 offset:32768
    v_mfma_f32_16x16x32_bf16 v[108:111], v[200:203], a[180:183], v[108:111]
    v_mfma_f32_16x16x32_bf16 v[112:115], v[200:203], a[184:187], v[112:115]
    ds_read_b64_tr_b16 v[218:219], v7 offset:33024
    v_mfma_f32_16x16x32_bf16 v[116:119], v[200:203], a[188:191], v[116:119]
    v_mfma_f32_16x16x32_bf16 v[120:123], v[204:207], a[176:179], v[120:123]
    ds_read_b64_tr_b16 v[220:221], v7 offset:34816
    v_mfma_f32_16x16x32_bf16 v[124:127], v[204:207], a[180:183], v[124:127]
    v_mfma_f32_16x16x32_bf16 v[128:131], v[204:207], a[184:187], v[128:131]
    ds_read_b64_tr_b16 v[222:223], v7 offset:35072
    v_mfma_f32_16x16x32_bf16 v[132:135], v[204:207], a[188:191], v[132:135]
    s_waitcnt lgkmcnt(4)
    v_mfma_f32_16x16x32_bf16 v[136:139], v[208:211], a[176:179], v[136:139]
    ds_read_b64_tr_b16 v[200:201], v9 offset:36864
    v_mfma_f32_16x16x32_bf16 v[140:143], v[208:211], a[180:183], v[140:143]
    v_mfma_f32_16x16x32_bf16 v[144:147], v[208:211], a[184:187], v[144:147]
    ds_read_b64_tr_b16 v[202:203], v9 offset:37376
    v_mfma_f32_16x16x32_bf16 v[148:151], v[208:211], a[188:191], v[148:151]
    v_mfma_f32_16x16x32_bf16 v[152:155], v[212:215], a[176:179], v[152:155]
    ds_read_b64_tr_b16 v[204:205], v11 offset:36864
    v_mfma_f32_16x16x32_bf16 v[156:159], v[212:215], a[180:183], v[156:159]
    v_mfma_f32_16x16x32_bf16 v[160:163], v[212:215], a[184:187], v[160:163]
    ds_read_b64_tr_b16 v[206:207], v11 offset:37376
    v_mfma_f32_16x16x32_bf16 v[164:167], v[212:215], a[188:191], v[164:167]
    s_waitcnt lgkmcnt(4)
    v_mfma_f32_16x16x32_bf16 v[168:171], v[216:219], a[176:179], v[168:171]
    ds_read_b64_tr_b16 v[208:209], v9 offset:40960
    v_mfma_f32_16x16x32_bf16 v[172:175], v[216:219], a[180:183], v[172:175]
    v_mfma_f32_16x16x32_bf16 v[176:179], v[216:219], a[184:187], v[176:179]
    ds_read_b64_tr_b16 v[210:211], v9 offset:41472
    v_mfma_f32_16x16x32_bf16 v[180:183], v[216:219], a[188:191], v[180:183]
    v_mfma_f32_16x16x32_bf16 v[184:187], v[220:223], a[176:179], v[184:187]
    ds_read_b64_tr_b16 v[212:213], v11 offset:40960
    v_mfma_f32_16x16x32_bf16 v[188:191], v[220:223], a[180:183], v[188:191]
    v_mfma_f32_16x16x32_bf16 v[192:195], v[220:223], a[184:187], v[192:195]
    ds_read_b64_tr_b16 v[214:215], v11 offset:41472
    v_mfma_f32_16x16x32_bf16 v[196:199], v[220:223], a[188:191], v[196:199]
    s_waitcnt lgkmcnt(4)
    v_mfma_f32_16x16x32_bf16 v[104:107], v[200:203], a[192:195], v[104:107]
    ds_read_b64_tr_b16 v[216:217], v7 offset:45056
    v_mfma_f32_16x16x32_bf16 v[108:111], v[200:203], a[196:199], v[108:111]
    v_mfma_f32_16x16x32_bf16 v[112:115], v[200:203], a[200:203], v[112:115]
    ds_read_b64_tr_b16 v[218:219], v7 offset:45312
    v_mfma_f32_16x16x32_bf16 v[116:119], v[200:203], a[204:207], v[116:119]
    v_mfma_f32_16x16x32_bf16 v[120:123], v[204:207], a[192:195], v[120:123]
    ds_read_b64_tr_b16 v[220:221], v7 offset:47104
    v_mfma_f32_16x16x32_bf16 v[124:127], v[204:207], a[196:199], v[124:127]
    v_mfma_f32_16x16x32_bf16 v[128:131], v[204:207], a[200:203], v[128:131]
    ds_read_b64_tr_b16 v[222:223], v7 offset:47360
    v_mfma_f32_16x16x32_bf16 v[132:135], v[204:207], a[204:207], v[132:135]
    s_waitcnt vmcnt(8) lgkmcnt(4)
    s_barrier
    v_mfma_f32_16x16x32_bf16 v[136:139], v[208:211], a[192:195], v[136:139]
    ds_read_b64_tr_b16 v[200:201], v9 offset:49152
    s_add_u32 m0, s35, 20480
    v_mfma_f32_16x16x32_bf16 v[140:143], v[208:211], a[196:199], v[140:143]
    buffer_load_dwordx4 v2, s[24:27], s81 offen lds
    v_mfma_f32_16x16x32_bf16 v[144:147], v[208:211], a[200:203], v[144:147]
    ds_read_b64_tr_b16 v[202:203], v9 offset:49664
    s_add_u32 s7, s7, 1
    v_mfma_f32_16x16x32_bf16 v[148:151], v[208:211], a[204:207], v[148:151]
    s_cmp_eq_u32 s7, 4
    s_cselect_b32 s100, s101, 0x80
    v_mfma_f32_16x16x32_bf16 v[152:155], v[212:215], a[192:195], v[152:155]
    ds_read_b64_tr_b16 v[204:205], v11 offset:49152
    v_add_u32 v1, s100, v1
    v_mfma_f32_16x16x32_bf16 v[156:159], v[212:215], a[196:199], v[156:159]
    s_add_u32 m0, s35, 24576
    v_mfma_f32_16x16x32_bf16 v[160:163], v[212:215], a[200:203], v[160:163]
    ds_read_b64_tr_b16 v[206:207], v11 offset:49664
    buffer_load_dwordx4 v1, s[8:11], s64 offen lds
    v_mfma_f32_16x16x32_bf16 v[164:167], v[212:215], a[204:207], v[164:167]
    s_add_u32 m0, s35, 28672
    s_waitcnt lgkmcnt(4)
    v_mfma_f32_16x16x32_bf16 v[168:171], v[216:219], a[192:195], v[168:171]
    ds_read_b64_tr_b16 v[208:209], v9 offset:53248
    buffer_load_dwordx4 v1, s[12:15], s64 offen lds
    v_mfma_f32_16x16x32_bf16 v[172:175], v[216:219], a[196:199], v[172:175]
    s_add_u32 m0, s35, 32768
    v_mfma_f32_16x16x32_bf16 v[176:179], v[216:219], a[200:203], v[176:179]
    ds_read_b64_tr_b16 v[210:211], v9 offset:53760
    buffer_load_dwordx4 v1, s[8:11], s65 offen lds
    v_mfma_f32_16x16x32_bf16 v[180:183], v[216:219], a[204:207], v[180:183]
    s_add_u32 m0, s35, 36864
    v_mfma_f32_16x16x32_bf16 v[184:187], v[220:223], a[192:195], v[184:187]
    ds_read_b64_tr_b16 v[212:213], v11 offset:53248
    buffer_load_dwordx4 v1, s[12:15], s65 offen lds
    v_mfma_f32_16x16x32_bf16 v[188:191], v[220:223], a[196:199], v[188:191]
    s_add_u32 m0, s35, 40960
    v_mfma_f32_16x16x32_bf16 v[192:195], v[220:223], a[200:203], v[192:195]
    ds_read_b64_tr_b16 v[214:215], v11 offset:53760
    buffer_load_dwordx4 v1, s[8:11], s66 offen lds
    v_mfma_f32_16x16x32_bf16 v[196:199], v[220:223], a[204:207], v[196:199]
    s_waitcnt lgkmcnt(4)
    v_mfma_f32_16x16x32_bf16 v[104:107], v[200:203], a[208:211], v[104:107]
    ds_read_b64_tr_b16 v[216:217], v7 offset:57344
    v_mfma_f32_16x16x32_bf16 v[108:111], v[200:203], a[212:215], v[108:111]
    v_mfma_f32_16x16x32_bf16 v[112:115], v[200:203], a[216:219], v[112:115]
    ds_read_b64_tr_b16 v[218:219], v7 offset:57600
    v_mfma_f32_16x16x32_bf16 v[116:119], v[200:203], a[220:223], v[116:119]
    v_mfma_f32_16x16x32_bf16 v[120:123], v[204:207], a[208:211], v[120:123]
    ds_read_b64_tr_b16 v[220:221], v7 offset:59392
    v_mfma_f32_16x16x32_bf16 v[124:127], v[204:207], a[212:215], v[124:127]
    v_mfma_f32_16x16x32_bf16 v[128:131], v[204:207], a[216:219], v[128:131]
    ds_read_b64_tr_b16 v[222:223], v7 offset:59648
    v_mfma_f32_16x16x32_bf16 v[132:135], v[204:207], a[220:223], v[132:135]
    s_waitcnt lgkmcnt(4)
    v_mfma_f32_16x16x32_bf16 v[136:139], v[208:211], a[208:211], v[136:139]
    ds_read_b64_tr_b16 v[200:201], v9 offset:61440
    v_mfma_f32_16x16x32_bf16 v[140:143], v[208:211], a[212:215], v[140:143]
    v_mfma_f32_16x16x32_bf16 v[144:147], v[208:211], a[216:219], v[144:147]
    ds_read_b64_tr_b16 v[202:203], v9 offset:61952
    v_mfma_f32_16x16x32_bf16 v[148:151], v[208:211], a[220:223], v[148:151]
    v_mfma_f32_16x16x32_bf16 v[152:155], v[212:215], a[208:211], v[152:155]
    ds_read_b64_tr_b16 v[204:205], v11 offset:61440
    v_mfma_f32_16x16x32_bf16 v[156:159], v[212:215], a[212:215], v[156:159]
    v_mfma_f32_16x16x32_bf16 v[160:163], v[212:215], a[216:219], v[160:163]
    ds_read_b64_tr_b16 v[206:207], v11 offset:61952
    v_mfma_f32_16x16x32_bf16 v[164:167], v[212:215], a[220:223], v[164:167]
    s_waitcnt lgkmcnt(4)
    v_mfma_f32_16x16x32_bf16 v[168:171], v[216:219], a[208:211], v[168:171]
    ds_read_b64_tr_b16 v[208:209], v10 offset:0
    v_mfma_f32_16x16x32_bf16 v[172:175], v[216:219], a[212:215], v[172:175]
    v_mfma_f32_16x16x32_bf16 v[176:179], v[216:219], a[216:219], v[176:179]
    ds_read_b64_tr_b16 v[210:211], v10 offset:512
    v_mfma_f32_16x16x32_bf16 v[180:183], v[216:219], a[220:223], v[180:183]
    v_mfma_f32_16x16x32_bf16 v[184:187], v[220:223], a[208:211], v[184:187]
    ds_read_b64_tr_b16 v[212:213], v12 offset:0
    v_mfma_f32_16x16x32_bf16 v[188:191], v[220:223], a[212:215], v[188:191]
    v_mfma_f32_16x16x32_bf16 v[192:195], v[220:223], a[216:219], v[192:195]
    ds_read_b64_tr_b16 v[214:215], v12 offset:512
    v_mfma_f32_16x16x32_bf16 v[196:199], v[220:223], a[220:223], v[196:199]
    s_waitcnt lgkmcnt(4)
    v_mfma_f32_16x16x32_bf16 v[104:107], v[200:203], a[224:227], v[104:107]
    ds_read_b64_tr_b16 v[216:217], v8 offset:4096
    v_mfma_f32_16x16x32_bf16 v[108:111], v[200:203], a[228:231], v[108:111]
    v_mfma_f32_16x16x32_bf16 v[112:115], v[200:203], a[232:235], v[112:115]
    ds_read_b64_tr_b16 v[218:219], v8 offset:4352
    v_mfma_f32_16x16x32_bf16 v[116:119], v[200:203], a[236:239], v[116:119]
    v_mfma_f32_16x16x32_bf16 v[120:123], v[204:207], a[224:227], v[120:123]
    ds_read_b64_tr_b16 v[220:221], v8 offset:6144
    v_mfma_f32_16x16x32_bf16 v[124:127], v[204:207], a[228:231], v[124:127]
    v_mfma_f32_16x16x32_bf16 v[128:131], v[204:207], a[232:235], v[128:131]
    ds_read_b64_tr_b16 v[222:223], v8 offset:6400
    v_mfma_f32_16x16x32_bf16 v[132:135], v[204:207], a[236:239], v[132:135]
    s_waitcnt vmcnt(8) lgkmcnt(4)
    s_barrier
    v_mfma_f32_16x16x32_bf16 v[136:139], v[208:211], a[224:227], v[136:139]
    ds_read_b64_tr_b16 v[200:201], v10 offset:8192
    s_add_u32 m0, s35, 45056
    v_mfma_f32_16x16x32_bf16 v[140:143], v[208:211], a[228:231], v[140:143]
    buffer_load_dwordx4 v1, s[12:15], s66 offen lds
    v_mfma_f32_16x16x32_bf16 v[144:147], v[208:211], a[232:235], v[144:147]
    ds_read_b64_tr_b16 v[202:203], v10 offset:8704
    s_add_u32 m0, s35, 49152
    v_mfma_f32_16x16x32_bf16 v[148:151], v[208:211], a[236:239], v[148:151]
    buffer_load_dwordx4 v1, s[8:11], s67 offen lds
    v_mfma_f32_16x16x32_bf16 v[152:155], v[212:215], a[224:227], v[152:155]
    ds_read_b64_tr_b16 v[204:205], v12 offset:8192
    s_add_u32 m0, s35, 53248
    v_mfma_f32_16x16x32_bf16 v[156:159], v[212:215], a[228:231], v[156:159]
    buffer_load_dwordx4 v1, s[12:15], s67 offen lds
    v_mfma_f32_16x16x32_bf16 v[160:163], v[212:215], a[232:235], v[160:163]
    ds_read_b64_tr_b16 v[206:207], v12 offset:8704
    s_add_u32 m0, s35, 57344
    v_mfma_f32_16x16x32_bf16 v[164:167], v[212:215], a[236:239], v[164:167]
    buffer_load_dwordx4 v1, s[8:11], s68 offen lds
    s_waitcnt lgkmcnt(4)
    v_mfma_f32_16x16x32_bf16 v[168:171], v[216:219], a[224:227], v[168:171]
    ds_read_b64_tr_b16 v[208:209], v10 offset:12288
    s_add_u32 m0, s35, 61440
    v_mfma_f32_16x16x32_bf16 v[172:175], v[216:219], a[228:231], v[172:175]
    buffer_load_dwordx4 v1, s[12:15], s68 offen lds
    v_mfma_f32_16x16x32_bf16 v[176:179], v[216:219], a[232:235], v[176:179]
    ds_read_b64_tr_b16 v[210:211], v10 offset:12800
    s_add_u32 m0, s35, 65536
    v_mfma_f32_16x16x32_bf16 v[180:183], v[216:219], a[236:239], v[180:183]
    buffer_load_dwordx4 v1, s[8:11], s69 offen lds
    v_mfma_f32_16x16x32_bf16 v[184:187], v[220:223], a[224:227], v[184:187]
    ds_read_b64_tr_b16 v[212:213], v12 offset:12288
    v_mfma_f32_16x16x32_bf16 v[188:191], v[220:223], a[228:231], v[188:191]
    v_mfma_f32_16x16x32_bf16 v[192:195], v[220:223], a[232:235], v[192:195]
    ds_read_b64_tr_b16 v[214:215], v12 offset:12800
    v_mfma_f32_16x16x32_bf16 v[196:199], v[220:223], a[236:239], v[196:199]
    s_waitcnt lgkmcnt(4)
    v_mfma_f32_16x16x32_bf16 v[104:107], v[200:203], a[240:243], v[104:107]
    ds_read_b64_tr_b16 v[216:217], v8 offset:16384
    v_mfma_f32_16x16x32_bf16 v[108:111], v[200:203], a[244:247], v[108:111]
    v_mfma_f32_16x16x32_bf16 v[112:115], v[200:203], a[248:251], v[112:115]
    ds_read_b64_tr_b16 v[218:219], v8 offset:16640
    v_mfma_f32_16x16x32_bf16 v[116:119], v[200:203], a[252:255], v[116:119]
    v_mfma_f32_16x16x32_bf16 v[120:123], v[204:207], a[240:243], v[120:123]
    ds_read_b64_tr_b16 v[220:221], v8 offset:18432
    v_mfma_f32_16x16x32_bf16 v[124:127], v[204:207], a[244:247], v[124:127]
    v_mfma_f32_16x16x32_bf16 v[128:131], v[204:207], a[248:251], v[128:131]
    ds_read_b64_tr_b16 v[222:223], v8 offset:18688
    v_mfma_f32_16x16x32_bf16 v[132:135], v[204:207], a[252:255], v[132:135]
    s_waitcnt lgkmcnt(4)
    v_mfma_f32_16x16x32_bf16 v[136:139], v[208:211], a[240:243], v[136:139]
    ds_read_b64_tr_b16 v[200:201], v9 offset:0
    v_mfma_f32_16x16x32_bf16 v[140:143], v[208:211], a[244:247], v[140:143]
    v_mfma_f32_16x16x32_bf16 v[144:147], v[208:211], a[248:251], v[144:147]
    ds_read_b64_tr_b16 v[202:203], v9 offset:512
    v_mfma_f32_16x16x32_bf16 v[148:151], v[208:211], a[252:255], v[148:151]
    v_mfma_f32_16x16x32_bf16 v[152:155], v[212:215], a[240:243], v[152:155]
    ds_read_b64_tr_b16 v[204:205], v11 offset:0
    v_mfma_f32_16x16x32_bf16 v[156:159], v[212:215], a[244:247], v[156:159]
    v_mfma_f32_16x16x32_bf16 v[160:163], v[212:215], a[248:251], v[160:163]
    ds_read_b64_tr_b16 v[206:207], v11 offset:512
    v_mfma_f32_16x16x32_bf16 v[164:167], v[212:215], a[252:255], v[164:167]
    s_waitcnt lgkmcnt(4)
    v_mfma_f32_16x16x32_bf16 v[168:171], v[216:219], a[240:243], v[168:171]
    ds_read_b64_tr_b16 v[208:209], v9 offset:4096
    v_mfma_f32_16x16x32_bf16 v[172:175], v[216:219], a[244:247], v[172:175]
    v_mfma_f32_16x16x32_bf16 v[176:179], v[216:219], a[248:251], v[176:179]
    ds_read_b64_tr_b16 v[210:211], v9 offset:4608
    v_mfma_f32_16x16x32_bf16 v[180:183], v[216:219], a[252:255], v[180:183]
    v_mfma_f32_16x16x32_bf16 v[184:187], v[220:223], a[240:243], v[184:187]
    ds_read_b64_tr_b16 v[212:213], v11 offset:4096
    v_mfma_f32_16x16x32_bf16 v[188:191], v[220:223], a[244:247], v[188:191]
    v_mfma_f32_16x16x32_bf16 v[192:195], v[220:223], a[248:251], v[192:195]
    ds_read_b64_tr_b16 v[214:215], v11 offset:4608
    v_mfma_f32_16x16x32_bf16 v[196:199], v[220:223], a[252:255], v[196:199]
    s_waitcnt lgkmcnt(4)
    v_mfma_f32_16x16x32_bf16 v[104:107], v[200:203], v[224:227], v[104:107]
    ds_read_b64_tr_b16 v[216:217], v7 offset:8192
    v_mfma_f32_16x16x32_bf16 v[108:111], v[200:203], v[228:231], v[108:111]
    v_mfma_f32_16x16x32_bf16 v[112:115], v[200:203], v[232:235], v[112:115]
    ds_read_b64_tr_b16 v[218:219], v7 offset:8448
    v_mfma_f32_16x16x32_bf16 v[116:119], v[200:203], v[236:239], v[116:119]
    v_mfma_f32_16x16x32_bf16 v[120:123], v[204:207], v[224:227], v[120:123]
    ds_read_b64_tr_b16 v[220:221], v7 offset:10240
    v_mfma_f32_16x16x32_bf16 v[124:127], v[204:207], v[228:231], v[124:127]
    v_mfma_f32_16x16x32_bf16 v[128:131], v[204:207], v[232:235], v[128:131]
    ds_read_b64_tr_b16 v[222:223], v7 offset:10496
    v_mfma_f32_16x16x32_bf16 v[132:135], v[204:207], v[236:239], v[132:135]
    s_waitcnt vmcnt(8) lgkmcnt(4)
    s_barrier
    v_mfma_f32_16x16x32_bf16 v[136:139], v[208:211], v[224:227], v[136:139]
    ds_read_b64_tr_b16 v[200:201], v9 offset:12288
    s_add_u32 m0, s35, 69632
    v_mfma_f32_16x16x32_bf16 v[140:143], v[208:211], v[228:231], v[140:143]
    buffer_load_dwordx4 v1, s[12:15], s69 offen lds
    v_mfma_f32_16x16x32_bf16 v[144:147], v[208:211], v[232:235], v[144:147]
    ds_read_b64_tr_b16 v[202:203], v9 offset:12800
    s_add_u32 m0, s35, 73728
    v_mfma_f32_16x16x32_bf16 v[148:151], v[208:211], v[236:239], v[148:151]
    buffer_load_dwordx4 v1, s[8:11], s70 offen lds
    v_mfma_f32_16x16x32_bf16 v[152:155], v[212:215], v[224:227], v[152:155]
    ds_read_b64_tr_b16 v[204:205], v11 offset:12288
    s_add_u32 m0, s35, 77824
    v_mfma_f32_16x16x32_bf16 v[156:159], v[212:215], v[228:231], v[156:159]
    buffer_load_dwordx4 v1, s[12:15], s70 offen lds
    v_mfma_f32_16x16x32_bf16 v[160:163], v[212:215], v[232:235], v[160:163]
    ds_read_b64_tr_b16 v[206:207], v11 offset:12800
    s_add_u32 m0, s35, 81920
    v_mfma_f32_16x16x32_bf16 v[164:167], v[212:215], v[236:239], v[164:167]
    buffer_load_dwordx4 v1, s[8:11], s71 offen lds
    s_waitcnt lgkmcnt(4)
    v_mfma_f32_16x16x32_bf16 v[168:171], v[216:219], v[224:227], v[168:171]
    ds_read_b64_tr_b16 v[208:209], v9 offset:16384
    s_add_u32 m0, s35, 0
    v_mfma_f32_16x16x32_bf16 v[172:175], v[216:219], v[228:231], v[172:175]
    buffer_load_dwordx4 v1, s[12:15], s71 offen lds
    v_mfma_f32_16x16x32_bf16 v[176:179], v[216:219], v[232:235], v[176:179]
    ds_read_b64_tr_b16 v[210:211], v9 offset:16896
    s_add_u32 m0, s35, 4096
    v_mfma_f32_16x16x32_bf16 v[180:183], v[216:219], v[236:239], v[180:183]
    buffer_load_dwordx4 v1, s[8:11], s72 offen lds
    v_mfma_f32_16x16x32_bf16 v[184:187], v[220:223], v[224:227], v[184:187]
    ds_read_b64_tr_b16 v[212:213], v11 offset:16384
    v_mfma_f32_16x16x32_bf16 v[188:191], v[220:223], v[228:231], v[188:191]
    v_mfma_f32_16x16x32_bf16 v[192:195], v[220:223], v[232:235], v[192:195]
    ds_read_b64_tr_b16 v[214:215], v11 offset:16896
    v_mfma_f32_16x16x32_bf16 v[196:199], v[220:223], v[236:239], v[196:199]
    s_waitcnt lgkmcnt(4)
    v_mfma_f32_16x16x32_bf16 v[104:107], v[200:203], v[240:243], v[104:107]
    ds_read_b64_tr_b16 v[216:217], v7 offset:20480
    v_mfma_f32_16x16x32_bf16 v[108:111], v[200:203], v[244:247], v[108:111]
    v_mfma_f32_16x16x32_bf16 v[112:115], v[200:203], v[248:251], v[112:115]
    ds_read_b64_tr_b16 v[218:219], v7 offset:20736
    v_mfma_f32_16x16x32_bf16 v[116:119], v[200:203], v[252:255], v[116:119]
    v_mfma_f32_16x16x32_bf16 v[120:123], v[204:207], v[240:243], v[120:123]
    ds_read_b64_tr_b16 v[220:221], v7 offset:22528
    v_mfma_f32_16x16x32_bf16 v[124:127], v[204:207], v[244:247], v[124:127]
    v_mfma_f32_16x16x32_bf16 v[128:131], v[204:207], v[248:251], v[128:131]
    ds_read_b64_tr_b16 v[222:223], v7 offset:22784
    v_mfma_f32_16x16x32_bf16 v[132:135], v[204:207], v[252:255], v[132:135]
    s_waitcnt lgkmcnt(4)
    v_mfma_f32_16x16x32_bf16 v[136:139], v[208:211], v[240:243], v[136:139]
    ds_read_b64_tr_b16 v[200:201], v9 offset:24576
    v_mfma_f32_16x16x32_bf16 v[140:143], v[208:211], v[244:247], v[140:143]
    v_mfma_f32_16x16x32_bf16 v[144:147], v[208:211], v[248:251], v[144:147]
    ds_read_b64_tr_b16 v[202:203], v9 offset:25088
    v_mfma_f32_16x16x32_bf16 v[148:151], v[208:211], v[252:255], v[148:151]
    v_mfma_f32_16x16x32_bf16 v[152:155], v[212:215], v[240:243], v[152:155]
    ds_read_b64_tr_b16 v[204:205], v11 offset:24576
    v_mfma_f32_16x16x32_bf16 v[156:159], v[212:215], v[244:247], v[156:159]
    v_mfma_f32_16x16x32_bf16 v[160:163], v[212:215], v[248:251], v[160:163]
    ds_read_b64_tr_b16 v[206:207], v11 offset:25088
    v_mfma_f32_16x16x32_bf16 v[164:167], v[212:215], v[252:255], v[164:167]
    s_waitcnt lgkmcnt(4)
    v_mfma_f32_16x16x32_bf16 v[168:171], v[216:219], v[240:243], v[168:171]
    ds_read_b64_tr_b16 v[208:209], v9 offset:28672
    v_mfma_f32_16x16x32_bf16 v[172:175], v[216:219], v[244:247], v[172:175]
    v_mfma_f32_16x16x32_bf16 v[176:179], v[216:219], v[248:251], v[176:179]
    ds_read_b64_tr_b16 v[210:211], v9 offset:29184
    v_mfma_f32_16x16x32_bf16 v[180:183], v[216:219], v[252:255], v[180:183]
    v_mfma_f32_16x16x32_bf16 v[184:187], v[220:223], v[240:243], v[184:187]
    ds_read_b64_tr_b16 v[212:213], v11 offset:28672
    v_mfma_f32_16x16x32_bf16 v[188:191], v[220:223], v[244:247], v[188:191]
    v_mfma_f32_16x16x32_bf16 v[192:195], v[220:223], v[248:251], v[192:195]
    ds_read_b64_tr_b16 v[214:215], v11 offset:29184
    v_mfma_f32_16x16x32_bf16 v[196:199], v[220:223], v[252:255], v[196:199]
    s_waitcnt lgkmcnt(4)
    v_mfma_f32_16x16x32_bf16 v[40:43], v[200:203], a[0:3], 0
    ds_read_b64_tr_b16 v[216:217], v9 offset:32768
    v_mfma_f32_16x16x32_bf16 v[44:47], v[200:203], a[4:7], 0
    v_mfma_f32_16x16x32_bf16 v[48:51], v[200:203], a[8:11], 0
    ds_read_b64_tr_b16 v[218:219], v9 offset:33280
    v_mfma_f32_16x16x32_bf16 v[52:55], v[200:203], a[12:15], 0
    v_mfma_f32_16x16x32_bf16 v[56:59], v[204:207], a[0:3], 0
    ds_read_b64_tr_b16 v[220:221], v11 offset:32768
    v_mfma_f32_16x16x32_bf16 v[60:63], v[204:207], a[4:7], 0
    v_mfma_f32_16x16x32_bf16 v[64:67], v[204:207], a[8:11], 0
    ds_read_b64_tr_b16 v[222:223], v11 offset:33280
    v_mfma_f32_16x16x32_bf16 v[68:71], v[204:207], a[12:15], 0
    s_waitcnt vmcnt(8) lgkmcnt(4)
    s_barrier
    v_mfma_f32_16x16x32_bf16 v[72:75], v[208:211], a[0:3], 0
    ds_read_b64_tr_b16 v[200:201], v9 offset:36864
    s_add_u32 m0, s35, 8192
    v_mfma_f32_16x16x32_bf16 v[76:79], v[208:211], a[4:7], 0
    buffer_load_dwordx4 v1, s[12:15], s72 offen lds
    v_mul_f32 v104, v104, v136
    v_mfma_f32_16x16x32_bf16 v[80:83], v[208:211], a[8:11], 0
    ds_read_b64_tr_b16 v[202:203], v9 offset:37376
    s_add_u32 m0, s35, 12288
    v_mfma_f32_16x16x32_bf16 v[84:87], v[208:211], a[12:15], 0
    buffer_load_dwordx4 v1, s[8:11], s73 offen lds
    v_mul_f32 v105, v105, v137
    v_mfma_f32_16x16x32_bf16 v[88:91], v[212:215], a[0:3], 0
    ds_read_b64_tr_b16 v[204:205], v11 offset:36864
    s_add_u32 m0, s35, 16384
    v_mfma_f32_16x16x32_bf16 v[92:95], v[212:215], a[4:7], 0
    buffer_load_dwordx4 v1, s[12:15], s73 offen lds
    v_mul_f32 v106, v106, v138
    v_mfma_f32_16x16x32_bf16 v[96:99], v[212:215], a[8:11], 0
    ds_read_b64_tr_b16 v[206:207], v11 offset:37376
    s_add_u32 m0, s35, 20480
    v_mfma_f32_16x16x32_bf16 v[100:103], v[212:215], a[12:15], 0
    buffer_load_dwordx4 v1, s[8:11], s74 offen lds
    s_waitcnt lgkmcnt(4)
    v_mfma_f32_16x16x32_bf16 v[40:43], v[216:219], a[16:19], v[40:43]
    ds_read_b64_tr_b16 v[208:209], v9 offset:40960
    s_add_u32 m0, s35, 24576
    v_mfma_f32_16x16x32_bf16 v[44:47], v[216:219], a[20:23], v[44:47]
    buffer_load_dwordx4 v1, s[12:15], s74 offen lds
    v_mul_f32 v107, v107, v139
    v_mfma_f32_16x16x32_bf16 v[48:51], v[216:219], a[24:27], v[48:51]
    ds_read_b64_tr_b16 v[210:211], v9 offset:41472
    s_add_u32 m0, s35, 28672
    v_mfma_f32_16x16x32_bf16 v[52:55], v[216:219], a[28:31], v[52:55]
    buffer_load_dwordx4 v1, s[8:11], s75 offen lds
    v_mul_f32 v120, v120, v152
    v_mfma_f32_16x16x32_bf16 v[56:59], v[220:223], a[16:19], v[56:59]
    ds_read_b64_tr_b16 v[212:213], v11 offset:40960
    v_mul_f32 v121, v121, v153
    v_mfma_f32_16x16x32_bf16 v[60:63], v[220:223], a[20:23], v[60:63]
    v_mul_f32 v122, v122, v154
    v_mul_f32 v123, v123, v155
    v_mfma_f32_16x16x32_bf16 v[64:67], v[220:223], a[24:27], v[64:67]
    ds_read_b64_tr_b16 v[214:215], v11 offset:41472
    v_cvt_pk_bf16_f32 v136, v104, v105
    v_mfma_f32_16x16x32_bf16 v[68:71], v[220:223], a[28:31], v[68:71]
    v_cvt_pk_bf16_f32 v137, v106, v107
    s_waitcnt lgkmcnt(4)
    v_mfma_f32_16x16x32_bf16 v[72:75], v[200:203], a[16:19], v[72:75]
    ds_read_b64_tr_b16 v[216:217], v9 offset:45056
    v_cvt_pk_bf16_f32 v138, v120, v121
    v_mfma_f32_16x16x32_bf16 v[76:79], v[200:203], a[20:23], v[76:79]
    v_cvt_pk_bf16_f32 v139, v122, v123
    ds_write_b128 v13, v[136:139] offset:16384
    v_mfma_f32_16x16x32_bf16 v[80:83], v[200:203], a[24:27], v[80:83]
    ds_read_b64_tr_b16 v[218:219], v9 offset:45568
    s_mov_b32 s91, 16384
    v_mfma_f32_16x16x32_bf16 v[84:87], v[200:203], a[28:31], v[84:87]
    buffer_store_dwordx4 v[136:139], v13, s[96:99], s91 offen offset:0 sc1
    v_mul_f32 v108, v108, v140
    v_mfma_f32_16x16x32_bf16 v[88:91], v[204:207], a[16:19], v[88:91]
    ds_read_b64_tr_b16 v[220:221], v11 offset:45056
    v_mul_f32 v109, v109, v141
    v_mfma_f32_16x16x32_bf16 v[92:95], v[204:207], a[20:23], v[92:95]
    v_mul_f32 v110, v110, v142
    v_mul_f32 v111, v111, v143
    v_mfma_f32_16x16x32_bf16 v[96:99], v[204:207], a[24:27], v[96:99]
    ds_read_b64_tr_b16 v[222:223], v11 offset:45568
    v_mul_f32 v124, v124, v156
    v_mfma_f32_16x16x32_bf16 v[100:103], v[204:207], a[28:31], v[100:103]
    v_mul_f32 v125, v125, v157
    s_waitcnt lgkmcnt(5)
    v_mfma_f32_16x16x32_bf16 v[40:43], v[208:211], a[32:35], v[40:43]
    ds_read_b64_tr_b16 v[200:201], v9 offset:49152
    v_mul_f32 v126, v126, v158
    v_mfma_f32_16x16x32_bf16 v[44:47], v[208:211], a[36:39], v[44:47]
    v_mul_f32 v127, v127, v159
    v_cvt_pk_bf16_f32 v140, v108, v109
    v_mfma_f32_16x16x32_bf16 v[48:51], v[208:211], a[40:43], v[48:51]
    ds_read_b64_tr_b16 v[202:203], v9 offset:49664
    v_cvt_pk_bf16_f32 v141, v110, v111
    v_mfma_f32_16x16x32_bf16 v[52:55], v[208:211], a[44:47], v[52:55]
    v_cvt_pk_bf16_f32 v142, v124, v125
    v_cvt_pk_bf16_f32 v143, v126, v127
    v_mfma_f32_16x16x32_bf16 v[56:59], v[212:215], a[32:35], v[56:59]
    ds_read_b64_tr_b16 v[204:205], v11 offset:49152
    v_mfma_f32_16x16x32_bf16 v[60:63], v[212:215], a[36:39], v[60:63]
    ds_write_b128 v13, v[140:143] offset:17408
    buffer_store_dwordx4 v[140:143], v13, s[96:99], s91 offen offset:1024 sc1
    v_mfma_f32_16x16x32_bf16 v[64:67], v[212:215], a[40:43], v[64:67]
    ds_read_b64_tr_b16 v[206:207], v11 offset:49664
    v_mul_f32 v112, v112, v144
    v_mfma_f32_16x16x32_bf16 v[68:71], v[212:215], a[44:47], v[68:71]
    v_mul_f32 v113, v113, v145
    s_waitcnt lgkmcnt(5)
    v_mfma_f32_16x16x32_bf16 v[72:75], v[216:219], a[32:35], v[72:75]
    ds_read_b64_tr_b16 v[208:209], v9 offset:53248
    v_mul_f32 v114, v114, v146
    v_mfma_f32_16x16x32_bf16 v[76:79], v[216:219], a[36:39], v[76:79]
    v_mul_f32 v115, v115, v147
    v_mul_f32 v128, v128, v160
    v_mfma_f32_16x16x32_bf16 v[80:83], v[216:219], a[40:43], v[80:83]
    ds_read_b64_tr_b16 v[210:211], v9 offset:53760
    v_mul_f32 v129, v129, v161
    v_mfma_f32_16x16x32_bf16 v[84:87], v[216:219], a[44:47], v[84:87]
    v_mul_f32 v130, v130, v162
    v_mul_f32 v131, v131, v163
    v_mfma_f32_16x16x32_bf16 v[88:91], v[220:223], a[32:35], v[88:91]
    ds_read_b64_tr_b16 v[212:213], v11 offset:53248
    v_cvt_pk_bf16_f32 v144, v112, v113
    v_mfma_f32_16x16x32_bf16 v[92:95], v[220:223], a[36:39], v[92:95]
    v_cvt_pk_bf16_f32 v145, v114, v115
    v_cvt_pk_bf16_f32 v146, v128, v129
    v_mfma_f32_16x16x32_bf16 v[96:99], v[220:223], a[40:43], v[96:99]
    ds_read_b64_tr_b16 v[214:215], v11 offset:53760
    v_cvt_pk_bf16_f32 v147, v130, v131
    v_mfma_f32_16x16x32_bf16 v[100:103], v[220:223], a[44:47], v[100:103]
    ds_write_b128 v13, v[144:147] offset:18432
    s_waitcnt lgkmcnt(5)
    v_mfma_f32_16x16x32_bf16 v[40:43], v[200:203], a[48:51], v[40:43]
    ds_read_b64_tr_b16 v[216:217], v9 offset:57344
    buffer_store_dwordx4 v[144:147], v13, s[96:99], s91 offen offset:2048 sc1
    v_mfma_f32_16x16x32_bf16 v[44:47], v[200:203], a[52:55], v[44:47]
    v_mul_f32 v116, v116, v148
    v_mul_f32 v117, v117, v149
    v_mfma_f32_16x16x32_bf16 v[48:51], v[200:203], a[56:59], v[48:51]
    ds_read_b64_tr_b16 v[218:219], v9 offset:57856
    v_mul_f32 v118, v118, v150
    v_mfma_f32_16x16x32_bf16 v[52:55], v[200:203], a[60:63], v[52:55]
    v_mul_f32 v119, v119, v151
    v_mul_f32 v132, v132, v164
    v_mfma_f32_16x16x32_bf16 v[56:59], v[204:207], a[48:51], v[56:59]
    ds_read_b64_tr_b16 v[220:221], v11 offset:57344
    v_mul_f32 v133, v133, v165
    v_mfma_f32_16x16x32_bf16 v[60:63], v[204:207], a[52:55], v[60:63]
    v_mul_f32 v134, v134, v166
    v_mul_f32 v135, v135, v167
    v_mfma_f32_16x16x32_bf16 v[64:67], v[204:207], a[56:59], v[64:67]
    ds_read_b64_tr_b16 v[222:223], v11 offset:57856
    v_cvt_pk_bf16_f32 v148, v116, v117
    v_mfma_f32_16x16x32_bf16 v[68:71], v[204:207], a[60:63], v[68:71]
    s_waitcnt vmcnt(11) lgkmcnt(5)
    s_barrier
    v_mfma_f32_16x16x32_bf16 v[72:75], v[208:211], a[48:51], v[72:75]
    ds_read_b64_tr_b16 v[200:201], v9 offset:61440
    s_add_u32 m0, s35, 32768
    v_mfma_f32_16x16x32_bf16 v[76:79], v[208:211], a[52:55], v[76:79]
    buffer_load_dwordx4 v1, s[12:15], s75 offen lds
    v_cvt_pk_bf16_f32 v149, v118, v119
    v_mfma_f32_16x16x32_bf16 v[80:83], v[208:211], a[56:59], v[80:83]
    ds_read_b64_tr_b16 v[202:203], v9 offset:61952
    s_add_u32 m0, s35, 36864
    v_mfma_f32_16x16x32_bf16 v[84:87], v[208:211], a[60:63], v[84:87]
    buffer_load_dwordx4 v1, s[8:11], s76 offen lds
    v_cvt_pk_bf16_f32 v150, v132, v133
    v_mfma_f32_16x16x32_bf16 v[88:91], v[212:215], a[48:51], v[88:91]
    ds_read_b64_tr_b16 v[204:205], v11 offset:61440
    s_add_u32 m0, s35, 40960
    v_mfma_f32_16x16x32_bf16 v[92:95], v[212:215], a[52:55], v[92:95]
    buffer_load_dwordx4 v1, s[12:15], s76 offen lds
    v_cvt_pk_bf16_f32 v151, v134, v135
    v_mfma_f32_16x16x32_bf16 v[96:99], v[212:215], a[56:59], v[96:99]
    ds_read_b64_tr_b16 v[206:207], v11 offset:61952
    s_add_u32 m0, s35, 45056
    v_mfma_f32_16x16x32_bf16 v[100:103], v[212:215], a[60:63], v[100:103]
    buffer_load_dwordx4 v1, s[8:11], s77 offen lds
    s_waitcnt lgkmcnt(4)
    v_mfma_f32_16x16x32_bf16 v[40:43], v[216:219], a[64:67], v[40:43]
    ds_read_b64_tr_b16 v[208:209], v10 offset:0
    s_add_u32 m0, s35, 49152
    v_mfma_f32_16x16x32_bf16 v[44:47], v[216:219], a[68:71], v[44:47]
    buffer_load_dwordx4 v1, s[12:15], s77 offen lds
    ds_write_b128 v13, v[148:151] offset:19456
    v_mfma_f32_16x16x32_bf16 v[48:51], v[216:219], a[72:75], v[48:51]
    ds_read_b64_tr_b16 v[210:211], v10 offset:512
    s_add_u32 m0, s35, 53248
    v_mfma_f32_16x16x32_bf16 v[52:55], v[216:219], a[76:79], v[52:55]
    buffer_load_dwordx4 v1, s[8:11], s78 offen lds
    v_mfma_f32_16x16x32_bf16 v[56:59], v[220:223], a[64:67], v[56:59]
    ds_read_b64_tr_b16 v[212:213], v12 offset:0
    buffer_store_dwordx4 v[148:151], v13, s[96:99], s91 offen offset:3072 sc1
    v_mfma_f32_16x16x32_bf16 v[60:63], v[220:223], a[68:71], v[60:63]
    v_lshrrev_b32 v38, 4, v0
    v_lshrrev_b32 v39, 1, v38
    v_mfma_f32_16x16x32_bf16 v[64:67], v[220:223], a[72:75], v[64:67]
    ds_read_b64_tr_b16 v[214:215], v12 offset:512
    v_add_u32 v7, 0x10000, v14
    v_mfma_f32_16x16x32_bf16 v[68:71], v[220:223], a[76:79], v[68:71]
    v_and_b32 v8, 15, v0
    s_waitcnt lgkmcnt(5)
    v_mfma_f32_16x16x32_bf16 v[72:75], v[200:203], a[64:67], v[72:75]
    ds_read_b64_tr_b16 v[216:217], v10 offset:4096
    v_lshlrev_b32 v8, 6, v8
    v_mfma_f32_16x16x32_bf16 v[76:79], v[200:203], a[68:71], v[76:79]
    v_lshl_add_u32 v8, v39, 4, v8
    v_and_b32 v39, 1, v38
    v_mfma_f32_16x16x32_bf16 v[80:83], v[200:203], a[72:75], v[80:83]
    ds_read_b64_tr_b16 v[218:219], v10 offset:4608
    v_lshl_add_u32 v8, v39, 5, v8
    v_mfma_f32_16x16x32_bf16 v[84:87], v[200:203], a[76:79], v[84:87]
    s_lshl_b32 s36, s93, 13
    s_lshl_b32 s37, s92, 12
    v_mfma_f32_16x16x32_bf16 v[88:91], v[204:207], a[64:67], v[88:91]
    ds_read_b64_tr_b16 v[220:221], v12 offset:4096
    s_add_u32 s36, s36, s37
    v_mfma_f32_16x16x32_bf16 v[92:95], v[204:207], a[68:71], v[92:95]
    v_add_u32 v8, s36, v8
    v_mfma_f32_16x16x32_bf16 v[96:99], v[204:207], a[72:75], v[96:99]
    ds_read_b64_tr_b16 v[222:223], v12 offset:4608
    v_mfma_f32_16x16x32_bf16 v[100:103], v[204:207], a[76:79], v[100:103]
    s_lshl_b32 s36, s33, 4
    s_add_u32 s36, s36, s34
    s_waitcnt lgkmcnt(4)
    v_mfma_f32_16x16x32_bf16 v[40:43], v[208:211], a[80:83], v[40:43]
    ds_read_b64_tr_b16 v[200:201], v10 offset:8192
    v_mfma_f32_16x16x32_bf16 v[44:47], v[208:211], a[84:87], v[44:47]
    s_mul_i32 s36, s36, 147456
    s_add_u32 s36, s36, 6291456
    v_mfma_f32_16x16x32_bf16 v[48:51], v[208:211], a[88:91], v[48:51]
    ds_read_b64_tr_b16 v[202:203], v10 offset:8704
    v_mfma_f32_16x16x32_bf16 v[52:55], v[208:211], a[92:95], v[52:55]
    s_add_u32 s24, s4, s36
    s_addc_u32 s25, s5, 0
    v_mfma_f32_16x16x32_bf16 v[56:59], v[212:215], a[80:83], v[56:59]
    ds_read_b64_tr_b16 v[204:205], v12 offset:8192
    v_mfma_f32_16x16x32_bf16 v[60:63], v[212:215], a[84:87], v[60:63]
    s_mov_b32 s26, 147456
    s_mov_b32 s27, 0x20000
    v_mfma_f32_16x16x32_bf16 v[64:67], v[212:215], a[88:91], v[64:67]
    ds_read_b64_tr_b16 v[206:207], v12 offset:8704
    s_mul_i32 s94, s3, 81920
    v_mfma_f32_16x16x32_bf16 v[68:71], v[212:215], a[92:95], v[68:71]
    s_xor_b32 s57, s2, 8
    s_lshl_b32 s57, s57, 6
    s_waitcnt lgkmcnt(4)
    v_mfma_f32_16x16x32_bf16 v[72:75], v[216:219], a[80:83], v[72:75]
    ds_read_b64_tr_b16 v[208:209], v10 offset:12288
    v_mfma_f32_16x16x32_bf16 v[76:79], v[216:219], a[84:87], v[76:79]
    s_lshl_b32 s37, s92, 3
    s_add_u32 s57, s57, s37
    v_mfma_f32_16x16x32_bf16 v[80:83], v[216:219], a[88:91], v[80:83]
    ds_read_b64_tr_b16 v[210:211], v10 offset:12800
    v_mfma_f32_16x16x32_bf16 v[84:87], v[216:219], a[92:95], v[84:87]
    s_lshl_b32 s36, s92, 12
    s_lshl_b32 s37, s93, 9
    v_mfma_f32_16x16x32_bf16 v[88:91], v[220:223], a[80:83], v[88:91]
    ds_read_b64_tr_b16 v[212:213], v12 offset:12288
    v_mfma_f32_16x16x32_bf16 v[92:95], v[220:223], a[84:87], v[92:95]
    s_add_u32 s36, s36, s37
    s_add_u32 s36, s36, 90112
    v_mfma_f32_16x16x32_bf16 v[96:99], v[220:223], a[88:91], v[96:99]
    ds_read_b64_tr_b16 v[214:215], v12 offset:12800
    v_lshl_add_u32 v39, v0, 3, s36
    v_mfma_f32_16x16x32_bf16 v[100:103], v[220:223], a[92:95], v[100:103]
    v_mul_f32 v168, v168, v184
    s_waitcnt lgkmcnt(4)
    v_mfma_f32_16x16x32_bf16 v[40:43], v[200:203], a[96:99], v[40:43]
    ds_read_b64_tr_b16 v[216:217], v10 offset:16384
    v_mul_f32 v169, v169, v185
    v_mfma_f32_16x16x32_bf16 v[44:47], v[200:203], a[100:103], v[44:47]
    v_mul_f32 v170, v170, v186
    v_mul_f32 v171, v171, v187
    v_mfma_f32_16x16x32_bf16 v[48:51], v[200:203], a[104:107], v[48:51]
    ds_read_b64_tr_b16 v[218:219], v10 offset:16896
    v_cvt_pk_bf16_f32 v184, v168, v169
    v_mfma_f32_16x16x32_bf16 v[52:55], v[200:203], a[108:111], v[52:55]
    v_cvt_pk_bf16_f32 v185, v170, v171
    ds_write_b64 v37, v[184:185] offset:0
    v_mfma_f32_16x16x32_bf16 v[56:59], v[204:207], a[96:99], v[56:59]
    ds_read_b64_tr_b16 v[220:221], v12 offset:16384
    buffer_store_dwordx2 v[184:185], v39, s[96:99], 0 offen offset:0 sc1
    v_mfma_f32_16x16x32_bf16 v[60:63], v[204:207], a[100:103], v[60:63]
    v_mul_f32 v172, v172, v188
    v_mul_f32 v173, v173, v189
    v_mfma_f32_16x16x32_bf16 v[64:67], v[204:207], a[104:107], v[64:67]
    ds_read_b64_tr_b16 v[222:223], v12 offset:16896
    v_mul_f32 v174, v174, v190
    v_mfma_f32_16x16x32_bf16 v[68:71], v[204:207], a[108:111], v[68:71]
    s_waitcnt vmcnt(13) lgkmcnt(5)
    s_barrier
    v_mfma_f32_16x16x32_bf16 v[72:75], v[208:211], a[96:99], v[72:75]
    ds_read_b64_tr_b16 v[200:201], v9 offset:0
    s_add_u32 m0, s35, 57344
    v_mfma_f32_16x16x32_bf16 v[76:79], v[208:211], a[100:103], v[76:79]
    buffer_load_dwordx4 v1, s[12:15], s78 offen lds
    v_mul_f32 v175, v175, v191
    v_mfma_f32_16x16x32_bf16 v[80:83], v[208:211], a[104:107], v[80:83]
    ds_read_b64_tr_b16 v[202:203], v9 offset:512
    s_add_u32 m0, s35, 61440
    v_mfma_f32_16x16x32_bf16 v[84:87], v[208:211], a[108:111], v[84:87]
    buffer_load_dwordx4 v1, s[8:11], s79 offen lds
    v_cvt_pk_bf16_f32 v188, v172, v173
    v_mfma_f32_16x16x32_bf16 v[88:91], v[212:215], a[96:99], v[88:91]
    ds_read_b64_tr_b16 v[204:205], v11 offset:0
    s_add_u32 m0, s35, 65536
    v_mfma_f32_16x16x32_bf16 v[92:95], v[212:215], a[100:103], v[92:95]
    buffer_load_dwordx4 v1, s[12:15], s79 offen lds
    v_cvt_pk_bf16_f32 v189, v174, v175
    v_mfma_f32_16x16x32_bf16 v[96:99], v[212:215], a[104:107], v[96:99]
    ds_read_b64_tr_b16 v[206:207], v11 offset:512
    s_add_u32 m0, s35, 69632
    v_mfma_f32_16x16x32_bf16 v[100:103], v[212:215], a[108:111], v[100:103]
    buffer_load_dwordx4 v1, s[8:11], s80 offen lds
    s_waitcnt lgkmcnt(4)
    v_mfma_f32_16x16x32_bf16 v[40:43], v[216:219], a[112:115], v[40:43]
    ds_read_b64_tr_b16 v[208:209], v9 offset:4096
    s_add_u32 m0, s35, 73728
    v_mfma_f32_16x16x32_bf16 v[44:47], v[216:219], a[116:119], v[44:47]
    buffer_load_dwordx4 v1, s[12:15], s80 offen lds
    ds_write_b64 v37, v[188:189] offset:1024
    v_mfma_f32_16x16x32_bf16 v[48:51], v[216:219], a[120:123], v[48:51]
    ds_read_b64_tr_b16 v[210:211], v9 offset:4608
    s_add_u32 m0, s35, 77824
    v_mfma_f32_16x16x32_bf16 v[52:55], v[216:219], a[124:127], v[52:55]
    buffer_load_dwordx4 v1, s[8:11], s81 offen lds
    v_mfma_f32_16x16x32_bf16 v[56:59], v[220:223], a[112:115], v[56:59]
    ds_read_b64_tr_b16 v[212:213], v11 offset:4096
    buffer_store_dwordx2 v[188:189], v39, s[96:99], 0 offen offset:1024 sc1
    v_mfma_f32_16x16x32_bf16 v[60:63], v[220:223], a[116:119], v[60:63]
    v_mul_f32 v176, v176, v192
    v_mul_f32 v177, v177, v193
    v_mfma_f32_16x16x32_bf16 v[64:67], v[220:223], a[120:123], v[64:67]
    ds_read_b64_tr_b16 v[214:215], v11 offset:4608
    v_mul_f32 v178, v178, v194
    v_mfma_f32_16x16x32_bf16 v[68:71], v[220:223], a[124:127], v[68:71]
    v_mul_f32 v179, v179, v195
    s_waitcnt lgkmcnt(5)
    v_mfma_f32_16x16x32_bf16 v[72:75], v[200:203], a[112:115], v[72:75]
    ds_read_b64_tr_b16 v[216:217], v9 offset:8192
    v_cvt_pk_bf16_f32 v192, v176, v177
    v_mfma_f32_16x16x32_bf16 v[76:79], v[200:203], a[116:119], v[76:79]
    v_cvt_pk_bf16_f32 v193, v178, v179
    ds_write_b64 v37, v[192:193] offset:2048
    v_mfma_f32_16x16x32_bf16 v[80:83], v[200:203], a[120:123], v[80:83]
    ds_read_b64_tr_b16 v[218:219], v9 offset:8704
    buffer_store_dwordx2 v[192:193], v39, s[96:99], 0 offen offset:2048 sc1
    v_mfma_f32_16x16x32_bf16 v[84:87], v[200:203], a[124:127], v[84:87]
    v_mul_f32 v180, v180, v196
    v_mul_f32 v181, v181, v197
    v_mfma_f32_16x16x32_bf16 v[88:91], v[204:207], a[112:115], v[88:91]
    ds_read_b64_tr_b16 v[220:221], v11 offset:8192
    v_mul_f32 v182, v182, v198
    v_mfma_f32_16x16x32_bf16 v[92:95], v[204:207], a[116:119], v[92:95]
    v_mul_f32 v183, v183, v199
    v_cvt_pk_bf16_f32 v196, v180, v181
    v_mfma_f32_16x16x32_bf16 v[96:99], v[204:207], a[120:123], v[96:99]
    ds_read_b64_tr_b16 v[222:223], v11 offset:8704
    v_cvt_pk_bf16_f32 v197, v182, v183
    v_mfma_f32_16x16x32_bf16 v[100:103], v[204:207], a[124:127], v[100:103]
    ds_write_b64 v37, v[196:197] offset:3072
    s_waitcnt lgkmcnt(6)
    v_mfma_f32_16x16x32_bf16 v[40:43], v[208:211], a[128:131], v[40:43]
    ds_read_b64_tr_b16 v[200:201], v9 offset:12288
    buffer_store_dwordx2 v[196:197], v39, s[96:99], 0 offen offset:3072 sc1
    v_mfma_f32_16x16x32_bf16 v[44:47], v[208:211], a[132:135], v[44:47]
    v_mfma_f32_16x16x32_bf16 v[48:51], v[208:211], a[136:139], v[48:51]
    ds_read_b64_tr_b16 v[202:203], v9 offset:12800
    v_mfma_f32_16x16x32_bf16 v[52:55], v[208:211], a[140:143], v[52:55]
    v_mfma_f32_16x16x32_bf16 v[56:59], v[212:215], a[128:131], v[56:59]
    ds_read_b64_tr_b16 v[204:205], v11 offset:12288
    v_mfma_f32_16x16x32_bf16 v[60:63], v[212:215], a[132:135], v[60:63]
    v_mfma_f32_16x16x32_bf16 v[64:67], v[212:215], a[136:139], v[64:67]
    ds_read_b64_tr_b16 v[206:207], v11 offset:12800
    v_mfma_f32_16x16x32_bf16 v[68:71], v[212:215], a[140:143], v[68:71]
    s_waitcnt lgkmcnt(5)
    v_mfma_f32_16x16x32_bf16 v[72:75], v[216:219], a[128:131], v[72:75]
    ds_read_b64_tr_b16 v[208:209], v9 offset:16384
    v_mfma_f32_16x16x32_bf16 v[76:79], v[216:219], a[132:135], v[76:79]
    v_mfma_f32_16x16x32_bf16 v[80:83], v[216:219], a[136:139], v[80:83]
    ds_read_b64_tr_b16 v[210:211], v9 offset:16896
    v_mfma_f32_16x16x32_bf16 v[84:87], v[216:219], a[140:143], v[84:87]
    v_mfma_f32_16x16x32_bf16 v[88:91], v[220:223], a[128:131], v[88:91]
    ds_read_b64_tr_b16 v[212:213], v11 offset:16384
    v_mfma_f32_16x16x32_bf16 v[92:95], v[220:223], a[132:135], v[92:95]
    v_mfma_f32_16x16x32_bf16 v[96:99], v[220:223], a[136:139], v[96:99]
    ds_read_b64_tr_b16 v[214:215], v11 offset:16896
    v_mfma_f32_16x16x32_bf16 v[100:103], v[220:223], a[140:143], v[100:103]
    s_waitcnt lgkmcnt(4)
    v_mfma_f32_16x16x32_bf16 v[40:43], v[200:203], a[144:147], v[40:43]
    ds_read_b64_tr_b16 v[216:217], v9 offset:20480
    v_mfma_f32_16x16x32_bf16 v[44:47], v[200:203], a[148:151], v[44:47]
    v_mfma_f32_16x16x32_bf16 v[48:51], v[200:203], a[152:155], v[48:51]
    ds_read_b64_tr_b16 v[218:219], v9 offset:20992
    v_mfma_f32_16x16x32_bf16 v[52:55], v[200:203], a[156:159], v[52:55]
    v_mfma_f32_16x16x32_bf16 v[56:59], v[204:207], a[144:147], v[56:59]
    ds_read_b64_tr_b16 v[220:221], v11 offset:20480
    v_mfma_f32_16x16x32_bf16 v[60:63], v[204:207], a[148:151], v[60:63]
    v_mfma_f32_16x16x32_bf16 v[64:67], v[204:207], a[152:155], v[64:67]
    ds_read_b64_tr_b16 v[222:223], v11 offset:20992
    v_mfma_f32_16x16x32_bf16 v[68:71], v[204:207], a[156:159], v[68:71]
    s_waitcnt vmcnt(13) lgkmcnt(4)
    s_barrier
    v_mfma_f32_16x16x32_bf16 v[72:75], v[208:211], a[144:147], v[72:75]
    ds_read_b64_tr_b16 v[200:201], v9 offset:24576
    s_add_u32 m0, s35, 81920
    v_mfma_f32_16x16x32_bf16 v[76:79], v[208:211], a[148:151], v[76:79]
    buffer_load_dwordx4 v1, s[12:15], s81 offen lds
    v_mfma_f32_16x16x32_bf16 v[80:83], v[208:211], a[152:155], v[80:83]
    ds_read_b64_tr_b16 v[202:203], v9 offset:25088
    s_add_u32 s7, s7, 1
    v_mfma_f32_16x16x32_bf16 v[84:87], v[208:211], a[156:159], v[84:87]
    s_cmp_eq_u32 s7, 4
    s_cselect_b32 s100, s101, 0x80
    v_mfma_f32_16x16x32_bf16 v[88:91], v[212:215], a[144:147], v[88:91]
    ds_read_b64_tr_b16 v[204:205], v11 offset:24576
    v_add_u32 v1, s100, v1
    v_mfma_f32_16x16x32_bf16 v[92:95], v[212:215], a[148:151], v[92:95]
    s_add_u32 m0, s35, 0
    v_mfma_f32_16x16x32_bf16 v[96:99], v[212:215], a[152:155], v[96:99]
    ds_read_b64_tr_b16 v[206:207], v11 offset:25088
    buffer_load_dwordx4 v1, s[8:11], s64 offen lds
    v_mfma_f32_16x16x32_bf16 v[100:103], v[212:215], a[156:159], v[100:103]
    s_add_u32 m0, s35, 4096
    s_waitcnt lgkmcnt(4)
    v_mfma_f32_16x16x32_bf16 v[40:43], v[216:219], a[160:163], v[40:43]
    ds_read_b64_tr_b16 v[208:209], v9 offset:28672
    buffer_load_dwordx4 v1, s[12:15], s64 offen lds
    v_mfma_f32_16x16x32_bf16 v[44:47], v[216:219], a[164:167], v[44:47]
    s_add_u32 m0, s35, 8192
    s_waitcnt vmcnt(13)
    v_mfma_f32_16x16x32_bf16 v[48:51], v[216:219], a[168:171], v[48:51]
    ds_read_b64_tr_b16 v[210:211], v9 offset:29184
    buffer_load_dwordx4 v1, s[8:11], s65 offen lds
    v_mfma_f32_16x16x32_bf16 v[52:55], v[216:219], a[172:175], v[52:55]
    s_add_u32 m0, s35, 12288
    v_mfma_f32_16x16x32_bf16 v[56:59], v[220:223], a[160:163], v[56:59]
    ds_read_b64_tr_b16 v[212:213], v11 offset:28672
    buffer_load_dwordx4 v1, s[12:15], s65 offen lds
    v_mfma_f32_16x16x32_bf16 v[60:63], v[220:223], a[164:167], v[60:63]
    s_add_u32 m0, s35, 16384
    v_mfma_f32_16x16x32_bf16 v[64:67], v[220:223], a[168:171], v[64:67]
    ds_read_b64_tr_b16 v[214:215], v11 offset:29184
    buffer_load_dwordx4 v1, s[8:11], s66 offen lds
    v_mfma_f32_16x16x32_bf16 v[68:71], v[220:223], a[172:175], v[68:71]
    buffer_store_dword v14, off, s[20:23], s56 offset:16 sc1
    s_waitcnt lgkmcnt(4)
    v_mfma_f32_16x16x32_bf16 v[72:75], v[200:203], a[160:163], v[72:75]
    ds_read_b64_tr_b16 v[216:217], v9 offset:32768
    v_mfma_f32_16x16x32_bf16 v[76:79], v[200:203], a[164:167], v[76:79]
    v_mfma_f32_16x16x32_bf16 v[80:83], v[200:203], a[168:171], v[80:83]
    ds_read_b64_tr_b16 v[218:219], v9 offset:33280
    v_mfma_f32_16x16x32_bf16 v[84:87], v[200:203], a[172:175], v[84:87]
    v_mfma_f32_16x16x32_bf16 v[88:91], v[204:207], a[160:163], v[88:91]
    ds_read_b64_tr_b16 v[220:221], v11 offset:32768
    v_mfma_f32_16x16x32_bf16 v[92:95], v[204:207], a[164:167], v[92:95]
    v_mfma_f32_16x16x32_bf16 v[96:99], v[204:207], a[168:171], v[96:99]
    ds_read_b64_tr_b16 v[222:223], v11 offset:33280
    v_mfma_f32_16x16x32_bf16 v[100:103], v[204:207], a[172:175], v[100:103]
    s_waitcnt lgkmcnt(4)
    v_mfma_f32_16x16x32_bf16 v[40:43], v[208:211], a[176:179], v[40:43]
    ds_read_b64_tr_b16 v[200:201], v9 offset:36864
    v_mfma_f32_16x16x32_bf16 v[44:47], v[208:211], a[180:183], v[44:47]
    v_mfma_f32_16x16x32_bf16 v[48:51], v[208:211], a[184:187], v[48:51]
    ds_read_b64_tr_b16 v[202:203], v9 offset:37376
    v_mfma_f32_16x16x32_bf16 v[52:55], v[208:211], a[188:191], v[52:55]
    v_mfma_f32_16x16x32_bf16 v[56:59], v[212:215], a[176:179], v[56:59]
    ds_read_b64_tr_b16 v[204:205], v11 offset:36864
    v_mfma_f32_16x16x32_bf16 v[60:63], v[212:215], a[180:183], v[60:63]
    v_mfma_f32_16x16x32_bf16 v[64:67], v[212:215], a[184:187], v[64:67]
    ds_read_b64_tr_b16 v[206:207], v11 offset:37376
    v_mfma_f32_16x16x32_bf16 v[68:71], v[212:215], a[188:191], v[68:71]
    s_waitcnt lgkmcnt(4)
    v_mfma_f32_16x16x32_bf16 v[72:75], v[216:219], a[176:179], v[72:75]
    ds_read_b64_tr_b16 v[208:209], v9 offset:40960
    v_mfma_f32_16x16x32_bf16 v[76:79], v[216:219], a[180:183], v[76:79]
    v_mfma_f32_16x16x32_bf16 v[80:83], v[216:219], a[184:187], v[80:83]
    ds_read_b64_tr_b16 v[210:211], v9 offset:41472
    v_mfma_f32_16x16x32_bf16 v[84:87], v[216:219], a[188:191], v[84:87]
    v_mfma_f32_16x16x32_bf16 v[88:91], v[220:223], a[176:179], v[88:91]
    ds_read_b64_tr_b16 v[212:213], v11 offset:40960
    v_mfma_f32_16x16x32_bf16 v[92:95], v[220:223], a[180:183], v[92:95]
    v_mfma_f32_16x16x32_bf16 v[96:99], v[220:223], a[184:187], v[96:99]
    ds_read_b64_tr_b16 v[214:215], v11 offset:41472
    v_mfma_f32_16x16x32_bf16 v[100:103], v[220:223], a[188:191], v[100:103]
    s_waitcnt lgkmcnt(4)
    v_mfma_f32_16x16x32_bf16 v[40:43], v[200:203], a[192:195], v[40:43]
    ds_read_b64_tr_b16 v[216:217], v9 offset:45056
    v_mfma_f32_16x16x32_bf16 v[44:47], v[200:203], a[196:199], v[44:47]
    v_mfma_f32_16x16x32_bf16 v[48:51], v[200:203], a[200:203], v[48:51]
    ds_read_b64_tr_b16 v[218:219], v9 offset:45568
    v_mfma_f32_16x16x32_bf16 v[52:55], v[200:203], a[204:207], v[52:55]
    v_mfma_f32_16x16x32_bf16 v[56:59], v[204:207], a[192:195], v[56:59]
    ds_read_b64_tr_b16 v[220:221], v11 offset:45056
    v_mfma_f32_16x16x32_bf16 v[60:63], v[204:207], a[196:199], v[60:63]
    v_mfma_f32_16x16x32_bf16 v[64:67], v[204:207], a[200:203], v[64:67]
    ds_read_b64_tr_b16 v[222:223], v11 offset:45568
    v_mfma_f32_16x16x32_bf16 v[68:71], v[204:207], a[204:207], v[68:71]
    s_waitcnt vmcnt(12) lgkmcnt(4)
    s_barrier
    v_mfma_f32_16x16x32_bf16 v[72:75], v[208:211], a[192:195], v[72:75]
    ds_read_b64_tr_b16 v[200:201], v9 offset:49152
    s_add_u32 m0, s35, 20480
    v_mfma_f32_16x16x32_bf16 v[76:79], v[208:211], a[196:199], v[76:79]
    buffer_load_dwordx4 v1, s[12:15], s66 offen lds
    v_mfma_f32_16x16x32_bf16 v[80:83], v[208:211], a[200:203], v[80:83]
    ds_read_b64_tr_b16 v[202:203], v9 offset:49664
    s_add_u32 m0, s35, 24576
    v_mfma_f32_16x16x32_bf16 v[84:87], v[208:211], a[204:207], v[84:87]
    buffer_load_dwordx4 v1, s[8:11], s67 offen lds
    v_mfma_f32_16x16x32_bf16 v[88:91], v[212:215], a[192:195], v[88:91]
    ds_read_b64_tr_b16 v[204:205], v11 offset:49152
    s_add_u32 m0, s35, 28672
    v_mfma_f32_16x16x32_bf16 v[92:95], v[212:215], a[196:199], v[92:95]
    buffer_load_dwordx4 v1, s[12:15], s67 offen lds
    v_mfma_f32_16x16x32_bf16 v[96:99], v[212:215], a[200:203], v[96:99]
    ds_read_b64_tr_b16 v[206:207], v11 offset:49664
    s_add_u32 m0, s35, 32768
    v_mfma_f32_16x16x32_bf16 v[100:103], v[212:215], a[204:207], v[100:103]
    buffer_load_dwordx4 v1, s[8:11], s68 offen lds
    s_waitcnt lgkmcnt(4)
    v_mfma_f32_16x16x32_bf16 v[40:43], v[216:219], a[208:211], v[40:43]
    ds_read_b64_tr_b16 v[208:209], v9 offset:53248
    s_add_u32 m0, s35, 36864
    v_mfma_f32_16x16x32_bf16 v[44:47], v[216:219], a[212:215], v[44:47]
    buffer_load_dwordx4 v1, s[12:15], s68 offen lds
    v_mfma_f32_16x16x32_bf16 v[48:51], v[216:219], a[216:219], v[48:51]
    ds_read_b64_tr_b16 v[210:211], v9 offset:53760
    s_add_u32 m0, s35, 40960
    v_mfma_f32_16x16x32_bf16 v[52:55], v[216:219], a[220:223], v[52:55]
    buffer_load_dwordx4 v1, s[8:11], s69 offen lds
    v_mfma_f32_16x16x32_bf16 v[56:59], v[220:223], a[208:211], v[56:59]
    ds_read_b64_tr_b16 v[212:213], v11 offset:53248
    v_mfma_f32_16x16x32_bf16 v[60:63], v[220:223], a[212:215], v[60:63]
    v_mfma_f32_16x16x32_bf16 v[64:67], v[220:223], a[216:219], v[64:67]
    ds_read_b64_tr_b16 v[214:215], v11 offset:53760
    v_mfma_f32_16x16x32_bf16 v[68:71], v[220:223], a[220:223], v[68:71]
    s_waitcnt lgkmcnt(4)
    v_mfma_f32_16x16x32_bf16 v[72:75], v[200:203], a[208:211], v[72:75]
    ds_read_b64_tr_b16 v[216:217], v9 offset:57344
    v_mfma_f32_16x16x32_bf16 v[76:79], v[200:203], a[212:215], v[76:79]
    v_mfma_f32_16x16x32_bf16 v[80:83], v[200:203], a[216:219], v[80:83]
    ds_read_b64_tr_b16 v[218:219], v9 offset:57856
    v_mfma_f32_16x16x32_bf16 v[84:87], v[200:203], a[220:223], v[84:87]
    v_mfma_f32_16x16x32_bf16 v[88:91], v[204:207], a[208:211], v[88:91]
    ds_read_b64_tr_b16 v[220:221], v11 offset:57344
    v_mfma_f32_16x16x32_bf16 v[92:95], v[204:207], a[212:215], v[92:95]
    v_mfma_f32_16x16x32_bf16 v[96:99], v[204:207], a[216:219], v[96:99]
    ds_read_b64_tr_b16 v[222:223], v11 offset:57856
    v_mfma_f32_16x16x32_bf16 v[100:103], v[204:207], a[220:223], v[100:103]
    s_waitcnt lgkmcnt(4)
    v_mfma_f32_16x16x32_bf16 v[40:43], v[208:211], a[224:227], v[40:43]
    ds_read_b64_tr_b16 v[200:201], v9 offset:61440
    v_mfma_f32_16x16x32_bf16 v[44:47], v[208:211], a[228:231], v[44:47]
    v_mfma_f32_16x16x32_bf16 v[48:51], v[208:211], a[232:235], v[48:51]
    ds_read_b64_tr_b16 v[202:203], v9 offset:61952
    v_mfma_f32_16x16x32_bf16 v[52:55], v[208:211], a[236:239], v[52:55]
    v_mfma_f32_16x16x32_bf16 v[56:59], v[212:215], a[224:227], v[56:59]
    ds_read_b64_tr_b16 v[204:205], v11 offset:61440
    v_mfma_f32_16x16x32_bf16 v[60:63], v[212:215], a[228:231], v[60:63]
    v_mfma_f32_16x16x32_bf16 v[64:67], v[212:215], a[232:235], v[64:67]
    ds_read_b64_tr_b16 v[206:207], v11 offset:61952
    v_mfma_f32_16x16x32_bf16 v[68:71], v[212:215], a[236:239], v[68:71]
    s_waitcnt lgkmcnt(4)
    v_mfma_f32_16x16x32_bf16 v[72:75], v[216:219], a[224:227], v[72:75]
    ds_read_b64_tr_b16 v[208:209], v10 offset:0
    v_mfma_f32_16x16x32_bf16 v[76:79], v[216:219], a[228:231], v[76:79]
    v_mfma_f32_16x16x32_bf16 v[80:83], v[216:219], a[232:235], v[80:83]
    ds_read_b64_tr_b16 v[210:211], v10 offset:512
    v_mfma_f32_16x16x32_bf16 v[84:87], v[216:219], a[236:239], v[84:87]
    v_mfma_f32_16x16x32_bf16 v[88:91], v[220:223], a[224:227], v[88:91]
    ds_read_b64_tr_b16 v[212:213], v12 offset:0
    v_mfma_f32_16x16x32_bf16 v[92:95], v[220:223], a[228:231], v[92:95]
    v_mfma_f32_16x16x32_bf16 v[96:99], v[220:223], a[232:235], v[96:99]
    ds_read_b64_tr_b16 v[214:215], v12 offset:512
    v_mfma_f32_16x16x32_bf16 v[100:103], v[220:223], a[236:239], v[100:103]
    s_waitcnt lgkmcnt(4)
    v_mfma_f32_16x16x32_bf16 v[40:43], v[200:203], a[240:243], v[40:43]
    ds_read_b64_tr_b16 v[216:217], v10 offset:4096
    v_mfma_f32_16x16x32_bf16 v[44:47], v[200:203], a[244:247], v[44:47]
    v_mfma_f32_16x16x32_bf16 v[48:51], v[200:203], a[248:251], v[48:51]
    ds_read_b64_tr_b16 v[218:219], v10 offset:4608
    v_mfma_f32_16x16x32_bf16 v[52:55], v[200:203], a[252:255], v[52:55]
    v_mfma_f32_16x16x32_bf16 v[56:59], v[204:207], a[240:243], v[56:59]
    ds_read_b64_tr_b16 v[220:221], v12 offset:4096
    v_mfma_f32_16x16x32_bf16 v[60:63], v[204:207], a[244:247], v[60:63]
    v_mfma_f32_16x16x32_bf16 v[64:67], v[204:207], a[248:251], v[64:67]
    ds_read_b64_tr_b16 v[222:223], v12 offset:4608
    v_mfma_f32_16x16x32_bf16 v[68:71], v[204:207], a[252:255], v[68:71]
    s_waitcnt vmcnt(9) lgkmcnt(4)
    s_barrier
    v_mfma_f32_16x16x32_bf16 v[72:75], v[208:211], a[240:243], v[72:75]
    ds_read_b64_tr_b16 v[200:201], v10 offset:8192
    s_add_u32 m0, s35, 45056
    v_mfma_f32_16x16x32_bf16 v[76:79], v[208:211], a[244:247], v[76:79]
    buffer_load_dwordx4 v1, s[12:15], s69 offen lds
    v_mfma_f32_16x16x32_bf16 v[80:83], v[208:211], a[248:251], v[80:83]
    ds_read_b64_tr_b16 v[202:203], v10 offset:8704
    s_add_u32 m0, s35, 49152
    v_mfma_f32_16x16x32_bf16 v[84:87], v[208:211], a[252:255], v[84:87]
    buffer_load_dwordx4 v1, s[8:11], s70 offen lds
    v_mfma_f32_16x16x32_bf16 v[88:91], v[212:215], a[240:243], v[88:91]
    ds_read_b64_tr_b16 v[204:205], v12 offset:8192
    s_add_u32 m0, s35, 53248
    v_mfma_f32_16x16x32_bf16 v[92:95], v[212:215], a[244:247], v[92:95]
    buffer_load_dwordx4 v1, s[12:15], s70 offen lds
    v_mfma_f32_16x16x32_bf16 v[96:99], v[212:215], a[248:251], v[96:99]
    ds_read_b64_tr_b16 v[206:207], v12 offset:8704
    s_add_u32 m0, s35, 57344
    v_mfma_f32_16x16x32_bf16 v[100:103], v[212:215], a[252:255], v[100:103]
    buffer_load_dwordx4 v1, s[8:11], s71 offen lds
    s_waitcnt lgkmcnt(4)
    v_mfma_f32_16x16x32_bf16 v[40:43], v[216:219], v[224:227], v[40:43]
    ds_read_b64_tr_b16 v[208:209], v10 offset:12288
    s_add_u32 m0, s35, 61440
    v_mfma_f32_16x16x32_bf16 v[44:47], v[216:219], v[228:231], v[44:47]
    buffer_load_dwordx4 v1, s[12:15], s71 offen lds
    v_mfma_f32_16x16x32_bf16 v[48:51], v[216:219], v[232:235], v[48:51]
    ds_read_b64_tr_b16 v[210:211], v10 offset:12800
    s_add_u32 m0, s35, 65536
    v_mfma_f32_16x16x32_bf16 v[52:55], v[216:219], v[236:239], v[52:55]
    buffer_load_dwordx4 v1, s[8:11], s72 offen lds
    v_mfma_f32_16x16x32_bf16 v[56:59], v[220:223], v[224:227], v[56:59]
    ds_read_b64_tr_b16 v[212:213], v12 offset:12288
    v_mfma_f32_16x16x32_bf16 v[60:63], v[220:223], v[228:231], v[60:63]
    v_mfma_f32_16x16x32_bf16 v[64:67], v[220:223], v[232:235], v[64:67]
    ds_read_b64_tr_b16 v[214:215], v12 offset:12800
    v_mfma_f32_16x16x32_bf16 v[68:71], v[220:223], v[236:239], v[68:71]
    s_waitcnt lgkmcnt(4)
    v_mfma_f32_16x16x32_bf16 v[72:75], v[200:203], v[224:227], v[72:75]
    ds_read_b64_tr_b16 v[216:217], v10 offset:16384
    v_mfma_f32_16x16x32_bf16 v[76:79], v[200:203], v[228:231], v[76:79]
    v_mfma_f32_16x16x32_bf16 v[80:83], v[200:203], v[232:235], v[80:83]
    ds_read_b64_tr_b16 v[218:219], v10 offset:16896
    v_mfma_f32_16x16x32_bf16 v[84:87], v[200:203], v[236:239], v[84:87]
    v_mfma_f32_16x16x32_bf16 v[88:91], v[204:207], v[224:227], v[88:91]
    ds_read_b64_tr_b16 v[220:221], v12 offset:16384
    v_mfma_f32_16x16x32_bf16 v[92:95], v[204:207], v[228:231], v[92:95]
    v_mfma_f32_16x16x32_bf16 v[96:99], v[204:207], v[232:235], v[96:99]
    ds_read_b64_tr_b16 v[222:223], v12 offset:16896
    v_mfma_f32_16x16x32_bf16 v[100:103], v[204:207], v[236:239], v[100:103]
    s_waitcnt lgkmcnt(4)
    v_mfma_f32_16x16x32_bf16 v[40:43], v[208:211], v[240:243], v[40:43]
    ds_read_b64_tr_b16 v[200:201], v9 offset:0
    v_mfma_f32_16x16x32_bf16 v[44:47], v[208:211], v[244:247], v[44:47]
    v_mfma_f32_16x16x32_bf16 v[48:51], v[208:211], v[248:251], v[48:51]
    ds_read_b64_tr_b16 v[202:203], v9 offset:512
    v_mfma_f32_16x16x32_bf16 v[52:55], v[208:211], v[252:255], v[52:55]
    v_mfma_f32_16x16x32_bf16 v[56:59], v[212:215], v[240:243], v[56:59]
    ds_read_b64_tr_b16 v[204:205], v11 offset:0
    v_mfma_f32_16x16x32_bf16 v[60:63], v[212:215], v[244:247], v[60:63]
    v_mfma_f32_16x16x32_bf16 v[64:67], v[212:215], v[248:251], v[64:67]
    ds_read_b64_tr_b16 v[206:207], v11 offset:512
    v_mfma_f32_16x16x32_bf16 v[68:71], v[212:215], v[252:255], v[68:71]
    s_waitcnt lgkmcnt(4)
    v_mfma_f32_16x16x32_bf16 v[72:75], v[216:219], v[240:243], v[72:75]
    ds_read_b64_tr_b16 v[208:209], v9 offset:4096
    v_mfma_f32_16x16x32_bf16 v[76:79], v[216:219], v[244:247], v[76:79]
    v_mfma_f32_16x16x32_bf16 v[80:83], v[216:219], v[248:251], v[80:83]
    ds_read_b64_tr_b16 v[210:211], v9 offset:4608
    v_mfma_f32_16x16x32_bf16 v[84:87], v[216:219], v[252:255], v[84:87]
    v_mfma_f32_16x16x32_bf16 v[88:91], v[220:223], v[240:243], v[88:91]
    ds_read_b64_tr_b16 v[212:213], v11 offset:4096
    v_mfma_f32_16x16x32_bf16 v[92:95], v[220:223], v[244:247], v[92:95]
    v_mfma_f32_16x16x32_bf16 v[96:99], v[220:223], v[248:251], v[96:99]
    ds_read_b64_tr_b16 v[214:215], v11 offset:4608
    v_mfma_f32_16x16x32_bf16 v[100:103], v[220:223], v[252:255], v[100:103]
    s_waitcnt lgkmcnt(4)
    v_mfma_f32_16x16x32_bf16 v[104:107], v[200:203], a[0:3], 0
    ds_read_b64_tr_b16 v[216:217], v9 offset:8192
    v_mfma_f32_16x16x32_bf16 v[108:111], v[200:203], a[4:7], 0
    v_mfma_f32_16x16x32_bf16 v[112:115], v[200:203], a[8:11], 0
    ds_read_b64_tr_b16 v[218:219], v9 offset:8704
    v_mfma_f32_16x16x32_bf16 v[116:119], v[200:203], a[12:15], 0
    v_mfma_f32_16x16x32_bf16 v[120:123], v[204:207], a[0:3], 0
    ds_read_b64_tr_b16 v[220:221], v11 offset:8192
    v_mfma_f32_16x16x32_bf16 v[124:127], v[204:207], a[4:7], 0
    v_mfma_f32_16x16x32_bf16 v[128:131], v[204:207], a[8:11], 0
    ds_read_b64_tr_b16 v[222:223], v11 offset:8704
    v_mfma_f32_16x16x32_bf16 v[132:135], v[204:207], a[12:15], 0
    s_waitcnt vmcnt(8) lgkmcnt(4)
    s_barrier
    v_mfma_f32_16x16x32_bf16 v[136:139], v[208:211], a[0:3], 0
    ds_read_b64_tr_b16 v[200:201], v9 offset:12288
    s_add_u32 m0, s35, 69632
    v_mfma_f32_16x16x32_bf16 v[140:143], v[208:211], a[4:7], 0
    buffer_load_dwordx4 v1, s[12:15], s72 offen lds
    v_mul_f32 v40, v40, v72
    v_mfma_f32_16x16x32_bf16 v[144:147], v[208:211], a[8:11], 0
    ds_read_b64_tr_b16 v[202:203], v9 offset:12800
    s_add_u32 m0, s35, 73728
    v_mfma_f32_16x16x32_bf16 v[148:151], v[208:211], a[12:15], 0
    buffer_load_dwordx4 v1, s[8:11], s73 offen lds
    v_mul_f32 v41, v41, v73
    v_mfma_f32_16x16x32_bf16 v[152:155], v[212:215], a[0:3], 0
    ds_read_b64_tr_b16 v[204:205], v11 offset:12288
    s_add_u32 m0, s35, 77824
    v_mfma_f32_16x16x32_bf16 v[156:159], v[212:215], a[4:7], 0
    buffer_load_dwordx4 v1, s[12:15], s73 offen lds
    v_mul_f32 v42, v42, v74
    v_mfma_f32_16x16x32_bf16 v[160:163], v[212:215], a[8:11], 0
    ds_read_b64_tr_b16 v[206:207], v11 offset:12800
    s_add_u32 m0, s35, 81920
    v_mfma_f32_16x16x32_bf16 v[164:167], v[212:215], a[12:15], 0
    buffer_load_dwordx4 v1, s[8:11], s74 offen lds
    s_waitcnt lgkmcnt(4)
    v_mfma_f32_16x16x32_bf16 v[104:107], v[216:219], a[16:19], v[104:107]
    ds_read_b64_tr_b16 v[208:209], v9 offset:16384
    s_add_u32 m0, s35, 0
    v_mfma_f32_16x16x32_bf16 v[108:111], v[216:219], a[20:23], v[108:111]
    buffer_load_dwordx4 v1, s[12:15], s74 offen lds
    v_mul_f32 v43, v43, v75
    v_mfma_f32_16x16x32_bf16 v[112:115], v[216:219], a[24:27], v[112:115]
    ds_read_b64_tr_b16 v[210:211], v9 offset:16896
    s_add_u32 m0, s35, 4096
    v_mfma_f32_16x16x32_bf16 v[116:119], v[216:219], a[28:31], v[116:119]
    buffer_load_dwordx4 v1, s[8:11], s75 offen lds
    v_mul_f32 v56, v56, v88
    v_mfma_f32_16x16x32_bf16 v[120:123], v[220:223], a[16:19], v[120:123]
    ds_read_b64_tr_b16 v[212:213], v11 offset:16384
    v_mul_f32 v57, v57, v89
    v_mfma_f32_16x16x32_bf16 v[124:127], v[220:223], a[20:23], v[124:127]
    v_mul_f32 v58, v58, v90
    v_mul_f32 v59, v59, v91
    v_mfma_f32_16x16x32_bf16 v[128:131], v[220:223], a[24:27], v[128:131]
    ds_read_b64_tr_b16 v[214:215], v11 offset:16896
    v_cvt_pk_bf16_f32 v72, v40, v41
    v_mfma_f32_16x16x32_bf16 v[132:135], v[220:223], a[28:31], v[132:135]
    v_cvt_pk_bf16_f32 v73, v42, v43
    s_waitcnt lgkmcnt(4)
    v_mfma_f32_16x16x32_bf16 v[136:139], v[200:203], a[16:19], v[136:139]
    ds_read_b64_tr_b16 v[216:217], v9 offset:20480
    v_cvt_pk_bf16_f32 v74, v56, v57
    v_mfma_f32_16x16x32_bf16 v[140:143], v[200:203], a[20:23], v[140:143]
    v_cvt_pk_bf16_f32 v75, v58, v59
    ds_write_b128 v13, v[72:75] offset:32768
    v_mfma_f32_16x16x32_bf16 v[144:147], v[200:203], a[24:27], v[144:147]
    ds_read_b64_tr_b16 v[218:219], v9 offset:20992
    s_mov_b32 s91, 32768
    v_mfma_f32_16x16x32_bf16 v[148:151], v[200:203], a[28:31], v[148:151]
    buffer_store_dwordx4 v[72:75], v13, s[96:99], s91 offen offset:0 sc1
    v_mul_f32 v44, v44, v76
    v_mfma_f32_16x16x32_bf16 v[152:155], v[204:207], a[16:19], v[152:155]
    ds_read_b64_tr_b16 v[220:221], v11 offset:20480
    v_mul_f32 v45, v45, v77
    v_mfma_f32_16x16x32_bf16 v[156:159], v[204:207], a[20:23], v[156:159]
    v_mul_f32 v46, v46, v78
    v_mul_f32 v47, v47, v79
    v_mfma_f32_16x16x32_bf16 v[160:163], v[204:207], a[24:27], v[160:163]
    ds_read_b64_tr_b16 v[222:223], v11 offset:20992
    v_mul_f32 v60, v60, v92
    v_mfma_f32_16x16x32_bf16 v[164:167], v[204:207], a[28:31], v[164:167]
    v_mul_f32 v61, v61, v93
    s_waitcnt lgkmcnt(5)
    v_mfma_f32_16x16x32_bf16 v[104:107], v[208:211], a[32:35], v[104:107]
    ds_read_b64_tr_b16 v[200:201], v9 offset:24576
    v_mul_f32 v62, v62, v94
    v_mfma_f32_16x16x32_bf16 v[108:111], v[208:211], a[36:39], v[108:111]
    ds_read_b128 a[16:19], v14 offset:8192
    v_mul_f32 v63, v63, v95
    v_mfma_f32_16x16x32_bf16 v[112:115], v[208:211], a[40:43], v[112:115]
    ds_read_b64_tr_b16 v[202:203], v9 offset:25088
    v_cvt_pk_bf16_f32 v76, v44, v45
    v_mfma_f32_16x16x32_bf16 v[116:119], v[208:211], a[44:47], v[116:119]
    ds_read_b128 a[20:23], v14 offset:9216
    v_cvt_pk_bf16_f32 v77, v46, v47
    v_mfma_f32_16x16x32_bf16 v[120:123], v[212:215], a[32:35], v[120:123]
    ds_read_b64_tr_b16 v[204:205], v11 offset:24576
    v_cvt_pk_bf16_f32 v78, v60, v61
    v_mfma_f32_16x16x32_bf16 v[124:127], v[212:215], a[36:39], v[124:127]
    ds_read_b128 a[24:27], v14 offset:10240
    v_cvt_pk_bf16_f32 v79, v62, v63
    v_mfma_f32_16x16x32_bf16 v[128:131], v[212:215], a[40:43], v[128:131]
    ds_read_b64_tr_b16 v[206:207], v11 offset:25088
    v_mfma_f32_16x16x32_bf16 v[132:135], v[212:215], a[44:47], v[132:135]
    ds_read_b128 a[28:31], v14 offset:11264
    s_waitcnt lgkmcnt(8)
    v_mfma_f32_16x16x32_bf16 v[136:139], v[216:219], a[32:35], v[136:139]
    ds_read_b64_tr_b16 v[208:209], v9 offset:28672
    v_mfma_f32_16x16x32_bf16 v[140:143], v[216:219], a[36:39], v[140:143]
    ds_write_b128 v13, v[76:79] offset:33792
    buffer_store_dwordx4 v[76:79], v13, s[96:99], s91 offen offset:1024 sc1
    v_mfma_f32_16x16x32_bf16 v[144:147], v[216:219], a[40:43], v[144:147]
    ds_read_b64_tr_b16 v[210:211], v9 offset:29184
    v_mul_f32 v48, v48, v80
    v_mfma_f32_16x16x32_bf16 v[148:151], v[216:219], a[44:47], v[148:151]
    v_mul_f32 v49, v49, v81
    v_mul_f32 v50, v50, v82
    v_mfma_f32_16x16x32_bf16 v[152:155], v[220:223], a[32:35], v[152:155]
    ds_read_b64_tr_b16 v[212:213], v11 offset:28672
    v_mul_f32 v51, v51, v83
    v_mfma_f32_16x16x32_bf16 v[156:159], v[220:223], a[36:39], v[156:159]
    v_mul_f32 v64, v64, v96
    v_mul_f32 v65, v65, v97
    v_mfma_f32_16x16x32_bf16 v[160:163], v[220:223], a[40:43], v[160:163]
    ds_read_b64_tr_b16 v[214:215], v11 offset:29184
    v_mul_f32 v66, v66, v98
    v_mfma_f32_16x16x32_bf16 v[164:167], v[220:223], a[44:47], v[164:167]
    v_mul_f32 v67, v67, v99
    s_waitcnt lgkmcnt(6)
    v_mfma_f32_16x16x32_bf16 v[104:107], v[200:203], a[48:51], v[104:107]
    ds_read_b64_tr_b16 v[216:217], v9 offset:32768
    buffer_load_dwordx2 v[38:39], off, s[20:23], s57 offset:16 sc1
    v_mfma_f32_16x16x32_bf16 v[108:111], v[200:203], a[52:55], v[108:111]
    ds_read_b128 a[32:35], v14 offset:16384
    v_cvt_pk_bf16_f32 v80, v48, v49
    v_mfma_f32_16x16x32_bf16 v[112:115], v[200:203], a[56:59], v[112:115]
    ds_read_b64_tr_b16 v[218:219], v9 offset:33280
    v_cvt_pk_bf16_f32 v81, v50, v51
    v_mfma_f32_16x16x32_bf16 v[116:119], v[200:203], a[60:63], v[116:119]
    ds_read_b128 a[36:39], v14 offset:17408
    v_cvt_pk_bf16_f32 v82, v64, v65
    v_mfma_f32_16x16x32_bf16 v[120:123], v[204:207], a[48:51], v[120:123]
    ds_read_b64_tr_b16 v[220:221], v11 offset:32768
    v_cvt_pk_bf16_f32 v83, v66, v67
    v_mfma_f32_16x16x32_bf16 v[124:127], v[204:207], a[52:55], v[124:127]
    ds_read_b128 a[40:43], v14 offset:18432
    v_mfma_f32_16x16x32_bf16 v[128:131], v[204:207], a[56:59], v[128:131]
    ds_read_b64_tr_b16 v[222:223], v11 offset:33280
    v_mfma_f32_16x16x32_bf16 v[132:135], v[204:207], a[60:63], v[132:135]
    s_waitcnt vmcnt(11) lgkmcnt(7)
    s_barrier
    v_mfma_f32_16x16x32_bf16 v[136:139], v[208:211], a[48:51], v[136:139]
    ds_read_b64_tr_b16 v[200:201], v9 offset:36864
    s_add_u32 m0, s35, 8192
    v_mfma_f32_16x16x32_bf16 v[140:143], v[208:211], a[52:55], v[140:143]
    ds_read_b128 a[44:47], v14 offset:19456
    buffer_load_dwordx4 v1, s[12:15], s75 offen lds
    v_mfma_f32_16x16x32_bf16 v[144:147], v[208:211], a[56:59], v[144:147]
    ds_read_b64_tr_b16 v[202:203], v9 offset:37376
    s_add_u32 m0, s35, 12288
    v_mfma_f32_16x16x32_bf16 v[148:151], v[208:211], a[60:63], v[148:151]
    buffer_load_dwordx4 v1, s[8:11], s76 offen lds
    ds_write_b128 v13, v[80:83] offset:34816
    v_mfma_f32_16x16x32_bf16 v[152:155], v[212:215], a[48:51], v[152:155]
    ds_read_b64_tr_b16 v[204:205], v11 offset:36864
    s_add_u32 m0, s35, 16384
    v_mfma_f32_16x16x32_bf16 v[156:159], v[212:215], a[52:55], v[156:159]
    buffer_load_dwordx4 v1, s[12:15], s76 offen lds
    v_mfma_f32_16x16x32_bf16 v[160:163], v[212:215], a[56:59], v[160:163]
    ds_read_b64_tr_b16 v[206:207], v11 offset:37376
    s_add_u32 m0, s35, 20480
    v_mfma_f32_16x16x32_bf16 v[164:167], v[212:215], a[60:63], v[164:167]
    buffer_load_dwordx4 v1, s[8:11], s77 offen lds
    s_waitcnt lgkmcnt(6)
    v_mfma_f32_16x16x32_bf16 v[104:107], v[216:219], a[64:67], v[104:107]
    ds_read_b64_tr_b16 v[208:209], v9 offset:40960
    s_add_u32 m0, s35, 24576
    v_mfma_f32_16x16x32_bf16 v[108:111], v[216:219], a[68:71], v[108:111]
    ds_read_b128 a[48:51], v14 offset:24576
    buffer_load_dwordx4 v1, s[12:15], s77 offen lds
    v_mfma_f32_16x16x32_bf16 v[112:115], v[216:219], a[72:75], v[112:115]
    ds_read_b64_tr_b16 v[210:211], v9 offset:41472
    s_add_u32 m0, s35, 28672
    v_mfma_f32_16x16x32_bf16 v[116:119], v[216:219], a[76:79], v[116:119]
    ds_read_b128 a[52:55], v14 offset:25600
    buffer_load_dwordx4 v1, s[8:11], s78 offen lds
    v_mfma_f32_16x16x32_bf16 v[120:123], v[220:223], a[64:67], v[120:123]
    ds_read_b64_tr_b16 v[212:213], v11 offset:40960
    buffer_store_dwordx4 v[80:83], v13, s[96:99], s91 offen offset:2048 sc1
    v_mfma_f32_16x16x32_bf16 v[124:127], v[220:223], a[68:71], v[124:127]
    ds_read_b128 a[56:59], v14 offset:26624
    v_mul_f32 v52, v52, v84
    v_mfma_f32_16x16x32_bf16 v[128:131], v[220:223], a[72:75], v[128:131]
    ds_read_b64_tr_b16 v[214:215], v11 offset:41472
    v_mul_f32 v53, v53, v85
    v_mfma_f32_16x16x32_bf16 v[132:135], v[220:223], a[76:79], v[132:135]
    ds_read_b128 a[60:63], v14 offset:27648
    s_waitcnt lgkmcnt(8)
    v_mfma_f32_16x16x32_bf16 v[136:139], v[200:203], a[64:67], v[136:139]
    ds_read_b64_tr_b16 v[216:217], v9 offset:45056
    v_mul_f32 v54, v54, v86
    v_mfma_f32_16x16x32_bf16 v[140:143], v[200:203], a[68:71], v[140:143]
    v_mul_f32 v55, v55, v87
    v_mul_f32 v68, v68, v100
    v_mfma_f32_16x16x32_bf16 v[144:147], v[200:203], a[72:75], v[144:147]
    ds_read_b64_tr_b16 v[218:219], v9 offset:45568
    v_mul_f32 v69, v69, v101
    v_mfma_f32_16x16x32_bf16 v[148:151], v[200:203], a[76:79], v[148:151]
    v_mul_f32 v70, v70, v102
    v_mul_f32 v71, v71, v103
    v_mfma_f32_16x16x32_bf16 v[152:155], v[204:207], a[64:67], v[152:155]
    ds_read_b64_tr_b16 v[220:221], v11 offset:45056
    v_cvt_pk_bf16_f32 v84, v52, v53
    v_mfma_f32_16x16x32_bf16 v[156:159], v[204:207], a[68:71], v[156:159]
    v_cvt_pk_bf16_f32 v85, v54, v55
    v_cvt_pk_bf16_f32 v86, v68, v69
    v_mfma_f32_16x16x32_bf16 v[160:163], v[204:207], a[72:75], v[160:163]
    ds_read_b64_tr_b16 v[222:223], v11 offset:45568
    v_cvt_pk_bf16_f32 v87, v70, v71
    v_mfma_f32_16x16x32_bf16 v[164:167], v[204:207], a[76:79], v[164:167]
    ds_write_b128 v13, v[84:87] offset:35840
    s_waitcnt lgkmcnt(6)
    v_mfma_f32_16x16x32_bf16 v[104:107], v[208:211], a[80:83], v[104:107]
    ds_read_b64_tr_b16 v[200:201], v9 offset:49152
    buffer_store_dwordx4 v[84:87], v13, s[96:99], s91 offen offset:3072 sc1
    v_mfma_f32_16x16x32_bf16 v[108:111], v[208:211], a[84:87], v[108:111]
    ds_read_b128 a[64:67], v14 offset:32768
    v_mfma_f32_16x16x32_bf16 v[112:115], v[208:211], a[88:91], v[112:115]
    ds_read_b64_tr_b16 v[202:203], v9 offset:49664
    v_mfma_f32_16x16x32_bf16 v[116:119], v[208:211], a[92:95], v[116:119]
    ds_read_b128 a[68:71], v14 offset:33792
    v_mfma_f32_16x16x32_bf16 v[120:123], v[212:215], a[80:83], v[120:123]
    ds_read_b64_tr_b16 v[204:205], v11 offset:49152
    v_mfma_f32_16x16x32_bf16 v[124:127], v[212:215], a[84:87], v[124:127]
    ds_read_b128 a[72:75], v14 offset:34816
    v_mfma_f32_16x16x32_bf16 v[128:131], v[212:215], a[88:91], v[128:131]
    ds_read_b64_tr_b16 v[206:207], v11 offset:49664
    v_mfma_f32_16x16x32_bf16 v[132:135], v[212:215], a[92:95], v[132:135]
    ds_read_b128 a[76:79], v14 offset:35840
    s_waitcnt lgkmcnt(9)
    v_mfma_f32_16x16x32_bf16 v[136:139], v[216:219], a[80:83], v[136:139]
    ds_read_b64_tr_b16 v[208:209], v9 offset:53248
    v_mfma_f32_16x16x32_bf16 v[140:143], v[216:219], a[84:87], v[140:143]
    ds_read_b128 a[0:3], v14 offset:0
    v_mfma_f32_16x16x32_bf16 v[144:147], v[216:219], a[88:91], v[144:147]
    ds_read_b64_tr_b16 v[210:211], v9 offset:53760
    v_mfma_f32_16x16x32_bf16 v[148:151], v[216:219], a[92:95], v[148:151]
    ds_read_b128 a[4:7], v14 offset:1024
    v_mfma_f32_16x16x32_bf16 v[152:155], v[220:223], a[80:83], v[152:155]
    ds_read_b64_tr_b16 v[212:213], v11 offset:53248
    v_mfma_f32_16x16x32_bf16 v[156:159], v[220:223], a[84:87], v[156:159]
    ds_read_b128 a[8:11], v14 offset:2048
    v_mfma_f32_16x16x32_bf16 v[160:163], v[220:223], a[88:91], v[160:163]
    ds_read_b64_tr_b16 v[214:215], v11 offset:53760
    v_mfma_f32_16x16x32_bf16 v[164:167], v[220:223], a[92:95], v[164:167]
    ds_read_b128 a[12:15], v14 offset:3072
    s_waitcnt lgkmcnt(9)
    v_mfma_f32_16x16x32_bf16 v[104:107], v[200:203], a[96:99], v[104:107]
    ds_read_b64_tr_b16 v[216:217], v9 offset:57344
    v_mfma_f32_16x16x32_bf16 v[108:111], v[200:203], a[100:103], v[108:111]
    v_mfma_f32_16x16x32_bf16 v[112:115], v[200:203], a[104:107], v[112:115]
    ds_read_b64_tr_b16 v[218:219], v9 offset:57856
    v_mfma_f32_16x16x32_bf16 v[116:119], v[200:203], a[108:111], v[116:119]
    v_mfma_f32_16x16x32_bf16 v[120:123], v[204:207], a[96:99], v[120:123]
    ds_read_b64_tr_b16 v[220:221], v11 offset:57344
    v_mfma_f32_16x16x32_bf16 v[124:127], v[204:207], a[100:103], v[124:127]
    v_mfma_f32_16x16x32_bf16 v[128:131], v[204:207], a[104:107], v[128:131]
    ds_read_b64_tr_b16 v[222:223], v11 offset:57856
    v_mfma_f32_16x16x32_bf16 v[132:135], v[204:207], a[108:111], v[132:135]
    s_waitcnt vmcnt(13) lgkmcnt(5)
    s_barrier
    v_mfma_f32_16x16x32_bf16 v[136:139], v[208:211], a[96:99], v[136:139]
    ds_read_b64_tr_b16 v[200:201], v9 offset:61440
    s_add_u32 m0, s35, 32768
    v_mfma_f32_16x16x32_bf16 v[140:143], v[208:211], a[100:103], v[140:143]
    ds_read_b128 a[80:83], v14 offset:40960
    buffer_load_dwordx4 v1, s[12:15], s78 offen lds
    v_mfma_f32_16x16x32_bf16 v[144:147], v[208:211], a[104:107], v[144:147]
    ds_read_b64_tr_b16 v[202:203], v9 offset:61952
    s_add_u32 m0, s35, 36864
    v_mfma_f32_16x16x32_bf16 v[148:151], v[208:211], a[108:111], v[148:151]
    ds_read_b128 a[84:87], v14 offset:41984
    buffer_load_dwordx4 v1, s[8:11], s79 offen lds
    v_mfma_f32_16x16x32_bf16 v[152:155], v[212:215], a[96:99], v[152:155]
    ds_read_b64_tr_b16 v[204:205], v11 offset:61440
    s_add_u32 m0, s35, 40960
    v_mfma_f32_16x16x32_bf16 v[156:159], v[212:215], a[100:103], v[156:159]
    ds_read_b128 a[88:91], v14 offset:43008
    buffer_load_dwordx4 v1, s[12:15], s79 offen lds
    v_mfma_f32_16x16x32_bf16 v[160:163], v[212:215], a[104:107], v[160:163]
    ds_read_b64_tr_b16 v[206:207], v11 offset:61952
    s_add_u32 m0, s35, 45056
    v_mfma_f32_16x16x32_bf16 v[164:167], v[212:215], a[108:111], v[164:167]
    ds_read_b128 a[92:95], v14 offset:44032
    s_waitcnt lgkmcnt(8)
    v_mfma_f32_16x16x32_bf16 v[104:107], v[216:219], a[112:115], v[104:107]
    ds_read_b64_tr_b16 v[208:209], v10 offset:0
    buffer_load_dwordx4 v1, s[8:11], s80 offen lds
    v_mfma_f32_16x16x32_bf16 v[108:111], v[216:219], a[116:119], v[108:111]
    ds_read_b128 a[96:99], v14 offset:49152
    s_add_u32 m0, s35, 49152
    v_mfma_f32_16x16x32_bf16 v[112:115], v[216:219], a[120:123], v[112:115]
    ds_read_b64_tr_b16 v[210:211], v10 offset:512
    buffer_load_dwordx4 v1, s[12:15], s80 offen lds
    v_mfma_f32_16x16x32_bf16 v[116:119], v[216:219], a[124:127], v[116:119]
    ds_read_b128 a[100:103], v14 offset:50176
    s_add_u32 m0, s35, 53248
    v_mfma_f32_16x16x32_bf16 v[120:123], v[220:223], a[112:115], v[120:123]
    ds_read_b64_tr_b16 v[212:213], v12 offset:0
    buffer_load_dwordx4 v1, s[8:11], s81 offen lds
    v_mfma_f32_16x16x32_bf16 v[124:127], v[220:223], a[116:119], v[124:127]
    ds_read_b128 a[104:107], v14 offset:51200
    v_mfma_f32_16x16x32_bf16 v[128:131], v[220:223], a[120:123], v[128:131]
    ds_read_b64_tr_b16 v[214:215], v12 offset:512
    v_mfma_f32_16x16x32_bf16 v[132:135], v[220:223], a[124:127], v[132:135]
    ds_read_b128 a[108:111], v14 offset:52224
    s_waitcnt lgkmcnt(9)
    v_mfma_f32_16x16x32_bf16 v[136:139], v[200:203], a[112:115], v[136:139]
    ds_read_b64_tr_b16 v[216:217], v10 offset:4096
    v_mfma_f32_16x16x32_bf16 v[140:143], v[200:203], a[116:119], v[140:143]
    v_mfma_f32_16x16x32_bf16 v[144:147], v[200:203], a[120:123], v[144:147]
    ds_read_b64_tr_b16 v[218:219], v10 offset:4608
    v_mfma_f32_16x16x32_bf16 v[148:151], v[200:203], a[124:127], v[148:151]
    v_mfma_f32_16x16x32_bf16 v[152:155], v[204:207], a[112:115], v[152:155]
    ds_read_b64_tr_b16 v[220:221], v12 offset:4096
    v_mfma_f32_16x16x32_bf16 v[156:159], v[204:207], a[116:119], v[156:159]
    v_mfma_f32_16x16x32_bf16 v[160:163], v[204:207], a[120:123], v[160:163]
    ds_read_b64_tr_b16 v[222:223], v12 offset:4608
    v_mfma_f32_16x16x32_bf16 v[164:167], v[204:207], a[124:127], v[164:167]
    s_waitcnt lgkmcnt(5)
    v_mfma_f32_16x16x32_bf16 v[104:107], v[208:211], a[128:131], v[104:107]
    ds_read_b64_tr_b16 v[200:201], v10 offset:8192
    s_waitcnt vmcnt(14)
    s_mov_b32 s60, 0
ffn_kernel_sp_75:
    v_min_u32 v38, v38, v39
    s_add_u32 s60, s60, 1
    v_readfirstlane_b32 s58, v38
    s_cmp_lg_u32 s58, 0
    s_cbranch_scc1 ffn_kernel_sp_75d
    s_cmp_ge_u32 s60, 0x8000
    s_cbranch_scc1 ffn_kernel_sp_75d
    buffer_load_dwordx2 v[38:39], off, s[20:23], s57 offset:16 sc1
    s_waitcnt vmcnt(0)
    s_branch ffn_kernel_sp_75
ffn_kernel_sp_75d:
    v_mfma_f32_16x16x32_bf16 v[108:111], v[208:211], a[132:135], v[108:111]
    v_mfma_f32_16x16x32_bf16 v[112:115], v[208:211], a[136:139], v[112:115]
    ds_read_b64_tr_b16 v[202:203], v10 offset:8704
    v_mfma_f32_16x16x32_bf16 v[116:119], v[208:211], a[140:143], v[116:119]
    v_mfma_f32_16x16x32_bf16 v[120:123], v[212:215], a[128:131], v[120:123]
    ds_read_b64_tr_b16 v[204:205], v12 offset:8192
    v_mfma_f32_16x16x32_bf16 v[124:127], v[212:215], a[132:135], v[124:127]
    v_mfma_f32_16x16x32_bf16 v[128:131], v[212:215], a[136:139], v[128:131]
    ds_read_b64_tr_b16 v[206:207], v12 offset:8704
    v_mfma_f32_16x16x32_bf16 v[132:135], v[212:215], a[140:143], v[132:135]
    s_waitcnt lgkmcnt(4)
    v_mfma_f32_16x16x32_bf16 v[136:139], v[216:219], a[128:131], v[136:139]
    ds_read_b64_tr_b16 v[208:209], v10 offset:12288
    v_mfma_f32_16x16x32_bf16 v[140:143], v[216:219], a[132:135], v[140:143]
    v_mfma_f32_16x16x32_bf16 v[144:147], v[216:219], a[136:139], v[144:147]
    ds_read_b64_tr_b16 v[210:211], v10 offset:12800
    v_mfma_f32_16x16x32_bf16 v[148:151], v[216:219], a[140:143], v[148:151]
    v_mfma_f32_16x16x32_bf16 v[152:155], v[220:223], a[128:131], v[152:155]
    ds_read_b64_tr_b16 v[212:213], v12 offset:12288
    v_mfma_f32_16x16x32_bf16 v[156:159], v[220:223], a[132:135], v[156:159]
    v_mfma_f32_16x16x32_bf16 v[160:163], v[220:223], a[136:139], v[160:163]
    ds_read_b64_tr_b16 v[214:215], v12 offset:12800
    v_mfma_f32_16x16x32_bf16 v[164:167], v[220:223], a[140:143], v[164:167]
    s_waitcnt lgkmcnt(4)
    v_mfma_f32_16x16x32_bf16 v[104:107], v[200:203], a[144:147], v[104:107]
    ds_read_b64_tr_b16 v[216:217], v10 offset:16384
    v_mfma_f32_16x16x32_bf16 v[108:111], v[200:203], a[148:151], v[108:111]
    v_mfma_f32_16x16x32_bf16 v[112:115], v[200:203], a[152:155], v[112:115]
    ds_read_b64_tr_b16 v[218:219], v10 offset:16896
    v_mfma_f32_16x16x32_bf16 v[116:119], v[200:203], a[156:159], v[116:119]
    v_mfma_f32_16x16x32_bf16 v[120:123], v[204:207], a[144:147], v[120:123]
    ds_read_b64_tr_b16 v[220:221], v12 offset:16384
    v_mfma_f32_16x16x32_bf16 v[124:127], v[204:207], a[148:151], v[124:127]
    v_mfma_f32_16x16x32_bf16 v[128:131], v[204:207], a[152:155], v[128:131]
    ds_read_b64_tr_b16 v[222:223], v12 offset:16896
    v_mfma_f32_16x16x32_bf16 v[132:135], v[204:207], a[156:159], v[132:135]
    s_waitcnt vmcnt(10) lgkmcnt(4)
    s_barrier
    v_mfma_f32_16x16x32_bf16 v[136:139], v[208:211], a[144:147], v[136:139]
    ds_read_b64_tr_b16 v[200:201], v9 offset:0
    s_add_u32 m0, s35, 57344
    v_mfma_f32_16x16x32_bf16 v[140:143], v[208:211], a[148:151], v[140:143]
    buffer_load_dwordx4 v1, s[12:15], s81 offen lds
    v_mfma_f32_16x16x32_bf16 v[144:147], v[208:211], a[152:155], v[144:147]
    ds_read_b64_tr_b16 v[202:203], v9 offset:512
    v_mfma_f32_16x16x32_bf16 v[148:151], v[208:211], a[156:159], v[148:151]
    s_xor_b32 s63, s3, 1
    s_mul_i32 s64, s63, 36864
    v_mfma_f32_16x16x32_bf16 v[152:155], v[212:215], a[144:147], v[152:155]
    ds_read_b64_tr_b16 v[204:205], v11 offset:0
    v_mfma_f32_16x16x32_bf16 v[156:159], v[212:215], a[148:151], v[156:159]
    s_add_u32 s64, s64, 294912
    s_mul_i32 s63, s63, 368640
    v_mfma_f32_16x16x32_bf16 v[160:163], v[212:215], a[152:155], v[160:163]
    ds_read_b64_tr_b16 v[206:207], v11 offset:512
    v_mfma_f32_16x16x32_bf16 v[164:167], v[212:215], a[156:159], v[164:167]
    s_mul_i32 s100, s3, 368640
    s_sub_u32 s63, s63, s100
    s_waitcnt lgkmcnt(4)
    v_mfma_f32_16x16x32_bf16 v[104:107], v[216:219], a[160:163], v[104:107]
    ds_read_b64_tr_b16 v[208:209], v9 offset:4096
    v_mfma_f32_16x16x32_bf16 v[108:111], v[216:219], a[164:167], v[108:111]
    s_add_u32 s65, s83, s63
    s_add_u32 s66, s84, s63
    v_mfma_f32_16x16x32_bf16 v[112:115], v[216:219], a[168:171], v[112:115]
    ds_read_b64_tr_b16 v[210:211], v9 offset:4608
    v_mfma_f32_16x16x32_bf16 v[116:119], v[216:219], a[172:175], v[116:119]
    s_add_u32 s67, s85, s63
    s_add_u32 s68, s86, s63
    v_mfma_f32_16x16x32_bf16 v[120:123], v[220:223], a[160:163], v[120:123]
    ds_read_b64_tr_b16 v[212:213], v11 offset:4096
    v_mfma_f32_16x16x32_bf16 v[124:127], v[220:223], a[164:167], v[124:127]
    s_add_u32 s69, s87, s63
    s_add_u32 s70, s88, s63
    v_mfma_f32_16x16x32_bf16 v[128:131], v[220:223], a[168:171], v[128:131]
    ds_read_b64_tr_b16 v[214:215], v11 offset:4608
    v_mfma_f32_16x16x32_bf16 v[132:135], v[220:223], a[172:175], v[132:135]
    s_add_u32 s71, s89, s63
    s_add_u32 s72, s90, s63
    s_waitcnt lgkmcnt(4)
    v_mfma_f32_16x16x32_bf16 v[136:139], v[200:203], a[160:163], v[136:139]
    ds_read_b64_tr_b16 v[216:217], v9 offset:8192
    s_add_u32 m0, s35, 61440
    v_mfma_f32_16x16x32_bf16 v[140:143], v[200:203], a[164:167], v[140:143]
    buffer_load_dwordx4 v36, s[16:19], s83 offen offset:0 lds
    v_mfma_f32_16x16x32_bf16 v[144:147], v[200:203], a[168:171], v[144:147]
    ds_read_b64_tr_b16 v[218:219], v9 offset:8704
    s_add_u32 m0, s35, 65536
    v_mfma_f32_16x16x32_bf16 v[148:151], v[200:203], a[172:175], v[148:151]
    buffer_load_dwordx4 v36, s[16:19], s84 offen offset:0 lds
    v_mfma_f32_16x16x32_bf16 v[152:155], v[204:207], a[160:163], v[152:155]
    ds_read_b64_tr_b16 v[220:221], v11 offset:8192
    s_add_u32 m0, s35, 69632
    v_mfma_f32_16x16x32_bf16 v[156:159], v[204:207], a[164:167], v[156:159]
    buffer_load_dwordx4 v36, s[16:19], s85 offen offset:0 lds
    v_mfma_f32_16x16x32_bf16 v[160:163], v[204:207], a[168:171], v[160:163]
    ds_read_b64_tr_b16 v[222:223], v11 offset:8704
    s_add_u32 m0, s35, 73728
    v_mfma_f32_16x16x32_bf16 v[164:167], v[204:207], a[172:175], v[164:167]
    buffer_load_dwordx4 v36, s[16:19], s86 offen offset:0 lds
    s_waitcnt lgkmcnt(4)
    v_mfma_f32_16x16x32_bf16 v[104:107], v[208:211], a[176:179], v[104:107]
    ds_read_b64_tr_b16 v[200:201], v9 offset:12288
    s_add_u32 m0, s35, 77824
    v_mfma_f32_16x16x32_bf16 v[108:111], v[208:211], a[180:183], v[108:111]
    buffer_load_dwordx4 v36, s[16:19], s87 offen offset:0 lds
    s_waitcnt vmcnt(12)
    v_mfma_f32_16x16x32_bf16 v[112:115], v[208:211], a[184:187], v[112:115]
    ds_read_b64_tr_b16 v[202:203], v9 offset:12800
    buffer_store_dword v14, off, s[20:23], s56 offset:32 sc1
    v_mfma_f32_16x16x32_bf16 v[116:119], v[208:211], a[188:191], v[116:119]
    s_mov_b32 s95, 8192
    buffer_load_dwordx4 a[160:163], v14, s[28:31], s95 offen offset:0 sc1
    v_mfma_f32_16x16x32_bf16 v[120:123], v[212:215], a[176:179], v[120:123]
    ds_read_b64_tr_b16 v[204:205], v11 offset:12288
    buffer_load_dwordx4 a[164:167], v14, s[28:31], s95 offen offset:1024 sc1
    v_mfma_f32_16x16x32_bf16 v[124:127], v[212:215], a[180:183], v[124:127]
    buffer_load_dwordx4 a[168:171], v14, s[28:31], s95 offen offset:2048 sc1
    v_mfma_f32_16x16x32_bf16 v[128:131], v[212:215], a[184:187], v[128:131]
    ds_read_b64_tr_b16 v[206:207], v11 offset:12800
    buffer_load_dwordx4 a[172:175], v14, s[28:31], s95 offen offset:3072 sc1
    v_mfma_f32_16x16x32_bf16 v[132:135], v[212:215], a[188:191], v[132:135]
    s_waitcnt lgkmcnt(4)
    v_mfma_f32_16x16x32_bf16 v[136:139], v[216:219], a[176:179], v[136:139]
    ds_read_b64_tr_b16 v[208:209], v9 offset:16384
    v_mfma_f32_16x16x32_bf16 v[140:143], v[216:219], a[180:183], v[140:143]
    v_mfma_f32_16x16x32_bf16 v[144:147], v[216:219], a[184:187], v[144:147]
    ds_read_b64_tr_b16 v[210:211], v9 offset:16896
    v_mfma_f32_16x16x32_bf16 v[148:151], v[216:219], a[188:191], v[148:151]
    v_mfma_f32_16x16x32_bf16 v[152:155], v[220:223], a[176:179], v[152:155]
    ds_read_b64_tr_b16 v[212:213], v11 offset:16384
    v_mfma_f32_16x16x32_bf16 v[156:159], v[220:223], a[180:183], v[156:159]
    v_mfma_f32_16x16x32_bf16 v[160:163], v[220:223], a[184:187], v[160:163]
    ds_read_b64_tr_b16 v[214:215], v11 offset:16896
    v_mfma_f32_16x16x32_bf16 v[164:167], v[220:223], a[188:191], v[164:167]
    s_waitcnt lgkmcnt(4)
    v_mfma_f32_16x16x32_bf16 v[104:107], v[200:203], a[192:195], v[104:107]
    ds_read_b64_tr_b16 v[216:217], v9 offset:20480
    s_mov_b32 s95, 16384
    v_mfma_f32_16x16x32_bf16 v[108:111], v[200:203], a[196:199], v[108:111]
    buffer_load_dwordx4 a[176:179], v14, s[28:31], s95 offen offset:0 sc1
    v_mfma_f32_16x16x32_bf16 v[112:115], v[200:203], a[200:203], v[112:115]
    ds_read_b64_tr_b16 v[218:219], v9 offset:20992
    buffer_load_dwordx4 a[180:183], v14, s[28:31], s95 offen offset:1024 sc1
    v_mfma_f32_16x16x32_bf16 v[116:119], v[200:203], a[204:207], v[116:119]
    buffer_load_dwordx4 a[184:187], v14, s[28:31], s95 offen offset:2048 sc1
    v_mfma_f32_16x16x32_bf16 v[120:123], v[204:207], a[192:195], v[120:123]
    ds_read_b64_tr_b16 v[220:221], v11 offset:20480
    buffer_load_dwordx4 a[188:191], v14, s[28:31], s95 offen offset:3072 sc1
    v_mfma_f32_16x16x32_bf16 v[124:127], v[204:207], a[196:199], v[124:127]
    v_mfma_f32_16x16x32_bf16 v[128:131], v[204:207], a[200:203], v[128:131]
    ds_read_b64_tr_b16 v[222:223], v11 offset:20992
    v_mfma_f32_16x16x32_bf16 v[132:135], v[204:207], a[204:207], v[132:135]
    s_waitcnt vmcnt(17) lgkmcnt(4)
    s_barrier
    v_mfma_f32_16x16x32_bf16 v[136:139], v[208:211], a[192:195], v[136:139]
    ds_read_b64_tr_b16 v[200:201], v9 offset:24576
    s_add_u32 m0, s35, 81920
    v_mfma_f32_16x16x32_bf16 v[140:143], v[208:211], a[196:199], v[140:143]
    buffer_load_dwordx4 v36, s[16:19], s88 offen offset:0 lds
    v_mfma_f32_16x16x32_bf16 v[144:147], v[208:211], a[200:203], v[144:147]
    ds_read_b64_tr_b16 v[202:203], v9 offset:25088
    s_add_u32 m0, s35, 0
    v_mfma_f32_16x16x32_bf16 v[148:151], v[208:211], a[204:207], v[148:151]
    buffer_load_dwordx4 v36, s[16:19], s82 offen offset:0 lds
    v_mfma_f32_16x16x32_bf16 v[152:155], v[212:215], a[192:195], v[152:155]
    ds_read_b64_tr_b16 v[204:205], v11 offset:24576
    s_add_u32 m0, s35, 4096
    v_mfma_f32_16x16x32_bf16 v[156:159], v[212:215], a[196:199], v[156:159]
    buffer_load_dwordx4 v36, s[16:19], s65 offen offset:0 lds
    v_mfma_f32_16x16x32_bf16 v[160:163], v[212:215], a[200:203], v[160:163]
    ds_read_b64_tr_b16 v[206:207], v11 offset:25088
    s_add_u32 m0, s35, 8192
    v_mfma_f32_16x16x32_bf16 v[164:167], v[212:215], a[204:207], v[164:167]
    buffer_load_dwordx4 v36, s[16:19], s66 offen offset:0 lds
    s_waitcnt lgkmcnt(4)
    v_mfma_f32_16x16x32_bf16 v[104:107], v[216:219], a[208:211], v[104:107]
    ds_read_b64_tr_b16 v[208:209], v9 offset:28672
    s_add_u32 m0, s35, 12288
    v_mfma_f32_16x16x32_bf16 v[108:111], v[216:219], a[212:215], v[108:111]
    buffer_load_dwordx4 v36, s[16:19], s67 offen offset:0 lds
    v_mfma_f32_16x16x32_bf16 v[112:115], v[216:219], a[216:219], v[112:115]
    ds_read_b64_tr_b16 v[210:211], v9 offset:29184
    s_add_u32 m0, s35, 16384
    v_mfma_f32_16x16x32_bf16 v[116:119], v[216:219], a[220:223], v[116:119]
    buffer_load_dwordx4 v36, s[16:19], s68 offen offset:0 lds
    v_mfma_f32_16x16x32_bf16 v[120:123], v[220:223], a[208:211], v[120:123]
    ds_read_b64_tr_b16 v[212:213], v11 offset:28672
    buffer_load_dwordx2 v[38:39], off, s[20:23], s57 offset:32 sc1
    v_mfma_f32_16x16x32_bf16 v[124:127], v[220:223], a[212:215], v[124:127]
    s_mov_b32 s95, 24576
    buffer_load_dwordx4 a[192:195], v14, s[28:31], s95 offen offset:0 sc1
    v_mfma_f32_16x16x32_bf16 v[128:131], v[220:223], a[216:219], v[128:131]
    ds_read_b64_tr_b16 v[214:215], v11 offset:29184
    buffer_load_dwordx4 a[196:199], v14, s[28:31], s95 offen offset:1024 sc1
    v_mfma_f32_16x16x32_bf16 v[132:135], v[220:223], a[220:223], v[132:135]
    buffer_load_dwordx4 a[200:203], v14, s[28:31], s95 offen offset:2048 sc1
    s_waitcnt lgkmcnt(4)
    v_mfma_f32_16x16x32_bf16 v[136:139], v[200:203], a[208:211], v[136:139]
    ds_read_b64_tr_b16 v[216:217], v9 offset:32768
    buffer_load_dwordx4 a[204:207], v14, s[28:31], s95 offen offset:3072 sc1
    v_mfma_f32_16x16x32_bf16 v[140:143], v[200:203], a[212:215], v[140:143]
    v_mfma_f32_16x16x32_bf16 v[144:147], v[200:203], a[216:219], v[144:147]
    ds_read_b64_tr_b16 v[218:219], v9 offset:33280
    v_mfma_f32_16x16x32_bf16 v[148:151], v[200:203], a[220:223], v[148:151]
    v_mfma_f32_16x16x32_bf16 v[152:155], v[204:207], a[208:211], v[152:155]
    ds_read_b64_tr_b16 v[220:221], v11 offset:32768
    v_mfma_f32_16x16x32_bf16 v[156:159], v[204:207], a[212:215], v[156:159]
    v_mfma_f32_16x16x32_bf16 v[160:163], v[204:207], a[216:219], v[160:163]
    ds_read_b64_tr_b16 v[222:223], v11 offset:33280
    v_mfma_f32_16x16x32_bf16 v[164:167], v[204:207], a[220:223], v[164:167]
    s_waitcnt lgkmcnt(4)
    v_mfma_f32_16x16x32_bf16 v[104:107], v[208:211], a[224:227], v[104:107]
    ds_read_b64_tr_b16 v[200:201], v9 offset:36864
    s_mov_b32 s95, 32768
    v_mfma_f32_16x16x32_bf16 v[108:111], v[208:211], a[228:231], v[108:111]
    buffer_load_dwordx4 a[208:211], v14, s[28:31], s95 offen offset:0 sc1
    v_mfma_f32_16x16x32_bf16 v[112:115], v[208:211], a[232:235], v[112:115]
    ds_read_b64_tr_b16 v[202:203], v9 offset:37376
    buffer_load_dwordx4 a[212:215], v14, s[28:31], s95 offen offset:1024 sc1
    v_mfma_f32_16x16x32_bf16 v[116:119], v[208:211], a[236:239], v[116:119]
    buffer_load_dwordx4 a[216:219], v14, s[28:31], s95 offen offset:2048 sc1
    v_mfma_f32_16x16x32_bf16 v[120:123], v[212:215], a[224:227], v[120:123]
    ds_read_b64_tr_b16 v[204:205], v11 offset:36864
    buffer_load_dwordx4 a[220:223], v14, s[28:31], s95 offen offset:3072 sc1
    v_mfma_f32_16x16x32_bf16 v[124:127], v[212:215], a[228:231], v[124:127]
    v_mfma_f32_16x16x32_bf16 v[128:131], v[212:215], a[232:235], v[128:131]
    ds_read_b64_tr_b16 v[206:207], v11 offset:37376
    v_mfma_f32_16x16x32_bf16 v[132:135], v[212:215], a[236:239], v[132:135]
    s_waitcnt lgkmcnt(4)
    v_mfma_f32_16x16x32_bf16 v[136:139], v[216:219], a[224:227], v[136:139]
    ds_read_b64_tr_b16 v[208:209], v9 offset:40960
    v_mfma_f32_16x16x32_bf16 v[140:143], v[216:219], a[228:231], v[140:143]
    v_mfma_f32_16x16x32_bf16 v[144:147], v[216:219], a[232:235], v[144:147]
    ds_read_b64_tr_b16 v[210:211], v9 offset:41472
    v_mfma_f32_16x16x32_bf16 v[148:151], v[216:219], a[236:239], v[148:151]
    v_mfma_f32_16x16x32_bf16 v[152:155], v[220:223], a[224:227], v[152:155]
    ds_read_b64_tr_b16 v[212:213], v11 offset:40960
    v_mfma_f32_16x16x32_bf16 v[156:159], v[220:223], a[228:231], v[156:159]
    v_mfma_f32_16x16x32_bf16 v[160:163], v[220:223], a[232:235], v[160:163]
    ds_read_b64_tr_b16 v[214:215], v11 offset:41472
    v_mfma_f32_16x16x32_bf16 v[164:167], v[220:223], a[236:239], v[164:167]
    s_waitcnt lgkmcnt(4)
    v_mfma_f32_16x16x32_bf16 v[104:107], v[200:203], a[240:243], v[104:107]
    ds_read_b64_tr_b16 v[216:217], v9 offset:45056
    v_mfma_f32_16x16x32_bf16 v[108:111], v[200:203], a[244:247], v[108:111]
    v_mfma_f32_16x16x32_bf16 v[112:115], v[200:203], a[248:251], v[112:115]
    ds_read_b64_tr_b16 v[218:219], v9 offset:45568
    v_mfma_f32_16x16x32_bf16 v[116:119], v[200:203], a[252:255], v[116:119]
    v_mfma_f32_16x16x32_bf16 v[120:123], v[204:207], a[240:243], v[120:123]
    ds_read_b64_tr_b16 v[220:221], v11 offset:45056
    v_mfma_f32_16x16x32_bf16 v[124:127], v[204:207], a[244:247], v[124:127]
    v_mfma_f32_16x16x32_bf16 v[128:131], v[204:207], a[248:251], v[128:131]
    ds_read_b64_tr_b16 v[222:223], v11 offset:45568
    v_mfma_f32_16x16x32_bf16 v[132:135], v[204:207], a[252:255], v[132:135]
    s_waitcnt vmcnt(26) lgkmcnt(4)
    s_barrier
    v_mfma_f32_16x16x32_bf16 v[136:139], v[208:211], a[240:243], v[136:139]
    ds_read_b64_tr_b16 v[200:201], v9 offset:49152
    s_add_u32 m0, s35, 20352
    v_mfma_f32_16x16x32_bf16 v[140:143], v[208:211], a[244:247], v[140:143]
    buffer_load_dwordx4 v36, s[16:19], s83 offen offset:128 lds
    v_mfma_f32_16x16x32_bf16 v[144:147], v[208:211], a[248:251], v[144:147]
    ds_read_b64_tr_b16 v[202:203], v9 offset:49664
    s_add_u32 m0, s35, 24448
    v_mfma_f32_16x16x32_bf16 v[148:151], v[208:211], a[252:255], v[148:151]
    buffer_load_dwordx4 v36, s[16:19], s84 offen offset:128 lds
    v_mfma_f32_16x16x32_bf16 v[152:155], v[212:215], a[240:243], v[152:155]
    ds_read_b64_tr_b16 v[204:205], v11 offset:49152
    s_add_u32 m0, s35, 28544
    v_mfma_f32_16x16x32_bf16 v[156:159], v[212:215], a[244:247], v[156:159]
    buffer_load_dwordx4 v36, s[16:19], s85 offen offset:128 lds
    v_mfma_f32_16x16x32_bf16 v[160:163], v[212:215], a[248:251], v[160:163]
    ds_read_b64_tr_b16 v[206:207], v11 offset:49664
    s_add_u32 m0, s35, 32640
    v_mfma_f32_16x16x32_bf16 v[164:167], v[212:215], a[252:255], v[164:167]
    buffer_load_dwordx4 v36, s[16:19], s86 offen offset:128 lds
    s_waitcnt lgkmcnt(4)
    v_mfma_f32_16x16x32_bf16 v[104:107], v[216:219], v[224:227], v[104:107]
    ds_read_b64_tr_b16 v[208:209], v9 offset:53248
    s_add_u32 m0, s35, 36736
    v_mfma_f32_16x16x32_bf16 v[108:111], v[216:219], v[228:231], v[108:111]
    buffer_load_dwordx4 v36, s[16:19], s87 offen offset:128 lds
    v_mfma_f32_16x16x32_bf16 v[112:115], v[216:219], v[232:235], v[112:115]
    ds_read_b64_tr_b16 v[210:211], v9 offset:53760
    s_add_u32 m0, s35, 40832
    v_mfma_f32_16x16x32_bf16 v[116:119], v[216:219], v[236:239], v[116:119]
    buffer_load_dwordx4 v36, s[16:19], s88 offen offset:128 lds
    v_mfma_f32_16x16x32_bf16 v[120:123], v[220:223], v[224:227], v[120:123]
    ds_read_b64_tr_b16 v[212:213], v11 offset:53248
    v_mfma_f32_16x16x32_bf16 v[124:127], v[220:223], v[228:231], v[124:127]
    v_mfma_f32_16x16x32_bf16 v[128:131], v[220:223], v[232:235], v[128:131]
    ds_read_b64_tr_b16 v[214:215], v11 offset:53760
    v_mfma_f32_16x16x32_bf16 v[132:135], v[220:223], v[236:239], v[132:135]
    s_waitcnt lgkmcnt(4)
    v_mfma_f32_16x16x32_bf16 v[136:139], v[200:203], v[224:227], v[136:139]
    ds_read_b64_tr_b16 v[216:217], v9 offset:57344
    v_mfma_f32_16x16x32_bf16 v[140:143], v[200:203], v[228:231], v[140:143]
    v_mfma_f32_16x16x32_bf16 v[144:147], v[200:203], v[232:235], v[144:147]
    ds_read_b64_tr_b16 v[218:219], v9 offset:57856
    v_mfma_f32_16x16x32_bf16 v[148:151], v[200:203], v[236:239], v[148:151]
    v_mfma_f32_16x16x32_bf16 v[152:155], v[204:207], v[224:227], v[152:155]
    ds_read_b64_tr_b16 v[220:221], v11 offset:57344
    v_mfma_f32_16x16x32_bf16 v[156:159], v[204:207], v[228:231], v[156:159]
    v_mfma_f32_16x16x32_bf16 v[160:163], v[204:207], v[232:235], v[160:163]
    ds_read_b64_tr_b16 v[222:223], v11 offset:57856
    v_mfma_f32_16x16x32_bf16 v[164:167], v[204:207], v[236:239], v[164:167]
    s_waitcnt lgkmcnt(4)
    v_mfma_f32_16x16x32_bf16 v[104:107], v[208:211], v[240:243], v[104:107]
    ds_read_b64_tr_b16 v[200:201], v3 offset:61440
    v_mfma_f32_16x16x32_bf16 v[108:111], v[208:211], v[244:247], v[108:111]
    s_mul_i32 s36, s33, 576
    s_lshl_b32 s37, s93, 4
    v_mfma_f32_16x16x32_bf16 v[112:115], v[208:211], v[248:251], v[112:115]
    ds_read_b64_tr_b16 v[202:203], v3 offset:63488
    s_add_u32 s36, s36, s37
    v_mfma_f32_16x16x32_bf16 v[116:119], v[208:211], v[252:255], v[116:119]
    v_lshrrev_b32 v2, 2, v0
    v_add_u32 v2, s36, v2
    v_mfma_f32_16x16x32_bf16 v[120:123], v[212:215], v[240:243], v[120:123]
    ds_read_b64_tr_b16 v[204:205], v5 offset:61440
    v_mul_u32_u24 v2, 1152, v2
    v_mfma_f32_16x16x32_bf16 v[124:127], v[212:215], v[244:247], v[124:127]
    v_bfe_u32 v9, v0, 4, 1
    v_lshlrev_b32 v10, 1, v9
    v_mfma_f32_16x16x32_bf16 v[128:131], v[212:215], v[248:251], v[128:131]
    ds_read_b64_tr_b16 v[206:207], v5 offset:63488
    v_and_b32 v1, 3, v0
    v_mfma_f32_16x16x32_bf16 v[132:135], v[212:215], v[252:255], v[132:135]
    v_xor_b32 v10, v10, v1
    s_waitcnt lgkmcnt(4)
    v_mfma_f32_16x16x32_bf16 v[136:139], v[216:219], v[240:243], v[136:139]
    ds_read_b64_tr_b16 v[208:209], v4 offset:0
    v_lshl_add_u32 v2, v10, 4, v2
    v_mfma_f32_16x16x32_bf16 v[140:143], v[216:219], v[244:247], v[140:143]
    s_lshl_b32 s36, s3, 6
    s_add_u32 s36, s36, 512
    v_mfma_f32_16x16x32_bf16 v[144:147], v[216:219], v[248:251], v[144:147]
    ds_read_b64_tr_b16 v[210:211], v4 offset:2048
    v_add_u32 v2, s36, v2
    v_mfma_f32_16x16x32_bf16 v[148:151], v[216:219], v[252:255], v[148:151]
    v_xor_b32 v9, s93, v9
    v_lshlrev_b32 v1, 3, v1
    v_mfma_f32_16x16x32_bf16 v[152:155], v[220:223], v[240:243], v[152:155]
    ds_read_b64_tr_b16 v[212:213], v6 offset:0
    v_lshl_add_u32 v9, v9, 5, v1
    v_mfma_f32_16x16x32_bf16 v[156:159], v[220:223], v[244:247], v[156:159]
    v_lshrrev_b32 v10, 2, v0
    v_lshl_add_u32 v9, v10, 6, v9
    v_mfma_f32_16x16x32_bf16 v[160:163], v[220:223], v[248:251], v[160:163]
    ds_read_b64_tr_b16 v[214:215], v6 offset:2048
    v_add_u32 v9, 4096, v9
    v_mfma_f32_16x16x32_bf16 v[164:167], v[220:223], v[252:255], v[164:167]
    v_add_u32 v10, 0x10000, v9
    s_waitcnt lgkmcnt(4)
    v_mfma_f32_16x16x32_bf16 v[40:43], v[200:203], a[16:19], 0
    ds_read_b64_tr_b16 v[216:217], v4 offset:4096
    s_waitcnt vmcnt(14)
    s_mov_b32 s60, 0
ffn_kernel_sp_76:
    v_min_u32 v38, v38, v39
    s_add_u32 s60, s60, 1
    v_readfirstlane_b32 s58, v38
    s_cmp_lg_u32 s58, 0
    s_cbranch_scc1 ffn_kernel_sp_76d
    s_cmp_ge_u32 s60, 0x8000
    s_cbranch_scc1 ffn_kernel_sp_76d
    buffer_load_dwordx2 v[38:39], off, s[20:23], s57 offset:32 sc1
    s_waitcnt vmcnt(0)
    s_branch ffn_kernel_sp_76
ffn_kernel_sp_76d:
    v_mfma_f32_16x16x32_bf16 v[44:47], v[200:203], a[20:23], 0
    v_and_b32 v1, 31, v0
    v_lshlrev_b32 v1, 5, v1
    v_mfma_f32_16x16x32_bf16 v[48:51], v[200:203], a[24:27], 0
    ds_read_b64_tr_b16 v[218:219], v4 offset:6144
    v_lshrrev_b32 v11, 5, v0
    v_mfma_f32_16x16x32_bf16 v[52:55], v[200:203], a[28:31], 0
    v_lshl_add_u32 v1, v11, 4, v1
    v_mfma_f32_16x16x32_bf16 v[56:59], v[204:207], a[16:19], 0
    ds_read_b64_tr_b16 v[220:221], v6 offset:4096
    v_mfma_f32_16x16x32_bf16 v[60:63], v[204:207], a[20:23], 0
    s_add_u32 s36, s3, 8
    s_lshl_b32 s36, s36, 13
    v_mfma_f32_16x16x32_bf16 v[64:67], v[204:207], a[24:27], 0
    ds_read_b64_tr_b16 v[222:223], v6 offset:6144
    v_mfma_f32_16x16x32_bf16 v[68:71], v[204:207], a[28:31], 0
    s_waitcnt lgkmcnt(4)
    s_barrier
    v_mfma_f32_16x16x32_bf16 v[40:43], v[208:211], a[32:35], v[40:43]
    ds_read_b64_tr_b16 v[200:201], v4 offset:8192
    s_add_u32 m0, s35, 44928
    v_mfma_f32_16x16x32_bf16 v[44:47], v[208:211], a[36:39], v[44:47]
    buffer_load_dwordx4 v36, s[16:19], s82 offen offset:128 lds
    v_mfma_f32_16x16x32_bf16 v[48:51], v[208:211], a[40:43], v[48:51]
    ds_read_b64_tr_b16 v[202:203], v4 offset:10240
    s_add_u32 m0, s35, 49024
    v_mfma_f32_16x16x32_bf16 v[52:55], v[208:211], a[44:47], v[52:55]
    buffer_load_dwordx4 v36, s[16:19], s65 offen offset:128 lds
    v_mfma_f32_16x16x32_bf16 v[56:59], v[212:215], a[32:35], v[56:59]
    ds_read_b64_tr_b16 v[204:205], v6 offset:8192
    s_add_u32 m0, s35, 53120
    v_mfma_f32_16x16x32_bf16 v[60:63], v[212:215], a[36:39], v[60:63]
    buffer_load_dwordx4 v36, s[16:19], s66 offen offset:128 lds
    v_mfma_f32_16x16x32_bf16 v[64:67], v[212:215], a[40:43], v[64:67]
    ds_read_b64_tr_b16 v[206:207], v6 offset:10240
    s_add_u32 m0, s35, 57216
    v_mfma_f32_16x16x32_bf16 v[68:71], v[212:215], a[44:47], v[68:71]
    buffer_load_dwordx4 v36, s[16:19], s67 offen offset:128 lds
    s_waitcnt lgkmcnt(4)
    v_mfma_f32_16x16x32_bf16 v[40:43], v[216:219], a[48:51], v[40:43]
    ds_read_b64_tr_b16 v[208:209], v4 offset:12288
    s_add_u32 m0, s35, 61312
    v_mfma_f32_16x16x32_bf16 v[44:47], v[216:219], a[52:55], v[44:47]
    buffer_load_dwordx4 v36, s[16:19], s68 offen offset:128 lds
    v_mfma_f32_16x16x32_bf16 v[48:51], v[216:219], a[56:59], v[48:51]
    ds_read_b64_tr_b16 v[210:211], v4 offset:14336
    s_add_u32 m0, s35, 65280
    v_mfma_f32_16x16x32_bf16 v[52:55], v[216:219], a[60:63], v[52:55]
    buffer_load_dwordx4 v36, s[16:19], s83 offen offset:256 lds
    v_mfma_f32_16x16x32_bf16 v[56:59], v[220:223], a[48:51], v[56:59]
    ds_read_b64_tr_b16 v[212:213], v6 offset:12288
    v_mfma_f32_16x16x32_bf16 v[60:63], v[220:223], a[52:55], v[60:63]
    s_lshl_b32 s59, s92, 12
    s_add_u32 s59, s59, 90112
    v_mfma_f32_16x16x32_bf16 v[64:67], v[220:223], a[56:59], v[64:67]
    ds_read_b64_tr_b16 v[214:215], v6 offset:14336
    v_lshl_add_u32 v38, v0, 3, s59
    v_mfma_f32_16x16x32_bf16 v[68:71], v[220:223], a[60:63], v[68:71]
    buffer_load_dwordx2 a[144:145], v38, s[28:31], 0 offen offset:0 sc1
    s_waitcnt lgkmcnt(4)
    v_mfma_f32_16x16x32_bf16 v[40:43], v[200:203], a[64:67], v[40:43]
    ds_read_b64_tr_b16 v[216:217], v4 offset:16384
    buffer_load_dwordx2 a[146:147], v38, s[28:31], 0 offen offset:512 sc1
    v_mfma_f32_16x16x32_bf16 v[44:47], v[200:203], a[68:71], v[44:47]
    buffer_load_dwordx2 a[148:149], v38, s[28:31], 0 offen offset:1024 sc1
    v_mfma_f32_16x16x32_bf16 v[48:51], v[200:203], a[72:75], v[48:51]
    ds_read_b64_tr_b16 v[218:219], v4 offset:18432
    buffer_load_dwordx2 a[150:151], v38, s[28:31], 0 offen offset:1536 sc1
    v_mfma_f32_16x16x32_bf16 v[52:55], v[200:203], a[76:79], v[52:55]
    buffer_load_dwordx2 a[152:153], v38, s[28:31], 0 offen offset:2048 sc1
    v_mfma_f32_16x16x32_bf16 v[56:59], v[204:207], a[64:67], v[56:59]
    ds_read_b64_tr_b16 v[220:221], v6 offset:16384
    buffer_load_dwordx2 a[154:155], v38, s[28:31], 0 offen offset:2560 sc1
    v_mfma_f32_16x16x32_bf16 v[60:63], v[204:207], a[68:71], v[60:63]
    buffer_load_dwordx2 a[156:157], v38, s[28:31], 0 offen offset:3072 sc1
    v_mfma_f32_16x16x32_bf16 v[64:67], v[204:207], a[72:75], v[64:67]
    ds_read_b64_tr_b16 v[222:223], v6 offset:18432
    buffer_load_dwordx2 a[158:159], v38, s[28:31], 0 offen offset:3584 sc1
    v_mfma_f32_16x16x32_bf16 v[68:71], v[204:207], a[76:79], v[68:71]
    s_mov_b32 s95, 40960
    s_waitcnt lgkmcnt(4)
    v_mfma_f32_16x16x32_bf16 v[40:43], v[208:211], a[80:83], v[40:43]
    ds_read_b64_tr_b16 v[200:201], v3 offset:0
    buffer_load_dwordx4 a[224:227], v14, s[28:31], s95 offen offset:0 sc1
    v_mfma_f32_16x16x32_bf16 v[44:47], v[208:211], a[84:87], v[44:47]
    buffer_load_dwordx4 a[228:231], v14, s[28:31], s95 offen offset:1024 sc1
    v_mfma_f32_16x16x32_bf16 v[48:51], v[208:211], a[88:91], v[48:51]
    ds_read_b64_tr_b16 v[202:203], v3 offset:2048
    buffer_load_dwordx4 a[232:235], v14, s[28:31], s95 offen offset:2048 sc1
    v_mfma_f32_16x16x32_bf16 v[52:55], v[208:211], a[92:95], v[52:55]
    buffer_load_dwordx4 a[236:239], v14, s[28:31], s95 offen offset:3072 sc1
    s_mov_b32 s95, 49152
    v_mfma_f32_16x16x32_bf16 v[56:59], v[212:215], a[80:83], v[56:59]
    ds_read_b64_tr_b16 v[204:205], v5 offset:0
    buffer_load_dwordx4 a[240:243], v14, s[28:31], s95 offen offset:0 sc1
    v_mfma_f32_16x16x32_bf16 v[60:63], v[212:215], a[84:87], v[60:63]
    buffer_load_dwordx4 a[244:247], v14, s[28:31], s95 offen offset:1024 sc1
    v_mfma_f32_16x16x32_bf16 v[64:67], v[212:215], a[88:91], v[64:67]
    ds_read_b64_tr_b16 v[206:207], v5 offset:2048
    buffer_load_dwordx4 a[248:251], v14, s[28:31], s95 offen offset:2048 sc1
    v_mfma_f32_16x16x32_bf16 v[68:71], v[212:215], a[92:95], v[68:71]
    buffer_load_dwordx4 a[252:255], v14, s[28:31], s95 offen offset:3072 sc1
    s_waitcnt lgkmcnt(4)
    v_mfma_f32_16x16x32_bf16 v[40:43], v[216:219], a[96:99], v[40:43]
    ds_read_b64_tr_b16 v[208:209], v3 offset:4096
    v_mfma_f32_16x16x32_bf16 v[44:47], v[216:219], a[100:103], v[44:47]
    s_lshl_b32 s37, s93, 12
    s_add_u32 s36, s36, s37
    v_mfma_f32_16x16x32_bf16 v[48:51], v[216:219], a[104:107], v[48:51]
    ds_read_b64_tr_b16 v[210:211], v3 offset:6144
    v_mfma_f32_16x16x32_bf16 v[52:55], v[216:219], a[108:111], v[52:55]
    s_lshl_b32 s37, s92, 11
    s_add_u32 s36, s36, s37
    v_mfma_f32_16x16x32_bf16 v[56:59], v[220:223], a[96:99], v[56:59]
    ds_read_b64_tr_b16 v[212:213], v5 offset:4096
    v_add_u32 v1, s36, v1
    v_mfma_f32_16x16x32_bf16 v[60:63], v[220:223], a[100:103], v[60:63]
    v_mul_f32 v104, v104, v136
    v_mul_f32 v105, v105, v137
    v_mfma_f32_16x16x32_bf16 v[64:67], v[220:223], a[104:107], v[64:67]
    ds_read_b64_tr_b16 v[214:215], v5 offset:6144
    v_mul_f32 v106, v106, v138
    v_mfma_f32_16x16x32_bf16 v[68:71], v[220:223], a[108:111], v[68:71]
    v_mul_f32 v107, v107, v139
    s_waitcnt lgkmcnt(4)
    v_mfma_f32_16x16x32_bf16 v[40:43], v[200:203], a[0:3], v[40:43]
    ds_read_b64_tr_b16 v[216:217], v3 offset:8192
    v_mul_f32 v120, v120, v152
    v_mfma_f32_16x16x32_bf16 v[44:47], v[200:203], a[4:7], v[44:47]
    v_mul_f32 v121, v121, v153
    v_mul_f32 v122, v122, v154
    v_mfma_f32_16x16x32_bf16 v[48:51], v[200:203], a[8:11], v[48:51]
    ds_read_b64_tr_b16 v[218:219], v3 offset:10240
    v_mul_f32 v123, v123, v155
    v_mfma_f32_16x16x32_bf16 v[52:55], v[200:203], a[12:15], v[52:55]
    v_cvt_pk_bf16_f32 v136, v104, v105
    v_cvt_pk_bf16_f32 v137, v106, v107
    v_mfma_f32_16x16x32_bf16 v[56:59], v[204:207], a[0:3], v[56:59]
    ds_read_b64_tr_b16 v[220:221], v5 offset:8192
    v_cvt_pk_bf16_f32 v138, v120, v121
    v_mfma_f32_16x16x32_bf16 v[60:63], v[204:207], a[4:7], v[60:63]
    v_cvt_pk_bf16_f32 v139, v122, v123
    ds_write_b128 v13, v[136:139] offset:49152
    v_mfma_f32_16x16x32_bf16 v[64:67], v[204:207], a[8:11], v[64:67]
    ds_read_b64_tr_b16 v[222:223], v5 offset:10240
    s_mov_b32 s91, 49152
    v_mfma_f32_16x16x32_bf16 v[68:71], v[204:207], a[12:15], v[68:71]
    s_waitcnt vmcnt(24) lgkmcnt(5)
    s_barrier
    v_mfma_f32_16x16x32_bf16 v[40:43], v[208:211], a[160:163], v[40:43]
    ds_read_b64_tr_b16 v[200:201], v3 offset:12288
    s_add_u32 m0, s35, 69376
    v_mfma_f32_16x16x32_bf16 v[44:47], v[208:211], a[164:167], v[44:47]
    buffer_load_dwordx4 v36, s[16:19], s84 offen offset:256 lds
    v_mfma_f32_16x16x32_bf16 v[48:51], v[208:211], a[168:171], v[48:51]
    ds_read_b64_tr_b16 v[202:203], v3 offset:14336
    s_add_u32 m0, s35, 73472
    v_mfma_f32_16x16x32_bf16 v[52:55], v[208:211], a[172:175], v[52:55]
    buffer_load_dwordx4 v36, s[16:19], s85 offen offset:256 lds
    v_mfma_f32_16x16x32_bf16 v[56:59], v[212:215], a[160:163], v[56:59]
    ds_read_b64_tr_b16 v[204:205], v5 offset:12288
    s_add_u32 m0, s35, 77568
    v_mfma_f32_16x16x32_bf16 v[60:63], v[212:215], a[164:167], v[60:63]
    buffer_load_dwordx4 v36, s[16:19], s86 offen offset:256 lds
    v_mfma_f32_16x16x32_bf16 v[64:67], v[212:215], a[168:171], v[64:67]
    ds_read_b64_tr_b16 v[206:207], v5 offset:14336
    s_add_u32 m0, s35, 81664
    v_mfma_f32_16x16x32_bf16 v[68:71], v[212:215], a[172:175], v[68:71]
    buffer_load_dwordx4 v36, s[16:19], s87 offen offset:256 lds
    s_waitcnt lgkmcnt(4)
    v_mfma_f32_16x16x32_bf16 v[40:43], v[216:219], a[176:179], v[40:43]
    ds_read_b64_tr_b16 v[208:209], v3 offset:16384
    s_sub_u32 m0, s35, 256
    v_mfma_f32_16x16x32_bf16 v[44:47], v[216:219], a[180:183], v[44:47]
    buffer_load_dwordx4 v36, s[16:19], s88 offen offset:256 lds
    v_mfma_f32_16x16x32_bf16 v[48:51], v[216:219], a[184:187], v[48:51]
    ds_read_b64_tr_b16 v[210:211], v3 offset:18432
    s_add_u32 m0, s35, 3840
    v_mfma_f32_16x16x32_bf16 v[52:55], v[216:219], a[188:191], v[52:55]
    buffer_load_dwordx4 v36, s[16:19], s82 offen offset:256 lds
    v_mfma_f32_16x16x32_bf16 v[56:59], v[220:223], a[176:179], v[56:59]
    ds_read_b64_tr_b16 v[212:213], v5 offset:16384
    buffer_store_dwordx4 v[136:139], v13, s[96:99], s91 offen offset:0 sc1
    v_mfma_f32_16x16x32_bf16 v[60:63], v[220:223], a[180:183], v[60:63]
    v_mul_f32 v108, v108, v140
    v_mul_f32 v109, v109, v141
    v_mfma_f32_16x16x32_bf16 v[64:67], v[220:223], a[184:187], v[64:67]
    ds_read_b64_tr_b16 v[214:215], v5 offset:18432
    v_mul_f32 v110, v110, v142
    v_mfma_f32_16x16x32_bf16 v[68:71], v[220:223], a[188:191], v[68:71]
    v_mul_f32 v111, v111, v143
    s_waitcnt lgkmcnt(4)
    v_mfma_f32_16x16x32_bf16 v[40:43], v[200:203], a[192:195], v[40:43]
    ds_read_b64_tr_b16 v[216:217], v3 offset:20480
    v_mul_f32 v124, v124, v156
    v_mfma_f32_16x16x32_bf16 v[44:47], v[200:203], a[196:199], v[44:47]
    v_mul_f32 v125, v125, v157
    v_mul_f32 v126, v126, v158
    v_mfma_f32_16x16x32_bf16 v[48:51], v[200:203], a[200:203], v[48:51]
    ds_read_b64_tr_b16 v[218:219], v3 offset:22528
    v_mul_f32 v127, v127, v159
    v_mfma_f32_16x16x32_bf16 v[52:55], v[200:203], a[204:207], v[52:55]
    v_cvt_pk_bf16_f32 v140, v108, v109
    v_cvt_pk_bf16_f32 v141, v110, v111
    v_mfma_f32_16x16x32_bf16 v[56:59], v[204:207], a[192:195], v[56:59]
    ds_read_b64_tr_b16 v[220:221], v5 offset:20480
    v_cvt_pk_bf16_f32 v142, v124, v125
    v_mfma_f32_16x16x32_bf16 v[60:63], v[204:207], a[196:199], v[60:63]
    v_cvt_pk_bf16_f32 v143, v126, v127
    ds_write_b128 v13, v[140:143] offset:50176
    v_mfma_f32_16x16x32_bf16 v[64:67], v[204:207], a[200:203], v[64:67]
    ds_read_b64_tr_b16 v[222:223], v5 offset:22528
    buffer_store_dwordx4 v[140:143], v13, s[96:99], s91 offen offset:1024 sc1
    v_mfma_f32_16x16x32_bf16 v[68:71], v[204:207], a[204:207], v[68:71]
    v_mul_f32 v112, v112, v144
    s_waitcnt lgkmcnt(5)
    v_mfma_f32_16x16x32_bf16 v[40:43], v[208:211], a[208:211], v[40:43]
    ds_read_b64_tr_b16 v[200:201], v3 offset:24576
    v_mul_f32 v113, v113, v145
    v_mfma_f32_16x16x32_bf16 v[44:47], v[208:211], a[212:215], v[44:47]
    v_mul_f32 v114, v114, v146
    v_mul_f32 v115, v115, v147
    v_mfma_f32_16x16x32_bf16 v[48:51], v[208:211], a[216:219], v[48:51]
    ds_read_b64_tr_b16 v[202:203], v3 offset:26624
    v_mul_f32 v128, v128, v160
    v_mfma_f32_16x16x32_bf16 v[52:55], v[208:211], a[220:223], v[52:55]
    v_mul_f32 v129, v129, v161
    v_mul_f32 v130, v130, v162
    v_mfma_f32_16x16x32_bf16 v[56:59], v[212:215], a[208:211], v[56:59]
    ds_read_b64_tr_b16 v[204:205], v5 offset:24576
    v_mul_f32 v131, v131, v163
    v_mfma_f32_16x16x32_bf16 v[60:63], v[212:215], a[212:215], v[60:63]
    v_cvt_pk_bf16_f32 v144, v112, v113
    v_cvt_pk_bf16_f32 v145, v114, v115
    v_mfma_f32_16x16x32_bf16 v[64:67], v[212:215], a[216:219], v[64:67]
    ds_read_b64_tr_b16 v[206:207], v5 offset:26624
    v_cvt_pk_bf16_f32 v146, v128, v129
    v_mfma_f32_16x16x32_bf16 v[68:71], v[212:215], a[220:223], v[68:71]
    v_cvt_pk_bf16_f32 v147, v130, v131
    s_waitcnt lgkmcnt(4)
    v_mfma_f32_16x16x32_bf16 v[72:75], v[216:219], a[16:19], 0
    ds_read_b64_tr_b16 v[208:209], v3 offset:28672
    v_mfma_f32_16x16x32_bf16 v[76:79], v[216:219], a[20:23], 0
    ds_write_b128 v13, v[144:147] offset:51200
    buffer_store_dwordx4 v[144:147], v13, s[96:99], s91 offen offset:2048 sc1
    v_mfma_f32_16x16x32_bf16 v[80:83], v[216:219], a[24:27], 0
    ds_read_b64_tr_b16 v[210:211], v3 offset:30720
    v_mul_f32 v116, v116, v148
    v_mfma_f32_16x16x32_bf16 v[84:87], v[216:219], a[28:31], 0
    v_mul_f32 v117, v117, v149
    v_mul_f32 v118, v118, v150
    v_mfma_f32_16x16x32_bf16 v[88:91], v[220:223], a[16:19], 0
    ds_read_b64_tr_b16 v[212:213], v5 offset:28672
    v_mul_f32 v119, v119, v151
    v_mfma_f32_16x16x32_bf16 v[92:95], v[220:223], a[20:23], 0
    v_mul_f32 v132, v132, v164
    v_mul_f32 v133, v133, v165
    v_mfma_f32_16x16x32_bf16 v[96:99], v[220:223], a[24:27], 0
    ds_read_b64_tr_b16 v[214:215], v5 offset:30720
    v_mul_f32 v134, v134, v166
    v_mfma_f32_16x16x32_bf16 v[100:103], v[220:223], a[28:31], 0
    v_mul_f32 v135, v135, v167
    s_waitcnt lgkmcnt(5)
    v_mfma_f32_16x16x32_bf16 v[72:75], v[200:203], a[32:35], v[72:75]
    ds_read_b64_tr_b16 v[216:217], v3 offset:32768
    v_cvt_pk_bf16_f32 v148, v116, v117
    v_mfma_f32_16x16x32_bf16 v[76:79], v[200:203], a[36:39], v[76:79]
    v_cvt_pk_bf16_f32 v149, v118, v119
    v_cvt_pk_bf16_f32 v150, v132, v133
    v_mfma_f32_16x16x32_bf16 v[80:83], v[200:203], a[40:43], v[80:83]
    ds_read_b64_tr_b16 v[218:219], v3 offset:34816
    v_cvt_pk_bf16_f32 v151, v134, v135
    v_mfma_f32_16x16x32_bf16 v[84:87], v[200:203], a[44:47], v[84:87]
    ds_write_b128 v13, v[148:151] offset:52224
    buffer_store_dwordx4 v[148:151], v13, s[96:99], s91 offen offset:3072 sc1
    v_mfma_f32_16x16x32_bf16 v[88:91], v[204:207], a[32:35], v[88:91]
    ds_read_b64_tr_b16 v[220:221], v5 offset:32768
    v_mfma_f32_16x16x32_bf16 v[92:95], v[204:207], a[36:39], v[92:95]
    v_mfma_f32_16x16x32_bf16 v[96:99], v[204:207], a[40:43], v[96:99]
    ds_read_b64_tr_b16 v[222:223], v5 offset:34816
    v_mfma_f32_16x16x32_bf16 v[100:103], v[204:207], a[44:47], v[100:103]
    s_waitcnt vmcnt(28) lgkmcnt(2)
    s_barrier
    v_mfma_f32_16x16x32_bf16 v[72:75], v[208:211], a[48:51], v[72:75]
    ds_read_b64_tr_b16 v[200:201], v3 offset:36864
    s_add_u32 m0, s35, 7936
    v_mfma_f32_16x16x32_bf16 v[76:79], v[208:211], a[52:55], v[76:79]
    ds_read_b128 a[112:115], v14 offset:57344
    buffer_load_dwordx4 v36, s[16:19], s65 offen offset:256 lds
    v_mfma_f32_16x16x32_bf16 v[80:83], v[208:211], a[56:59], v[80:83]
    ds_read_b64_tr_b16 v[202:203], v3 offset:38912
    s_add_u32 m0, s35, 12032
    v_mfma_f32_16x16x32_bf16 v[84:87], v[208:211], a[60:63], v[84:87]
    ds_read_b128 a[116:119], v14 offset:58368
    buffer_load_dwordx4 v36, s[16:19], s66 offen offset:256 lds
    v_mfma_f32_16x16x32_bf16 v[88:91], v[212:215], a[48:51], v[88:91]
    ds_read_b64_tr_b16 v[204:205], v5 offset:36864
    s_add_u32 m0, s35, 16128
    v_mfma_f32_16x16x32_bf16 v[92:95], v[212:215], a[52:55], v[92:95]
    ds_read_b128 a[120:123], v14 offset:59392
    buffer_load_dwordx4 v36, s[16:19], s67 offen offset:256 lds
    v_mfma_f32_16x16x32_bf16 v[96:99], v[212:215], a[56:59], v[96:99]
    ds_read_b64_tr_b16 v[206:207], v5 offset:38912
    s_add_u32 m0, s35, 20224
    v_mfma_f32_16x16x32_bf16 v[100:103], v[212:215], a[60:63], v[100:103]
    ds_read_b128 a[124:127], v14 offset:60416
    s_waitcnt lgkmcnt(8)
    v_mfma_f32_16x16x32_bf16 v[72:75], v[216:219], a[64:67], v[72:75]
    ds_read_b64_tr_b16 v[208:209], v3 offset:40960
    buffer_load_dwordx4 v36, s[16:19], s68 offen offset:256 lds
    v_mfma_f32_16x16x32_bf16 v[76:79], v[216:219], a[68:71], v[76:79]
    ds_read_b128 a[128:131], v7 offset:0
    v_mfma_f32_16x16x32_bf16 v[80:83], v[216:219], a[72:75], v[80:83]
    ds_read_b64_tr_b16 v[210:211], v3 offset:43008
    v_mfma_f32_16x16x32_bf16 v[84:87], v[216:219], a[76:79], v[84:87]
    ds_read_b128 a[132:135], v7 offset:1024
    v_mfma_f32_16x16x32_bf16 v[88:91], v[220:223], a[64:67], v[88:91]
    ds_read_b64_tr_b16 v[212:213], v5 offset:40960
    v_mfma_f32_16x16x32_bf16 v[92:95], v[220:223], a[68:71], v[92:95]
    ds_read_b128 a[136:139], v7 offset:2048
    v_mfma_f32_16x16x32_bf16 v[96:99], v[220:223], a[72:75], v[96:99]
    ds_read_b64_tr_b16 v[214:215], v5 offset:43008
    v_mfma_f32_16x16x32_bf16 v[100:103], v[220:223], a[76:79], v[100:103]
    ds_read_b128 a[140:143], v7 offset:3072
    s_waitcnt lgkmcnt(9)
    v_mfma_f32_16x16x32_bf16 v[72:75], v[200:203], a[80:83], v[72:75]
    ds_read_b64_tr_b16 v[216:217], v3 offset:45056
    v_mfma_f32_16x16x32_bf16 v[76:79], v[200:203], a[84:87], v[76:79]
    s_cmp_eq_u32 s92, 0
    s_cselect_b32 s63, s83, s84
    v_mfma_f32_16x16x32_bf16 v[80:83], v[200:203], a[88:91], v[80:83]
    ds_read_b64_tr_b16 v[218:219], v3 offset:47104
    s_add_u32 m0, s35, 24576
    v_mfma_f32_16x16x32_bf16 v[84:87], v[200:203], a[92:95], v[84:87]
    buffer_load_dwordx4 v2, s[16:19], s63 offen lds
    v_mfma_f32_16x16x32_bf16 v[88:91], v[204:207], a[80:83], v[88:91]
    ds_read_b64_tr_b16 v[220:221], v5 offset:45056
    v_mfma_f32_16x16x32_bf16 v[92:95], v[204:207], a[84:87], v[92:95]
    s_cmp_eq_u32 s92, 0
    s_cselect_b32 s63, s85, s86
    v_mfma_f32_16x16x32_bf16 v[96:99], v[204:207], a[88:91], v[96:99]
    ds_read_b64_tr_b16 v[222:223], v5 offset:47104
    s_add_u32 m0, s35, 28672
    v_mfma_f32_16x16x32_bf16 v[100:103], v[204:207], a[92:95], v[100:103]
    buffer_load_dwordx4 v2, s[16:19], s63 offen lds
    s_waitcnt lgkmcnt(5)
    v_mfma_f32_16x16x32_bf16 v[72:75], v[208:211], a[96:99], v[72:75]
    ds_read_b64_tr_b16 v[200:201], v3 offset:49152
    v_mfma_f32_16x16x32_bf16 v[76:79], v[208:211], a[100:103], v[76:79]
    v_mfma_f32_16x16x32_bf16 v[80:83], v[208:211], a[104:107], v[80:83]
    ds_read_b64_tr_b16 v[202:203], v3 offset:51200
    v_mfma_f32_16x16x32_bf16 v[84:87], v[208:211], a[108:111], v[84:87]
    v_mfma_f32_16x16x32_bf16 v[88:91], v[212:215], a[96:99], v[88:91]
    ds_read_b64_tr_b16 v[204:205], v5 offset:49152
    v_mfma_f32_16x16x32_bf16 v[92:95], v[212:215], a[100:103], v[92:95]
    v_mfma_f32_16x16x32_bf16 v[96:99], v[212:215], a[104:107], v[96:99]
    ds_read_b64_tr_b16 v[206:207], v5 offset:51200
    v_mfma_f32_16x16x32_bf16 v[100:103], v[212:215], a[108:111], v[100:103]
    s_waitcnt lgkmcnt(4)
    v_mfma_f32_16x16x32_bf16 v[72:75], v[216:219], a[0:3], v[72:75]
    ds_read_b64_tr_b16 v[208:209], v3 offset:53248
    v_mfma_f32_16x16x32_bf16 v[76:79], v[216:219], a[4:7], v[76:79]
    v_mfma_f32_16x16x32_bf16 v[80:83], v[216:219], a[8:11], v[80:83]
    ds_read_b64_tr_b16 v[210:211], v3 offset:55296
    v_mfma_f32_16x16x32_bf16 v[84:87], v[216:219], a[12:15], v[84:87]
    v_mfma_f32_16x16x32_bf16 v[88:91], v[220:223], a[0:3], v[88:91]
    ds_read_b64_tr_b16 v[212:213], v5 offset:53248
    v_mfma_f32_16x16x32_bf16 v[92:95], v[220:223], a[4:7], v[92:95]
    v_mfma_f32_16x16x32_bf16 v[96:99], v[220:223], a[8:11], v[96:99]
    ds_read_b64_tr_b16 v[214:215], v5 offset:55296
    v_mfma_f32_16x16x32_bf16 v[100:103], v[220:223], a[12:15], v[100:103]
    s_waitcnt lgkmcnt(4)
    v_mfma_f32_16x16x32_bf16 v[72:75], v[200:203], a[160:163], v[72:75]
    ds_read_b64_tr_b16 v[216:217], v3 offset:57344
    v_mfma_f32_16x16x32_bf16 v[76:79], v[200:203], a[164:167], v[76:79]
    v_mfma_f32_16x16x32_bf16 v[80:83], v[200:203], a[168:171], v[80:83]
    ds_read_b64_tr_b16 v[218:219], v3 offset:59392
    v_mfma_f32_16x16x32_bf16 v[84:87], v[200:203], a[172:175], v[84:87]
    v_mfma_f32_16x16x32_bf16 v[88:91], v[204:207], a[160:163], v[88:91]
    ds_read_b64_tr_b16 v[220:221], v5 offset:57344
    v_mfma_f32_16x16x32_bf16 v[92:95], v[204:207], a[164:167], v[92:95]
    v_mfma_f32_16x16x32_bf16 v[96:99], v[204:207], a[168:171], v[96:99]
    ds_read_b64_tr_b16 v[222:223], v5 offset:59392
    v_mfma_f32_16x16x32_bf16 v[100:103], v[204:207], a[172:175], v[100:103]
    s_waitcnt vmcnt(12) lgkmcnt(4)
    s_barrier
    v_mfma_f32_16x16x32_bf16 v[72:75], v[208:211], a[176:179], v[72:75]
    ds_read_b64_tr_b16 v[200:201], v3 offset:61440
    v_mfma_f32_16x16x32_bf16 v[76:79], v[208:211], a[180:183], v[76:79]
    s_cmp_eq_u32 s92, 0
    s_cselect_b32 s63, s87, s88
    v_mfma_f32_16x16x32_bf16 v[80:83], v[208:211], a[184:187], v[80:83]
    ds_read_b64_tr_b16 v[202:203], v3 offset:63488
    s_add_u32 m0, s35, 32768
    v_mfma_f32_16x16x32_bf16 v[84:87], v[208:211], a[188:191], v[84:87]
    buffer_load_dwordx4 v2, s[16:19], s63 offen lds
    v_mfma_f32_16x16x32_bf16 v[88:91], v[212:215], a[176:179], v[88:91]
    ds_read_b64_tr_b16 v[204:205], v5 offset:61440
    v_mfma_f32_16x16x32_bf16 v[92:95], v[212:215], a[180:183], v[92:95]
    s_cmp_eq_u32 s92, 0
    s_cselect_b32 s63, s65, s66
    v_mfma_f32_16x16x32_bf16 v[96:99], v[212:215], a[184:187], v[96:99]
    ds_read_b64_tr_b16 v[206:207], v5 offset:63488
    s_add_u32 m0, s35, 36864
    v_mfma_f32_16x16x32_bf16 v[100:103], v[212:215], a[188:191], v[100:103]
    buffer_load_dwordx4 v2, s[16:19], s63 offen lds
    s_waitcnt lgkmcnt(4)
    v_mfma_f32_16x16x32_bf16 v[72:75], v[216:219], a[192:195], v[72:75]
    ds_read_b64_tr_b16 v[208:209], v4 offset:0
    v_mfma_f32_16x16x32_bf16 v[76:79], v[216:219], a[196:199], v[76:79]
    s_cmp_eq_u32 s92, 0
    s_cselect_b32 s63, s67, s68
    v_mfma_f32_16x16x32_bf16 v[80:83], v[216:219], a[200:203], v[80:83]
    ds_read_b64_tr_b16 v[210:211], v4 offset:2048
    s_add_u32 m0, s35, 40960
    v_mfma_f32_16x16x32_bf16 v[84:87], v[216:219], a[204:207], v[84:87]
    buffer_load_dwordx4 v2, s[16:19], s63 offen lds
    v_mfma_f32_16x16x32_bf16 v[88:91], v[220:223], a[192:195], v[88:91]
    ds_read_b64_tr_b16 v[212:213], v6 offset:0
    s_add_u32 m0, s35, 45056
    v_mfma_f32_16x16x32_bf16 v[92:95], v[220:223], a[196:199], v[92:95]
    buffer_load_dwordx4 v36, s[16:19], s64 offen offset:0 lds
    v_mfma_f32_16x16x32_bf16 v[96:99], v[220:223], a[200:203], v[96:99]
    ds_read_b64_tr_b16 v[214:215], v6 offset:2048
    s_add_u32 m0, s35, 49152
    v_mfma_f32_16x16x32_bf16 v[100:103], v[220:223], a[204:207], v[100:103]
    buffer_load_dwordx4 v36, s[16:19], s69 offen offset:0 lds
    s_waitcnt lgkmcnt(4)
    v_mfma_f32_16x16x32_bf16 v[72:75], v[200:203], a[208:211], v[72:75]
    ds_read_b64_tr_b16 v[216:217], v4 offset:4096
    s_add_u32 m0, s35, 53248
    v_mfma_f32_16x16x32_bf16 v[76:79], v[200:203], a[212:215], v[76:79]
    buffer_load_dwordx4 v36, s[16:19], s70 offen offset:0 lds
    v_mfma_f32_16x16x32_bf16 v[80:83], v[200:203], a[216:219], v[80:83]
    ds_read_b64_tr_b16 v[218:219], v4 offset:6144
    v_mfma_f32_16x16x32_bf16 v[84:87], v[200:203], a[220:223], v[84:87]
    v_mfma_f32_16x16x32_bf16 v[88:91], v[204:207], a[208:211], v[88:91]
    ds_read_b64_tr_b16 v[220:221], v6 offset:4096
    v_mfma_f32_16x16x32_bf16 v[92:95], v[204:207], a[212:215], v[92:95]
    v_mfma_f32_16x16x32_bf16 v[96:99], v[204:207], a[216:219], v[96:99]
    ds_read_b64_tr_b16 v[222:223], v6 offset:6144
    v_mfma_f32_16x16x32_bf16 v[100:103], v[204:207], a[220:223], v[100:103]
    s_waitcnt lgkmcnt(4)
    v_mfma_f32_16x16x32_bf16 v[168:171], v[208:211], a[16:19], 0
    ds_read_b64_tr_b16 v[200:201], v4 offset:8192
    v_mfma_f32_16x16x32_bf16 v[172:175], v[208:211], a[20:23], 0
    v_mfma_f32_16x16x32_bf16 v[176:179], v[208:211], a[24:27], 0
    ds_read_b64_tr_b16 v[202:203], v4 offset:10240
    v_mfma_f32_16x16x32_bf16 v[180:183], v[208:211], a[28:31], 0
    v_mfma_f32_16x16x32_bf16 v[184:187], v[212:215], a[16:19], 0
    ds_read_b64_tr_b16 v[204:205], v6 offset:8192
    v_mfma_f32_16x16x32_bf16 v[188:191], v[212:215], a[20:23], 0
    v_mfma_f32_16x16x32_bf16 v[192:195], v[212:215], a[24:27], 0
    ds_read_b64_tr_b16 v[206:207], v6 offset:10240
    v_mfma_f32_16x16x32_bf16 v[196:199], v[212:215], a[28:31], 0
    s_waitcnt lgkmcnt(4)
    v_mfma_f32_16x16x32_bf16 v[168:171], v[216:219], a[32:35], v[168:171]
    ds_read_b64_tr_b16 v[208:209], v4 offset:12288
    v_mfma_f32_16x16x32_bf16 v[172:175], v[216:219], a[36:39], v[172:175]
    v_mfma_f32_16x16x32_bf16 v[176:179], v[216:219], a[40:43], v[176:179]
    ds_read_b64_tr_b16 v[210:211], v4 offset:14336
    v_mfma_f32_16x16x32_bf16 v[180:183], v[216:219], a[44:47], v[180:183]
    v_mfma_f32_16x16x32_bf16 v[184:187], v[220:223], a[32:35], v[184:187]
    ds_read_b64_tr_b16 v[212:213], v6 offset:12288
    v_mfma_f32_16x16x32_bf16 v[188:191], v[220:223], a[36:39], v[188:191]
    v_mfma_f32_16x16x32_bf16 v[192:195], v[220:223], a[40:43], v[192:195]
    ds_read_b64_tr_b16 v[214:215], v6 offset:14336
    v_mfma_f32_16x16x32_bf16 v[196:199], v[220:223], a[44:47], v[196:199]
    s_waitcnt lgkmcnt(4)
    v_mfma_f32_16x16x32_bf16 v[168:171], v[200:203], a[48:51], v[168:171]
    ds_read_b64_tr_b16 v[216:217], v4 offset:16384
    s_waitcnt vmcnt(12)
    v_mfma_f32_16x16x32_bf16 v[172:175], v[200:203], a[52:55], v[172:175]
    buffer_store_dword v14, off, s[20:23], s56 offset:48 sc1
    v_mfma_f32_16x16x32_bf16 v[176:179], v[200:203], a[56:59], v[176:179]
    ds_read_b64_tr_b16 v[218:219], v4 offset:18432
    v_mfma_f32_16x16x32_bf16 v[180:183], v[200:203], a[60:63], v[180:183]
    v_mfma_f32_16x16x32_bf16 v[184:187], v[204:207], a[48:51], v[184:187]
    ds_read_b64_tr_b16 v[220:221], v6 offset:16384
    v_mfma_f32_16x16x32_bf16 v[188:191], v[204:207], a[52:55], v[188:191]
    v_mfma_f32_16x16x32_bf16 v[192:195], v[204:207], a[56:59], v[192:195]
    ds_read_b64_tr_b16 v[222:223], v6 offset:18432
    v_mfma_f32_16x16x32_bf16 v[196:199], v[204:207], a[60:63], v[196:199]
    s_waitcnt vmcnt(9) lgkmcnt(4)
    s_barrier
    v_mfma_f32_16x16x32_bf16 v[168:171], v[208:211], a[64:67], v[168:171]
    ds_read_b64_tr_b16 v[200:201], v3 offset:0
    s_add_u32 m0, s35, 57216
    v_mfma_f32_16x16x32_bf16 v[172:175], v[208:211], a[68:71], v[172:175]
    buffer_load_dwordx4 v36, s[16:19], s64 offen offset:128 lds
    v_mfma_f32_16x16x32_bf16 v[176:179], v[208:211], a[72:75], v[176:179]
    ds_read_b64_tr_b16 v[202:203], v3 offset:2048
    s_add_u32 m0, s35, 61312
    v_mfma_f32_16x16x32_bf16 v[180:183], v[208:211], a[76:79], v[180:183]
    buffer_load_dwordx4 v36, s[16:19], s69 offen offset:128 lds
    v_mfma_f32_16x16x32_bf16 v[184:187], v[212:215], a[64:67], v[184:187]
    ds_read_b64_tr_b16 v[204:205], v5 offset:0
    s_add_u32 m0, s35, 65408
    v_mfma_f32_16x16x32_bf16 v[188:191], v[212:215], a[68:71], v[188:191]
    buffer_load_dwordx4 v36, s[16:19], s70 offen offset:128 lds
    v_mfma_f32_16x16x32_bf16 v[192:195], v[212:215], a[72:75], v[192:195]
    ds_read_b64_tr_b16 v[206:207], v5 offset:2048
    s_add_u32 m0, s35, 69376
    v_mfma_f32_16x16x32_bf16 v[196:199], v[212:215], a[76:79], v[196:199]
    buffer_load_dwordx4 v36, s[16:19], s64 offen offset:256 lds
    s_waitcnt lgkmcnt(4)
    v_mfma_f32_16x16x32_bf16 v[168:171], v[216:219], a[80:83], v[168:171]
    ds_read_b64_tr_b16 v[208:209], v3 offset:4096
    s_add_u32 m0, s35, 73472
    v_mfma_f32_16x16x32_bf16 v[172:175], v[216:219], a[84:87], v[172:175]
    buffer_load_dwordx4 v36, s[16:19], s69 offen offset:256 lds
    v_mfma_f32_16x16x32_bf16 v[176:179], v[216:219], a[88:91], v[176:179]
    ds_read_b64_tr_b16 v[210:211], v3 offset:6144
    s_add_u32 m0, s35, 77568
    v_mfma_f32_16x16x32_bf16 v[180:183], v[216:219], a[92:95], v[180:183]
    buffer_load_dwordx4 v36, s[16:19], s70 offen offset:256 lds
    v_mfma_f32_16x16x32_bf16 v[184:187], v[220:223], a[80:83], v[184:187]
    ds_read_b64_tr_b16 v[212:213], v5 offset:4096
    v_mfma_f32_16x16x32_bf16 v[188:191], v[220:223], a[84:87], v[188:191]
    v_mfma_f32_16x16x32_bf16 v[192:195], v[220:223], a[88:91], v[192:195]
    ds_read_b64_tr_b16 v[214:215], v5 offset:6144
    v_mfma_f32_16x16x32_bf16 v[196:199], v[220:223], a[92:95], v[196:199]
    s_waitcnt lgkmcnt(4)
    v_mfma_f32_16x16x32_bf16 v[168:171], v[200:203], a[96:99], v[168:171]
    ds_read_b64_tr_b16 v[216:217], v3 offset:8192
    buffer_load_dwordx2 v[38:39], off, s[20:23], s57 offset:48 sc1
    v_mfma_f32_16x16x32_bf16 v[172:175], v[200:203], a[100:103], v[172:175]
    v_mfma_f32_16x16x32_bf16 v[176:179], v[200:203], a[104:107], v[176:179]
    ds_read_b64_tr_b16 v[218:219], v3 offset:10240
    v_mfma_f32_16x16x32_bf16 v[180:183], v[200:203], a[108:111], v[180:183]
    v_mfma_f32_16x16x32_bf16 v[184:187], v[204:207], a[96:99], v[184:187]
    ds_read_b64_tr_b16 v[220:221], v5 offset:8192
    v_mfma_f32_16x16x32_bf16 v[188:191], v[204:207], a[100:103], v[188:191]
    v_mfma_f32_16x16x32_bf16 v[192:195], v[204:207], a[104:107], v[192:195]
    ds_read_b64_tr_b16 v[222:223], v5 offset:10240
    v_mfma_f32_16x16x32_bf16 v[196:199], v[204:207], a[108:111], v[196:199]
    s_waitcnt lgkmcnt(4)
    v_mfma_f32_16x16x32_bf16 v[168:171], v[208:211], a[0:3], v[168:171]
    ds_read_b64_tr_b16 v[200:201], v3 offset:12288
    v_mfma_f32_16x16x32_bf16 v[172:175], v[208:211], a[4:7], v[172:175]
    v_mfma_f32_16x16x32_bf16 v[176:179], v[208:211], a[8:11], v[176:179]
    ds_read_b64_tr_b16 v[202:203], v3 offset:14336
    v_mfma_f32_16x16x32_bf16 v[180:183], v[208:211], a[12:15], v[180:183]
    v_mfma_f32_16x16x32_bf16 v[184:187], v[212:215], a[0:3], v[184:187]
    ds_read_b64_tr_b16 v[204:205], v5 offset:12288
    v_mfma_f32_16x16x32_bf16 v[188:191], v[212:215], a[4:7], v[188:191]
    v_mfma_f32_16x16x32_bf16 v[192:195], v[212:215], a[8:11], v[192:195]
    ds_read_b64_tr_b16 v[206:207], v5 offset:14336
    v_mfma_f32_16x16x32_bf16 v[196:199], v[212:215], a[12:15], v[196:199]
    s_waitcnt lgkmcnt(4)
    v_mfma_f32_16x16x32_bf16 v[168:171], v[216:219], a[160:163], v[168:171]
    ds_read_b64_tr_b16 v[208:209], v3 offset:16384
    v_mfma_f32_16x16x32_bf16 v[172:175], v[216:219], a[164:167], v[172:175]
    v_mfma_f32_16x16x32_bf16 v[176:179], v[216:219], a[168:171], v[176:179]
    ds_read_b64_tr_b16 v[210:211], v3 offset:18432
    v_mfma_f32_16x16x32_bf16 v[180:183], v[216:219], a[172:175], v[180:183]
    v_mfma_f32_16x16x32_bf16 v[184:187], v[220:223], a[160:163], v[184:187]
    ds_read_b64_tr_b16 v[212:213], v5 offset:16384
    v_mfma_f32_16x16x32_bf16 v[188:191], v[220:223], a[164:167], v[188:191]
    v_mfma_f32_16x16x32_bf16 v[192:195], v[220:223], a[168:171], v[192:195]
    ds_read_b64_tr_b16 v[214:215], v5 offset:18432
    v_mfma_f32_16x16x32_bf16 v[196:199], v[220:223], a[172:175], v[196:199]
    s_waitcnt lgkmcnt(4)
    v_mfma_f32_16x16x32_bf16 v[168:171], v[200:203], a[176:179], v[168:171]
    ds_read_b64_tr_b16 v[216:217], v3 offset:20480
    v_mfma_f32_16x16x32_bf16 v[172:175], v[200:203], a[180:183], v[172:175]
    v_mfma_f32_16x16x32_bf16 v[176:179], v[200:203], a[184:187], v[176:179]
    ds_read_b64_tr_b16 v[218:219], v3 offset:22528
    v_mfma_f32_16x16x32_bf16 v[180:183], v[200:203], a[188:191], v[180:183]
    v_mfma_f32_16x16x32_bf16 v[184:187], v[204:207], a[176:179], v[184:187]
    ds_read_b64_tr_b16 v[220:221], v5 offset:20480
    v_mfma_f32_16x16x32_bf16 v[188:191], v[204:207], a[180:183], v[188:191]
    v_mfma_f32_16x16x32_bf16 v[192:195], v[204:207], a[184:187], v[192:195]
    ds_read_b64_tr_b16 v[222:223], v5 offset:22528
    v_mfma_f32_16x16x32_bf16 v[196:199], v[204:207], a[188:191], v[196:199]
    s_waitcnt vmcnt(10) lgkmcnt(4)
    s_barrier
    v_mfma_f32_16x16x32_bf16 v[168:171], v[208:211], a[192:195], v[168:171]
    ds_read_b64_tr_b16 v[200:201], v9 offset:24576
    v_mfma_f32_16x16x32_bf16 v[172:175], v[208:211], a[196:199], v[172:175]
    s_cmp_eq_u32 s92, 0
    s_cselect_b32 s63, s82, s64
    v_mfma_f32_16x16x32_bf16 v[176:179], v[208:211], a[200:203], v[176:179]
    ds_read_b64_tr_b16 v[202:203], v9 offset:25600
    s_add_u32 m0, s35, 81920
    v_mfma_f32_16x16x32_bf16 v[180:183], v[208:211], a[204:207], v[180:183]
    buffer_load_dwordx4 v2, s[16:19], s63 offen lds
    v_mfma_f32_16x16x32_bf16 v[184:187], v[212:215], a[192:195], v[184:187]
    ds_read_b64_tr_b16 v[204:205], v9 offset:26624
    v_mfma_f32_16x16x32_bf16 v[188:191], v[212:215], a[196:199], v[188:191]
    s_cmp_eq_u32 s92, 0
    s_cselect_b32 s63, s69, s70
    v_mfma_f32_16x16x32_bf16 v[192:195], v[212:215], a[200:203], v[192:195]
    ds_read_b64_tr_b16 v[206:207], v9 offset:27648
    s_add_u32 m0, s35, 0
    v_mfma_f32_16x16x32_bf16 v[196:199], v[212:215], a[204:207], v[196:199]
    buffer_load_dwordx4 v2, s[16:19], s63 offen lds
    s_waitcnt lgkmcnt(4)
    v_mfma_f32_16x16x32_bf16 v[168:171], v[216:219], a[208:211], v[168:171]
    ds_read_b64_tr_b16 v[208:209], v9 offset:28672
    s_add_u32 m0, s35, 4096
    v_mfma_f32_16x16x32_bf16 v[172:175], v[216:219], a[212:215], v[172:175]
    buffer_load_dwordx4 v36, s[16:19], s89 offen offset:0 lds
    v_mfma_f32_16x16x32_bf16 v[176:179], v[216:219], a[216:219], v[176:179]
    ds_read_b64_tr_b16 v[210:211], v9 offset:29696
    s_add_u32 m0, s35, 8192
    v_mfma_f32_16x16x32_bf16 v[180:183], v[216:219], a[220:223], v[180:183]
    buffer_load_dwordx4 v36, s[16:19], s90 offen offset:0 lds
    v_mfma_f32_16x16x32_bf16 v[184:187], v[220:223], a[208:211], v[184:187]
    ds_read_b64_tr_b16 v[212:213], v9 offset:30720
    s_add_u32 m0, s35, 12160
    v_mfma_f32_16x16x32_bf16 v[188:191], v[220:223], a[212:215], v[188:191]
    buffer_load_dwordx4 v36, s[16:19], s89 offen offset:128 lds
    v_mfma_f32_16x16x32_bf16 v[192:195], v[220:223], a[216:219], v[192:195]
    ds_read_b64_tr_b16 v[214:215], v9 offset:31744
    s_add_u32 m0, s35, 16256
    v_mfma_f32_16x16x32_bf16 v[196:199], v[220:223], a[220:223], v[196:199]
    buffer_load_dwordx4 v36, s[16:19], s90 offen offset:128 lds
    s_waitcnt lgkmcnt(4)
    v_mfma_f32_16x16x32_bf16 v[136:139], v[200:203], a[16:19], 0
    ds_read_b64_tr_b16 v[216:217], v9 offset:32768
    v_mfma_f32_16x16x32_bf16 v[140:143], v[200:203], a[20:23], 0
    v_mfma_f32_16x16x32_bf16 v[144:147], v[200:203], a[24:27], 0
    ds_read_b64_tr_b16 v[218:219], v9 offset:33792
    v_mfma_f32_16x16x32_bf16 v[148:151], v[200:203], a[28:31], 0
    v_mfma_f32_16x16x32_bf16 v[136:139], v[204:207], a[32:35], v[136:139]
    ds_read_b64_tr_b16 v[220:221], v9 offset:34816
    v_mfma_f32_16x16x32_bf16 v[140:143], v[204:207], a[36:39], v[140:143]
    v_mfma_f32_16x16x32_bf16 v[144:147], v[204:207], a[40:43], v[144:147]
    ds_read_b64_tr_b16 v[222:223], v9 offset:35840
    v_mfma_f32_16x16x32_bf16 v[148:151], v[204:207], a[44:47], v[148:151]
    s_waitcnt lgkmcnt(4)
    v_mfma_f32_16x16x32_bf16 v[136:139], v[208:211], a[48:51], v[136:139]
    ds_read_b64_tr_b16 v[200:201], v9 offset:36864
    v_mfma_f32_16x16x32_bf16 v[140:143], v[208:211], a[52:55], v[140:143]
    v_mfma_f32_16x16x32_bf16 v[144:147], v[208:211], a[56:59], v[144:147]
    ds_read_b64_tr_b16 v[202:203], v9 offset:37888
    v_mfma_f32_16x16x32_bf16 v[148:151], v[208:211], a[60:63], v[148:151]
    v_mfma_f32_16x16x32_bf16 v[136:139], v[212:215], a[64:67], v[136:139]
    ds_read_b64_tr_b16 v[204:205], v9 offset:38912
    v_mfma_f32_16x16x32_bf16 v[140:143], v[212:215], a[68:71], v[140:143]
    v_mfma_f32_16x16x32_bf16 v[144:147], v[212:215], a[72:75], v[144:147]
    ds_read_b64_tr_b16 v[206:207], v9 offset:39936
    v_mfma_f32_16x16x32_bf16 v[148:151], v[212:215], a[76:79], v[148:151]
    s_waitcnt lgkmcnt(4)
    v_mfma_f32_16x16x32_bf16 v[136:139], v[216:219], a[80:83], v[136:139]
    ds_read_b64_tr_b16 v[208:209], v9 offset:40960
    v_mfma_f32_16x16x32_bf16 v[140:143], v[216:219], a[84:87], v[140:143]
    v_mfma_f32_16x16x32_bf16 v[144:147], v[216:219], a[88:91], v[144:147]
    ds_read_b64_tr_b16 v[210:211], v9 offset:41984
    v_mfma_f32_16x16x32_bf16 v[148:151], v[216:219], a[92:95], v[148:151]
    v_mfma_f32_16x16x32_bf16 v[136:139], v[220:223], a[96:99], v[136:139]
    ds_read_b64_tr_b16 v[212:213], v9 offset:43008
    v_mfma_f32_16x16x32_bf16 v[140:143], v[220:223], a[100:103], v[140:143]
    v_mfma_f32_16x16x32_bf16 v[144:147], v[220:223], a[104:107], v[144:147]
    ds_read_b64_tr_b16 v[214:215], v9 offset:44032
    v_mfma_f32_16x16x32_bf16 v[148:151], v[220:223], a[108:111], v[148:151]
    s_waitcnt lgkmcnt(4)
    v_mfma_f32_16x16x32_bf16 v[136:139], v[200:203], a[160:163], v[136:139]
    ds_read_b64_tr_b16 v[216:217], v3 offset:45056
    v_mfma_f32_16x16x32_bf16 v[140:143], v[200:203], a[164:167], v[140:143]
    v_mfma_f32_16x16x32_bf16 v[144:147], v[200:203], a[168:171], v[144:147]
    ds_read_b64_tr_b16 v[218:219], v3 offset:47104
    v_mfma_f32_16x16x32_bf16 v[148:151], v[200:203], a[172:175], v[148:151]
    v_mfma_f32_16x16x32_bf16 v[136:139], v[204:207], a[176:179], v[136:139]
    ds_read_b64_tr_b16 v[220:221], v5 offset:45056
    v_mfma_f32_16x16x32_bf16 v[140:143], v[204:207], a[180:183], v[140:143]
    v_mfma_f32_16x16x32_bf16 v[144:147], v[204:207], a[184:187], v[144:147]
    ds_read_b64_tr_b16 v[222:223], v5 offset:47104
    v_mfma_f32_16x16x32_bf16 v[148:151], v[204:207], a[188:191], v[148:151]
    s_waitcnt vmcnt(9) lgkmcnt(4)
    s_barrier
    v_mfma_f32_16x16x32_bf16 v[136:139], v[208:211], a[192:195], v[136:139]
    ds_read_b64_tr_b16 v[200:201], v3 offset:49152
    s_add_u32 m0, s35, 20224
    v_mfma_f32_16x16x32_bf16 v[140:143], v[208:211], a[196:199], v[140:143]
    buffer_load_dwordx4 v36, s[16:19], s89 offen offset:256 lds
    s_waitcnt vmcnt(7)
    s_mov_b32 s60, 0
ffn_kernel_sp_77:
    v_min_u32 v38, v38, v39
    s_add_u32 s60, s60, 1
    v_readfirstlane_b32 s58, v38
    s_cmp_lg_u32 s58, 0
    s_cbranch_scc1 ffn_kernel_sp_77d
    s_cmp_ge_u32 s60, 0x8000
    s_cbranch_scc1 ffn_kernel_sp_77d
    buffer_load_dwordx2 v[38:39], off, s[20:23], s57 offset:48 sc1
    s_waitcnt vmcnt(0)
    s_branch ffn_kernel_sp_77
ffn_kernel_sp_77d:
    v_mfma_f32_16x16x32_bf16 v[144:147], v[208:211], a[200:203], v[144:147]
    ds_read_b64_tr_b16 v[202:203], v3 offset:51200
    s_add_u32 m0, s35, 24320
    v_mfma_f32_16x16x32_bf16 v[148:151], v[208:211], a[204:207], v[148:151]
    buffer_load_dwordx4 v36, s[16:19], s90 offen offset:256 lds
    v_mfma_f32_16x16x32_bf16 v[136:139], v[212:215], a[208:211], v[136:139]
    ds_read_b64_tr_b16 v[204:205], v5 offset:49152
    v_mfma_f32_16x16x32_bf16 v[140:143], v[212:215], a[212:215], v[140:143]
    s_cmp_eq_u32 s92, 0
    s_cselect_b32 s63, s89, s90
    v_mfma_f32_16x16x32_bf16 v[144:147], v[212:215], a[216:219], v[144:147]
    ds_read_b64_tr_b16 v[206:207], v5 offset:51200
    s_add_u32 m0, s35, 28672
    v_mfma_f32_16x16x32_bf16 v[148:151], v[212:215], a[220:223], v[148:151]
    buffer_load_dwordx4 v2, s[16:19], s63 offen lds
    s_waitcnt lgkmcnt(4)
    v_mfma_f32_16x16x32_bf16 v[40:43], v[216:219], a[144:147], v[40:43]
    ds_read_b64_tr_b16 v[208:209], v3 offset:53248
    s_add_u32 m0, s35, 32768
    v_mfma_f32_16x16x32_bf16 v[44:47], v[216:219], a[148:151], v[44:47]
    buffer_load_dwordx4 v36, s[16:19], s71 offen offset:0 lds
    s_mov_b32 s95, 57344
    v_mfma_f32_16x16x32_bf16 v[48:51], v[216:219], a[152:155], v[48:51]
    ds_read_b64_tr_b16 v[210:211], v3 offset:55296
    s_add_u32 m0, s35, 36864
    v_mfma_f32_16x16x32_bf16 v[52:55], v[216:219], a[156:159], v[52:55]
    buffer_load_dwordx4 v36, s[16:19], s72 offen offset:0 lds
    v_mfma_f32_16x16x32_bf16 v[56:59], v[220:223], a[144:147], v[56:59]
    ds_read_b64_tr_b16 v[212:213], v5 offset:53248
    s_add_u32 m0, s35, 40832
    v_mfma_f32_16x16x32_bf16 v[60:63], v[220:223], a[148:151], v[60:63]
    buffer_load_dwordx4 v36, s[16:19], s71 offen offset:128 lds
    v_mfma_f32_16x16x32_bf16 v[64:67], v[220:223], a[152:155], v[64:67]
    ds_read_b64_tr_b16 v[214:215], v5 offset:55296
    buffer_load_dwordx4 v[224:227], v14, s[28:31], s95 offen offset:0 sc1
    v_mfma_f32_16x16x32_bf16 v[68:71], v[220:223], a[156:159], v[68:71]
    buffer_load_dwordx4 v[228:231], v14, s[28:31], s95 offen offset:1024 sc1
    s_waitcnt lgkmcnt(4)
    v_mfma_f32_16x16x32_bf16 v[40:43], v[200:203], a[224:227], v[40:43]
    ds_read_b64_tr_b16 v[216:217], v3 offset:57344
    buffer_load_dwordx4 v[232:235], v14, s[28:31], s95 offen offset:2048 sc1
    v_mfma_f32_16x16x32_bf16 v[44:47], v[200:203], a[228:231], v[44:47]
    buffer_load_dwordx4 v[236:239], v14, s[28:31], s95 offen offset:3072 sc1
    s_mov_b32 s95, 65536
    v_mfma_f32_16x16x32_bf16 v[48:51], v[200:203], a[232:235], v[48:51]
    ds_read_b64_tr_b16 v[218:219], v3 offset:59392
    buffer_load_dwordx4 v[240:243], v14, s[28:31], s95 offen offset:0 sc1
    v_mfma_f32_16x16x32_bf16 v[52:55], v[200:203], a[236:239], v[52:55]
    buffer_load_dwordx4 v[244:247], v14, s[28:31], s95 offen offset:1024 sc1
    v_mfma_f32_16x16x32_bf16 v[56:59], v[204:207], a[224:227], v[56:59]
    ds_read_b64_tr_b16 v[220:221], v5 offset:57344
    buffer_load_dwordx4 v[248:251], v14, s[28:31], s95 offen offset:2048 sc1
    v_mfma_f32_16x16x32_bf16 v[60:63], v[204:207], a[228:231], v[60:63]
    buffer_load_dwordx4 v[252:255], v14, s[28:31], s95 offen offset:3072 sc1
    v_mfma_f32_16x16x32_bf16 v[64:67], v[204:207], a[232:235], v[64:67]
    ds_read_b64_tr_b16 v[222:223], v5 offset:59392
    v_mfma_f32_16x16x32_bf16 v[68:71], v[204:207], a[236:239], v[68:71]
    s_waitcnt lgkmcnt(4)
    v_mfma_f32_16x16x32_bf16 v[40:43], v[208:211], a[240:243], v[40:43]
    ds_read_b64_tr_b16 v[200:201], v3 offset:61440
    v_mfma_f32_16x16x32_bf16 v[44:47], v[208:211], a[244:247], v[44:47]
    v_mfma_f32_16x16x32_bf16 v[48:51], v[208:211], a[248:251], v[48:51]
    ds_read_b64_tr_b16 v[202:203], v3 offset:63488
    v_mfma_f32_16x16x32_bf16 v[52:55], v[208:211], a[252:255], v[52:55]
    v_mfma_f32_16x16x32_bf16 v[56:59], v[212:215], a[240:243], v[56:59]
    ds_read_b64_tr_b16 v[204:205], v5 offset:61440
    v_mfma_f32_16x16x32_bf16 v[60:63], v[212:215], a[244:247], v[60:63]
    v_mfma_f32_16x16x32_bf16 v[64:67], v[212:215], a[248:251], v[64:67]
    ds_read_b64_tr_b16 v[206:207], v5 offset:63488
    v_mfma_f32_16x16x32_bf16 v[68:71], v[212:215], a[252:255], v[68:71]
    s_waitcnt lgkmcnt(4)
    v_mfma_f32_16x16x32_bf16 v[72:75], v[216:219], a[144:147], v[72:75]
    ds_read_b64_tr_b16 v[208:209], v4 offset:0
    v_mfma_f32_16x16x32_bf16 v[76:79], v[216:219], a[148:151], v[76:79]
    v_mfma_f32_16x16x32_bf16 v[80:83], v[216:219], a[152:155], v[80:83]
    ds_read_b64_tr_b16 v[210:211], v4 offset:2048
    v_mfma_f32_16x16x32_bf16 v[84:87], v[216:219], a[156:159], v[84:87]
    v_mfma_f32_16x16x32_bf16 v[88:91], v[220:223], a[144:147], v[88:91]
    ds_read_b64_tr_b16 v[212:213], v6 offset:0
    v_mfma_f32_16x16x32_bf16 v[92:95], v[220:223], a[148:151], v[92:95]
    v_mfma_f32_16x16x32_bf16 v[96:99], v[220:223], a[152:155], v[96:99]
    ds_read_b64_tr_b16 v[214:215], v6 offset:2048
    v_mfma_f32_16x16x32_bf16 v[100:103], v[220:223], a[156:159], v[100:103]
    s_waitcnt lgkmcnt(4)
    v_mfma_f32_16x16x32_bf16 v[72:75], v[200:203], a[224:227], v[72:75]
    ds_read_b64_tr_b16 v[216:217], v4 offset:4096
    v_mfma_f32_16x16x32_bf16 v[76:79], v[200:203], a[228:231], v[76:79]
    v_mfma_f32_16x16x32_bf16 v[80:83], v[200:203], a[232:235], v[80:83]
    ds_read_b64_tr_b16 v[218:219], v4 offset:6144
    v_mfma_f32_16x16x32_bf16 v[84:87], v[200:203], a[236:239], v[84:87]
    v_mfma_f32_16x16x32_bf16 v[88:91], v[204:207], a[224:227], v[88:91]
    ds_read_b64_tr_b16 v[220:221], v6 offset:4096
    v_mfma_f32_16x16x32_bf16 v[92:95], v[204:207], a[228:231], v[92:95]
    v_mfma_f32_16x16x32_bf16 v[96:99], v[204:207], a[232:235], v[96:99]
    ds_read_b64_tr_b16 v[222:223], v6 offset:6144
    v_mfma_f32_16x16x32_bf16 v[100:103], v[204:207], a[236:239], v[100:103]
    s_waitcnt vmcnt(16) lgkmcnt(4)
    s_barrier
    v_mfma_f32_16x16x32_bf16 v[72:75], v[208:211], a[240:243], v[72:75]
    ds_read_b64_tr_b16 v[200:201], v4 offset:8192
    s_add_u32 m0, s35, 44928
    v_mfma_f32_16x16x32_bf16 v[76:79], v[208:211], a[244:247], v[76:79]
    buffer_load_dwordx4 v36, s[16:19], s72 offen offset:128 lds
    v_mfma_f32_16x16x32_bf16 v[80:83], v[208:211], a[248:251], v[80:83]
    ds_read_b64_tr_b16 v[202:203], v4 offset:10240
    s_add_u32 m0, s35, 48896
    v_mfma_f32_16x16x32_bf16 v[84:87], v[208:211], a[252:255], v[84:87]
    buffer_load_dwordx4 v36, s[16:19], s71 offen offset:256 lds
    v_mfma_f32_16x16x32_bf16 v[88:91], v[212:215], a[240:243], v[88:91]
    ds_read_b64_tr_b16 v[204:205], v6 offset:8192
    s_add_u32 m0, s35, 52992
    v_mfma_f32_16x16x32_bf16 v[92:95], v[212:215], a[244:247], v[92:95]
    buffer_load_dwordx4 v36, s[16:19], s72 offen offset:256 lds
    v_mfma_f32_16x16x32_bf16 v[96:99], v[212:215], a[248:251], v[96:99]
    ds_read_b64_tr_b16 v[206:207], v6 offset:10240
    v_mfma_f32_16x16x32_bf16 v[100:103], v[212:215], a[252:255], v[100:103]
    s_cmp_eq_u32 s92, 0
    s_cselect_b32 s63, s71, s72
    s_waitcnt lgkmcnt(4)
    v_mfma_f32_16x16x32_bf16 v[168:171], v[216:219], a[144:147], v[168:171]
    ds_read_b64_tr_b16 v[208:209], v4 offset:12288
    s_add_u32 m0, s35, 57344
    v_mfma_f32_16x16x32_bf16 v[172:175], v[216:219], a[148:151], v[172:175]
    buffer_load_dwordx4 v2, s[16:19], s63 offen lds
    v_mfma_f32_16x16x32_bf16 v[176:179], v[216:219], a[152:155], v[176:179]
    ds_read_b64_tr_b16 v[210:211], v4 offset:14336
    s_add_u32 m0, s35, 61056
    v_mfma_f32_16x16x32_bf16 v[180:183], v[216:219], a[156:159], v[180:183]
    buffer_load_dwordx4 v36, s[16:19], s82 offen offset:384 lds
    v_mfma_f32_16x16x32_bf16 v[184:187], v[220:223], a[144:147], v[184:187]
    ds_read_b64_tr_b16 v[212:213], v6 offset:12288
    s_add_u32 m0, s35, 65152
    v_mfma_f32_16x16x32_bf16 v[188:191], v[220:223], a[148:151], v[188:191]
    buffer_load_dwordx4 v36, s[16:19], s83 offen offset:384 lds
    v_mfma_f32_16x16x32_bf16 v[192:195], v[220:223], a[152:155], v[192:195]
    ds_read_b64_tr_b16 v[214:215], v6 offset:14336
    v_mfma_f32_16x16x32_bf16 v[196:199], v[220:223], a[156:159], v[196:199]
    s_waitcnt lgkmcnt(4)
    v_mfma_f32_16x16x32_bf16 v[168:171], v[200:203], a[224:227], v[168:171]
    ds_read_b64_tr_b16 v[216:217], v10 offset:16384
    v_mfma_f32_16x16x32_bf16 v[172:175], v[200:203], a[228:231], v[172:175]
    v_mfma_f32_16x16x32_bf16 v[176:179], v[200:203], a[232:235], v[176:179]
    ds_read_b64_tr_b16 v[218:219], v10 offset:17408
    v_mfma_f32_16x16x32_bf16 v[180:183], v[200:203], a[236:239], v[180:183]
    v_mfma_f32_16x16x32_bf16 v[184:187], v[204:207], a[224:227], v[184:187]
    ds_read_b64_tr_b16 v[220:221], v10 offset:18432
    v_mfma_f32_16x16x32_bf16 v[188:191], v[204:207], a[228:231], v[188:191]
    v_mfma_f32_16x16x32_bf16 v[192:195], v[204:207], a[232:235], v[192:195]
    ds_read_b64_tr_b16 v[222:223], v10 offset:19456
    v_mfma_f32_16x16x32_bf16 v[196:199], v[204:207], a[236:239], v[196:199]
    s_waitcnt lgkmcnt(4)
    v_mfma_f32_16x16x32_bf16 v[168:171], v[208:211], a[240:243], v[168:171]
    ds_read_b64_tr_b16 v[200:201], v9 offset:0
    v_mfma_f32_16x16x32_bf16 v[172:175], v[208:211], a[244:247], v[172:175]
    v_mfma_f32_16x16x32_bf16 v[176:179], v[208:211], a[248:251], v[176:179]
    ds_read_b64_tr_b16 v[202:203], v9 offset:1024
    v_mfma_f32_16x16x32_bf16 v[180:183], v[208:211], a[252:255], v[180:183]
    v_mfma_f32_16x16x32_bf16 v[184:187], v[212:215], a[240:243], v[184:187]
    ds_read_b64_tr_b16 v[204:205], v9 offset:2048
    v_mfma_f32_16x16x32_bf16 v[188:191], v[212:215], a[244:247], v[188:191]
    v_mfma_f32_16x16x32_bf16 v[192:195], v[212:215], a[248:251], v[192:195]
    ds_read_b64_tr_b16 v[206:207], v9 offset:3072
    v_mfma_f32_16x16x32_bf16 v[196:199], v[212:215], a[252:255], v[196:199]
    s_waitcnt lgkmcnt(4)
    v_mfma_f32_16x16x32_bf16 v[136:139], v[216:219], a[0:3], v[136:139]
    ds_read_b64_tr_b16 v[208:209], v3 offset:4096
    v_mfma_f32_16x16x32_bf16 v[140:143], v[216:219], a[4:7], v[140:143]
    v_mfma_f32_16x16x32_bf16 v[144:147], v[216:219], a[8:11], v[144:147]
    ds_read_b64_tr_b16 v[210:211], v3 offset:6144
    v_mfma_f32_16x16x32_bf16 v[148:151], v[216:219], a[12:15], v[148:151]
    v_mfma_f32_16x16x32_bf16 v[136:139], v[220:223], a[144:147], v[136:139]
    ds_read_b64_tr_b16 v[212:213], v5 offset:4096
    v_mfma_f32_16x16x32_bf16 v[140:143], v[220:223], a[148:151], v[140:143]
    v_mfma_f32_16x16x32_bf16 v[144:147], v[220:223], a[152:155], v[144:147]
    ds_read_b64_tr_b16 v[214:215], v5 offset:6144
    v_mfma_f32_16x16x32_bf16 v[148:151], v[220:223], a[156:159], v[148:151]
    s_waitcnt lgkmcnt(4)
    v_mfma_f32_16x16x32_bf16 v[136:139], v[200:203], a[224:227], v[136:139]
    ds_read_b64_tr_b16 v[216:217], v3 offset:8192
    v_mfma_f32_16x16x32_bf16 v[140:143], v[200:203], a[228:231], v[140:143]
    v_mfma_f32_16x16x32_bf16 v[144:147], v[200:203], a[232:235], v[144:147]
    ds_read_b64_tr_b16 v[218:219], v3 offset:10240
    v_mfma_f32_16x16x32_bf16 v[148:151], v[200:203], a[236:239], v[148:151]
    v_mfma_f32_16x16x32_bf16 v[136:139], v[204:207], a[240:243], v[136:139]
    ds_read_b64_tr_b16 v[220:221], v5 offset:8192
    v_mfma_f32_16x16x32_bf16 v[140:143], v[204:207], a[244:247], v[140:143]
    v_mfma_f32_16x16x32_bf16 v[144:147], v[204:207], a[248:251], v[144:147]
    ds_read_b64_tr_b16 v[222:223], v5 offset:10240
    v_mfma_f32_16x16x32_bf16 v[148:151], v[204:207], a[252:255], v[148:151]
    s_waitcnt vmcnt(16) lgkmcnt(4)
    s_barrier
    v_mfma_f32_16x16x32_bf16 v[40:43], v[208:211], a[112:115], v[40:43]
    ds_read_b64_tr_b16 v[200:201], v3 offset:12288
    s_add_u32 m0, s35, 69248
    v_mfma_f32_16x16x32_bf16 v[44:47], v[208:211], a[116:119], v[44:47]
    buffer_load_dwordx4 v36, s[16:19], s84 offen offset:384 lds
    v_mfma_f32_16x16x32_bf16 v[48:51], v[208:211], a[120:123], v[48:51]
    ds_read_b64_tr_b16 v[202:203], v3 offset:14336
    s_add_u32 m0, s35, 73344
    v_mfma_f32_16x16x32_bf16 v[52:55], v[208:211], a[124:127], v[52:55]
    buffer_load_dwordx4 v36, s[16:19], s85 offen offset:384 lds
    v_mfma_f32_16x16x32_bf16 v[56:59], v[212:215], a[112:115], v[56:59]
    ds_read_b64_tr_b16 v[204:205], v5 offset:12288
    s_add_u32 m0, s35, 77440
    v_mfma_f32_16x16x32_bf16 v[60:63], v[212:215], a[116:119], v[60:63]
    buffer_load_dwordx4 v36, s[16:19], s86 offen offset:384 lds
    v_mfma_f32_16x16x32_bf16 v[64:67], v[212:215], a[120:123], v[64:67]
    ds_read_b64_tr_b16 v[206:207], v5 offset:14336
    s_add_u32 m0, s35, 81536
    v_mfma_f32_16x16x32_bf16 v[68:71], v[212:215], a[124:127], v[68:71]
    buffer_load_dwordx4 v36, s[16:19], s87 offen offset:384 lds
    s_waitcnt lgkmcnt(4)
    v_mfma_f32_16x16x32_bf16 v[40:43], v[216:219], a[128:131], v[40:43]
    ds_read_b64_tr_b16 v[208:209], v3 offset:16384
    s_sub_u32 m0, s35, 384
    v_mfma_f32_16x16x32_bf16 v[44:47], v[216:219], a[132:135], v[44:47]
    buffer_load_dwordx4 v36, s[16:19], s88 offen offset:384 lds
    v_mfma_f32_16x16x32_bf16 v[48:51], v[216:219], a[136:139], v[48:51]
    ds_read_b64_tr_b16 v[210:211], v3 offset:18432
    s_add_u32 m0, s35, 3712
    v_mfma_f32_16x16x32_bf16 v[52:55], v[216:219], a[140:143], v[52:55]
    buffer_load_dwordx4 v36, s[16:19], s89 offen offset:384 lds
    v_mfma_f32_16x16x32_bf16 v[56:59], v[220:223], a[128:131], v[56:59]
    ds_read_b64_tr_b16 v[212:213], v5 offset:16384
    v_mfma_f32_16x16x32_bf16 v[60:63], v[220:223], a[132:135], v[60:63]
    v_mfma_f32_16x16x32_bf16 v[64:67], v[220:223], a[136:139], v[64:67]
    ds_read_b64_tr_b16 v[214:215], v5 offset:18432
    v_mfma_f32_16x16x32_bf16 v[68:71], v[220:223], a[140:143], v[68:71]
    s_waitcnt lgkmcnt(4)
    v_mfma_f32_16x16x32_bf16 v[72:75], v[200:203], a[112:115], v[72:75]
    ds_read_b64_tr_b16 v[216:217], v3 offset:20480
    v_mfma_f32_16x16x32_bf16 v[76:79], v[200:203], a[116:119], v[76:79]
    v_mfma_f32_16x16x32_bf16 v[80:83], v[200:203], a[120:123], v[80:83]
    ds_read_b64_tr_b16 v[218:219], v3 offset:22528
    v_mfma_f32_16x16x32_bf16 v[84:87], v[200:203], a[124:127], v[84:87]
    v_mfma_f32_16x16x32_bf16 v[88:91], v[204:207], a[112:115], v[88:91]
    ds_read_b64_tr_b16 v[220:221], v5 offset:20480
    v_mfma_f32_16x16x32_bf16 v[92:95], v[204:207], a[116:119], v[92:95]
    v_mfma_f32_16x16x32_bf16 v[96:99], v[204:207], a[120:123], v[96:99]
    ds_read_b64_tr_b16 v[222:223], v5 offset:22528
    v_mfma_f32_16x16x32_bf16 v[100:103], v[204:207], a[124:127], v[100:103]
    s_waitcnt lgkmcnt(4)
    v_mfma_f32_16x16x32_bf16 v[72:75], v[208:211], a[128:131], v[72:75]
    ds_read_b64_tr_b16 v[200:201], v3 offset:24576
    v_mfma_f32_16x16x32_bf16 v[76:79], v[208:211], a[132:135], v[76:79]
    v_mfma_f32_16x16x32_bf16 v[80:83], v[208:211], a[136:139], v[80:83]
    ds_read_b64_tr_b16 v[202:203], v3 offset:26624
    v_mfma_f32_16x16x32_bf16 v[84:87], v[208:211], a[140:143], v[84:87]
    v_mfma_f32_16x16x32_bf16 v[88:91], v[212:215], a[128:131], v[88:91]
    ds_read_b64_tr_b16 v[204:205], v5 offset:24576
    v_mfma_f32_16x16x32_bf16 v[92:95], v[212:215], a[132:135], v[92:95]
    v_mfma_f32_16x16x32_bf16 v[96:99], v[212:215], a[136:139], v[96:99]
    ds_read_b64_tr_b16 v[206:207], v5 offset:26624
    v_mfma_f32_16x16x32_bf16 v[100:103], v[212:215], a[140:143], v[100:103]
    s_waitcnt lgkmcnt(4)
    v_mfma_f32_16x16x32_bf16 v[168:171], v[216:219], a[112:115], v[168:171]
    ds_read_b64_tr_b16 v[208:209], v9 offset:28672
    v_mfma_f32_16x16x32_bf16 v[172:175], v[216:219], a[116:119], v[172:175]
    v_mfma_f32_16x16x32_bf16 v[176:179], v[216:219], a[120:123], v[176:179]
    ds_read_b64_tr_b16 v[210:211], v9 offset:29696
    v_mfma_f32_16x16x32_bf16 v[180:183], v[216:219], a[124:127], v[180:183]
    v_mfma_f32_16x16x32_bf16 v[184:187], v[220:223], a[112:115], v[184:187]
    ds_read_b64_tr_b16 v[212:213], v9 offset:30720
    v_mfma_f32_16x16x32_bf16 v[188:191], v[220:223], a[116:119], v[188:191]
    v_mfma_f32_16x16x32_bf16 v[192:195], v[220:223], a[120:123], v[192:195]
    ds_read_b64_tr_b16 v[214:215], v9 offset:31744
    v_mfma_f32_16x16x32_bf16 v[196:199], v[220:223], a[124:127], v[196:199]
    s_waitcnt lgkmcnt(4)
    v_mfma_f32_16x16x32_bf16 v[168:171], v[200:203], a[128:131], v[168:171]
    ds_read_b64_tr_b16 v[216:217], v3 offset:32768
    v_mfma_f32_16x16x32_bf16 v[172:175], v[200:203], a[132:135], v[172:175]
    v_mfma_f32_16x16x32_bf16 v[176:179], v[200:203], a[136:139], v[176:179]
    ds_read_b64_tr_b16 v[218:219], v3 offset:34816
    v_mfma_f32_16x16x32_bf16 v[180:183], v[200:203], a[140:143], v[180:183]
    v_mfma_f32_16x16x32_bf16 v[184:187], v[204:207], a[128:131], v[184:187]
    ds_read_b64_tr_b16 v[220:221], v5 offset:32768
    v_mfma_f32_16x16x32_bf16 v[188:191], v[204:207], a[132:135], v[188:191]
    v_mfma_f32_16x16x32_bf16 v[192:195], v[204:207], a[136:139], v[192:195]
    ds_read_b64_tr_b16 v[222:223], v5 offset:34816
    v_mfma_f32_16x16x32_bf16 v[196:199], v[204:207], a[140:143], v[196:199]
    s_waitcnt vmcnt(8) lgkmcnt(4)
    s_barrier
    v_mfma_f32_16x16x32_bf16 v[136:139], v[208:211], a[112:115], v[136:139]
    ds_read_b64_tr_b16 v[200:201], v3 offset:36864
    s_add_u32 m0, s35, 7808
    v_mfma_f32_16x16x32_bf16 v[140:143], v[208:211], a[116:119], v[140:143]
    buffer_load_dwordx4 v36, s[16:19], s90 offen offset:384 lds
    v_mfma_f32_16x16x32_bf16 v[144:147], v[208:211], a[120:123], v[144:147]
    ds_read_b64_tr_b16 v[202:203], v3 offset:38912
    s_add_u32 m0, s35, 11904
    v_mfma_f32_16x16x32_bf16 v[148:151], v[208:211], a[124:127], v[148:151]
    buffer_load_dwordx4 v36, s[16:19], s64 offen offset:384 lds
    v_mfma_f32_16x16x32_bf16 v[136:139], v[212:215], a[128:131], v[136:139]
    ds_read_b64_tr_b16 v[204:205], v5 offset:36864
    s_add_u32 m0, s35, 16000
    v_mfma_f32_16x16x32_bf16 v[140:143], v[212:215], a[132:135], v[140:143]
    buffer_load_dwordx4 v36, s[16:19], s65 offen offset:384 lds
    v_mfma_f32_16x16x32_bf16 v[144:147], v[212:215], a[136:139], v[144:147]
    ds_read_b64_tr_b16 v[206:207], v5 offset:38912
    s_add_u32 m0, s35, 20096
    v_mfma_f32_16x16x32_bf16 v[148:151], v[212:215], a[140:143], v[148:151]
    buffer_load_dwordx4 v36, s[16:19], s66 offen offset:384 lds
    s_waitcnt lgkmcnt(4)
    v_mfma_f32_16x16x32_bf16 v[40:43], v[216:219], v[224:227], v[40:43]
    ds_read_b64_tr_b16 v[208:209], v3 offset:40960
    s_add_u32 m0, s35, 24192
    v_mfma_f32_16x16x32_bf16 v[44:47], v[216:219], v[228:231], v[44:47]
    buffer_load_dwordx4 v36, s[16:19], s67 offen offset:384 lds
    v_mfma_f32_16x16x32_bf16 v[48:51], v[216:219], v[232:235], v[48:51]
    ds_read_b64_tr_b16 v[210:211], v3 offset:43008
    s_add_u32 m0, s35, 28288
    v_mfma_f32_16x16x32_bf16 v[52:55], v[216:219], v[236:239], v[52:55]
    buffer_load_dwordx4 v36, s[16:19], s68 offen offset:384 lds
    v_mfma_f32_16x16x32_bf16 v[56:59], v[220:223], v[224:227], v[56:59]
    ds_read_b64_tr_b16 v[212:213], v5 offset:40960
    v_mfma_f32_16x16x32_bf16 v[60:63], v[220:223], v[228:231], v[60:63]
    v_mfma_f32_16x16x32_bf16 v[64:67], v[220:223], v[232:235], v[64:67]
    ds_read_b64_tr_b16 v[214:215], v5 offset:43008
    v_mfma_f32_16x16x32_bf16 v[68:71], v[220:223], v[236:239], v[68:71]
    s_waitcnt lgkmcnt(4)
    v_mfma_f32_16x16x32_bf16 v[40:43], v[200:203], v[240:243], v[40:43]
    ds_read_b64_tr_b16 v[216:217], v3 offset:45056
    v_mfma_f32_16x16x32_bf16 v[44:47], v[200:203], v[244:247], v[44:47]
    v_mfma_f32_16x16x32_bf16 v[48:51], v[200:203], v[248:251], v[48:51]
    ds_read_b64_tr_b16 v[218:219], v3 offset:47104
    v_mfma_f32_16x16x32_bf16 v[52:55], v[200:203], v[252:255], v[52:55]
    v_mfma_f32_16x16x32_bf16 v[56:59], v[204:207], v[240:243], v[56:59]
    ds_read_b64_tr_b16 v[220:221], v5 offset:45056
    v_mfma_f32_16x16x32_bf16 v[60:63], v[204:207], v[244:247], v[60:63]
    v_mfma_f32_16x16x32_bf16 v[64:67], v[204:207], v[248:251], v[64:67]
    ds_read_b64_tr_b16 v[222:223], v5 offset:47104
    v_mfma_f32_16x16x32_bf16 v[68:71], v[204:207], v[252:255], v[68:71]
    s_waitcnt lgkmcnt(4)
    v_mfma_f32_16x16x32_bf16 v[72:75], v[208:211], v[224:227], v[72:75]
    ds_read_b64_tr_b16 v[200:201], v3 offset:49152
    v_mfma_f32_16x16x32_bf16 v[76:79], v[208:211], v[228:231], v[76:79]
    v_mfma_f32_16x16x32_bf16 v[80:83], v[208:211], v[232:235], v[80:83]
    ds_read_b64_tr_b16 v[202:203], v3 offset:51200
    v_mfma_f32_16x16x32_bf16 v[84:87], v[208:211], v[236:239], v[84:87]
    v_mfma_f32_16x16x32_bf16 v[88:91], v[212:215], v[224:227], v[88:91]
    ds_read_b64_tr_b16 v[204:205], v5 offset:49152
    v_mfma_f32_16x16x32_bf16 v[92:95], v[212:215], v[228:231], v[92:95]
    v_mfma_f32_16x16x32_bf16 v[96:99], v[212:215], v[232:235], v[96:99]
    ds_read_b64_tr_b16 v[206:207], v5 offset:51200
    v_mfma_f32_16x16x32_bf16 v[100:103], v[212:215], v[236:239], v[100:103]
    s_waitcnt lgkmcnt(4)
    v_mfma_f32_16x16x32_bf16 v[72:75], v[216:219], v[240:243], v[72:75]
    ds_read_b64_tr_b16 v[208:209], v3 offset:53248
    v_cvt_pk_bf16_f32 v20, v40, v41
    v_mfma_f32_16x16x32_bf16 v[76:79], v[216:219], v[244:247], v[76:79]
    v_cvt_pk_bf16_f32 v21, v42, v43
    v_cvt_pk_bf16_f32 v22, v56, v57
    v_mfma_f32_16x16x32_bf16 v[80:83], v[216:219], v[248:251], v[80:83]
    ds_read_b64_tr_b16 v[210:211], v3 offset:55296
    v_cvt_pk_bf16_f32 v23, v58, v59
    v_mfma_f32_16x16x32_bf16 v[84:87], v[216:219], v[252:255], v[84:87]
    v_cvt_pk_bf16_f32 v24, v44, v45
    v_cvt_pk_bf16_f32 v25, v46, v47
    v_mfma_f32_16x16x32_bf16 v[88:91], v[220:223], v[240:243], v[88:91]
    ds_read_b64_tr_b16 v[212:213], v5 offset:53248
    v_cvt_pk_bf16_f32 v26, v60, v61
    v_mfma_f32_16x16x32_bf16 v[92:95], v[220:223], v[244:247], v[92:95]
    v_cvt_pk_bf16_f32 v27, v62, v63
    v_cvt_pk_bf16_f32 v28, v48, v49
    v_mfma_f32_16x16x32_bf16 v[96:99], v[220:223], v[248:251], v[96:99]
    ds_read_b64_tr_b16 v[214:215], v5 offset:55296
    v_cvt_pk_bf16_f32 v29, v50, v51
    v_mfma_f32_16x16x32_bf16 v[100:103], v[220:223], v[252:255], v[100:103]
    v_cvt_pk_bf16_f32 v30, v64, v65
    s_waitcnt lgkmcnt(4)
    v_mfma_f32_16x16x32_bf16 v[168:171], v[200:203], v[224:227], v[168:171]
    ds_read_b64_tr_b16 v[216:217], v9 offset:57344
    v_cvt_pk_bf16_f32 v31, v66, v67
    v_mfma_f32_16x16x32_bf16 v[172:175], v[200:203], v[228:231], v[172:175]
    v_cvt_pk_bf16_f32 v32, v52, v53
    v_cvt_pk_bf16_f32 v33, v54, v55
    v_mfma_f32_16x16x32_bf16 v[176:179], v[200:203], v[232:235], v[176:179]
    ds_read_b64_tr_b16 v[218:219], v9 offset:58368
    v_cvt_pk_bf16_f32 v34, v68, v69
    v_mfma_f32_16x16x32_bf16 v[180:183], v[200:203], v[236:239], v[180:183]
    v_cvt_pk_bf16_f32 v35, v70, v71
    s_add_u32 s62, s94, 0
    v_mfma_f32_16x16x32_bf16 v[184:187], v[204:207], v[224:227], v[184:187]
    ds_read_b64_tr_b16 v[220:221], v9 offset:59392
    s_nop 0
    v_mfma_f32_16x16x32_bf16 v[188:191], v[204:207], v[228:231], v[188:191]
    v_permlane16_swap_b32 v20, v22
    v_permlane16_swap_b32 v21, v23
    v_mfma_f32_16x16x32_bf16 v[192:195], v[204:207], v[232:235], v[192:195]
    ds_read_b64_tr_b16 v[222:223], v9 offset:60416
    v_permlane16_swap_b32 v24, v26
    v_mfma_f32_16x16x32_bf16 v[196:199], v[204:207], v[236:239], v[196:199]
    s_waitcnt vmcnt(8) lgkmcnt(4)
    s_barrier
    v_mfma_f32_16x16x32_bf16 v[168:171], v[208:211], v[240:243], v[168:171]
    ds_read_b64_tr_b16 v[200:201], v3 offset:61440
    s_add_u32 m0, s35, 32384
    v_mfma_f32_16x16x32_bf16 v[172:175], v[208:211], v[244:247], v[172:175]
    buffer_load_dwordx4 v36, s[16:19], s69 offen offset:384 lds
    v_permlane16_swap_b32 v25, v27
    v_mfma_f32_16x16x32_bf16 v[176:179], v[208:211], v[248:251], v[176:179]
    ds_read_b64_tr_b16 v[202:203], v3 offset:63488
    s_add_u32 m0, s35, 36480
    v_mfma_f32_16x16x32_bf16 v[180:183], v[208:211], v[252:255], v[180:183]
    buffer_load_dwordx4 v36, s[16:19], s70 offen offset:384 lds
    v_permlane16_swap_b32 v28, v30
    v_mfma_f32_16x16x32_bf16 v[184:187], v[212:215], v[240:243], v[184:187]
    ds_read_b64_tr_b16 v[204:205], v5 offset:61440
    s_add_u32 m0, s35, 40576
    v_mfma_f32_16x16x32_bf16 v[188:191], v[212:215], v[244:247], v[188:191]
    buffer_load_dwordx4 v36, s[16:19], s71 offen offset:384 lds
    v_permlane16_swap_b32 v29, v31
    v_mfma_f32_16x16x32_bf16 v[192:195], v[212:215], v[248:251], v[192:195]
    ds_read_b64_tr_b16 v[206:207], v5 offset:63488
    s_add_u32 m0, s35, 44672
    v_mfma_f32_16x16x32_bf16 v[196:199], v[212:215], v[252:255], v[196:199]
    buffer_load_dwordx4 v36, s[16:19], s72 offen offset:384 lds
    s_waitcnt lgkmcnt(4)
    v_mfma_f32_16x16x32_bf16 v[136:139], v[216:219], v[224:227], v[136:139]
    ds_read_b64_tr_b16 v[208:209], v4 offset:0
    v_permlane16_swap_b32 v32, v34
    v_mfma_f32_16x16x32_bf16 v[140:143], v[216:219], v[228:231], v[140:143]
    v_permlane16_swap_b32 v33, v35
    buffer_store_dwordx4 v[20:23], v8, s[24:27], s62 offen offset:0 sc1
    v_mfma_f32_16x16x32_bf16 v[144:147], v[216:219], v[232:235], v[144:147]
    ds_read_b64_tr_b16 v[210:211], v4 offset:2048
    v_mfma_f32_16x16x32_bf16 v[148:151], v[216:219], v[236:239], v[148:151]
    v_mfma_f32_16x16x32_bf16 v[136:139], v[220:223], v[240:243], v[136:139]
    ds_read_b64_tr_b16 v[212:213], v6 offset:0
    v_mfma_f32_16x16x32_bf16 v[140:143], v[220:223], v[244:247], v[140:143]
    v_mfma_f32_16x16x32_bf16 v[144:147], v[220:223], v[248:251], v[144:147]
    ds_read_b64_tr_b16 v[214:215], v6 offset:2048
    v_mfma_f32_16x16x32_bf16 v[148:151], v[220:223], v[252:255], v[148:151]
    s_waitcnt lgkmcnt(4)
    v_mfma_f32_16x16x32_bf16 v[104:107], v[200:203], a[0:3], 0
    ds_read_b64_tr_b16 v[216:217], v4 offset:4096
    buffer_store_dwordx4 v[24:27], v8, s[24:27], s62 offen offset:1024 sc1
    v_mfma_f32_16x16x32_bf16 v[108:111], v[200:203], a[4:7], 0
    v_mfma_f32_16x16x32_bf16 v[112:115], v[200:203], a[8:11], 0
    ds_read_b64_tr_b16 v[218:219], v4 offset:6144
    v_mfma_f32_16x16x32_bf16 v[116:119], v[200:203], a[12:15], 0
    v_mfma_f32_16x16x32_bf16 v[120:123], v[204:207], a[0:3], 0
    ds_read_b64_tr_b16 v[220:221], v6 offset:4096
    v_mfma_f32_16x16x32_bf16 v[124:127], v[204:207], a[4:7], 0
    v_mfma_f32_16x16x32_bf16 v[128:131], v[204:207], a[8:11], 0
    ds_read_b64_tr_b16 v[222:223], v6 offset:6144
    v_mfma_f32_16x16x32_bf16 v[132:135], v[204:207], a[12:15], 0
    s_waitcnt lgkmcnt(4)
    v_mfma_f32_16x16x32_bf16 v[104:107], v[208:211], a[16:19], v[104:107]
    ds_read_b64_tr_b16 v[200:201], v4 offset:8192
    buffer_store_dwordx4 v[28:31], v8, s[24:27], s62 offen offset:2048 sc1
    v_mfma_f32_16x16x32_bf16 v[108:111], v[208:211], a[20:23], v[108:111]
    v_mfma_f32_16x16x32_bf16 v[112:115], v[208:211], a[24:27], v[112:115]
    ds_read_b64_tr_b16 v[202:203], v4 offset:10240
    v_mfma_f32_16x16x32_bf16 v[116:119], v[208:211], a[28:31], v[116:119]
    v_mfma_f32_16x16x32_bf16 v[120:123], v[212:215], a[16:19], v[120:123]
    ds_read_b64_tr_b16 v[204:205], v6 offset:8192
    v_mfma_f32_16x16x32_bf16 v[124:127], v[212:215], a[20:23], v[124:127]
    v_mfma_f32_16x16x32_bf16 v[128:131], v[212:215], a[24:27], v[128:131]
    ds_read_b64_tr_b16 v[206:207], v6 offset:10240
    v_mfma_f32_16x16x32_bf16 v[132:135], v[212:215], a[28:31], v[132:135]
    s_waitcnt lgkmcnt(4)
    v_mfma_f32_16x16x32_bf16 v[104:107], v[216:219], a[32:35], v[104:107]
    ds_read_b64_tr_b16 v[208:209], v4 offset:12288
    buffer_store_dwordx4 v[32:35], v8, s[24:27], s62 offen offset:3072 sc1
    v_mfma_f32_16x16x32_bf16 v[108:111], v[216:219], a[36:39], v[108:111]
    s_nop 0
    v_cvt_pk_bf16_f32 v20, v72, v73
    v_mfma_f32_16x16x32_bf16 v[112:115], v[216:219], a[40:43], v[112:115]
    ds_read_b64_tr_b16 v[210:211], v4 offset:14336
    v_cvt_pk_bf16_f32 v21, v74, v75
    v_mfma_f32_16x16x32_bf16 v[116:119], v[216:219], a[44:47], v[116:119]
    v_cvt_pk_bf16_f32 v22, v88, v89
    v_cvt_pk_bf16_f32 v23, v90, v91
    v_mfma_f32_16x16x32_bf16 v[120:123], v[220:223], a[32:35], v[120:123]
    ds_read_b64_tr_b16 v[212:213], v6 offset:12288
    v_cvt_pk_bf16_f32 v24, v76, v77
    v_mfma_f32_16x16x32_bf16 v[124:127], v[220:223], a[36:39], v[124:127]
    v_cvt_pk_bf16_f32 v25, v78, v79
    v_cvt_pk_bf16_f32 v26, v92, v93
    v_mfma_f32_16x16x32_bf16 v[128:131], v[220:223], a[40:43], v[128:131]
    ds_read_b64_tr_b16 v[214:215], v6 offset:14336
    v_cvt_pk_bf16_f32 v27, v94, v95
    v_mfma_f32_16x16x32_bf16 v[132:135], v[220:223], a[44:47], v[132:135]
    v_cvt_pk_bf16_f32 v28, v80, v81
    s_waitcnt lgkmcnt(4)
    v_mfma_f32_16x16x32_bf16 v[104:107], v[200:203], a[48:51], v[104:107]
    ds_read_b64_tr_b16 v[216:217], v4 offset:16384
    v_cvt_pk_bf16_f32 v29, v82, v83
    v_mfma_f32_16x16x32_bf16 v[108:111], v[200:203], a[52:55], v[108:111]
    v_cvt_pk_bf16_f32 v30, v96, v97
    v_cvt_pk_bf16_f32 v31, v98, v99
    v_mfma_f32_16x16x32_bf16 v[112:115], v[200:203], a[56:59], v[112:115]
    ds_read_b64_tr_b16 v[218:219], v4 offset:18432
    v_cvt_pk_bf16_f32 v32, v84, v85
    v_mfma_f32_16x16x32_bf16 v[116:119], v[200:203], a[60:63], v[116:119]
    v_cvt_pk_bf16_f32 v33, v86, v87
    v_cvt_pk_bf16_f32 v34, v100, v101
    v_mfma_f32_16x16x32_bf16 v[120:123], v[204:207], a[48:51], v[120:123]
    ds_read_b64_tr_b16 v[220:221], v6 offset:16384
    v_cvt_pk_bf16_f32 v35, v102, v103
    v_mfma_f32_16x16x32_bf16 v[124:127], v[204:207], a[52:55], v[124:127]
    s_add_u32 s62, s94, 16384
    s_nop 0
    v_mfma_f32_16x16x32_bf16 v[128:131], v[204:207], a[56:59], v[128:131]
    ds_read_b64_tr_b16 v[222:223], v6 offset:18432
    v_permlane16_swap_b32 v20, v22
    v_mfma_f32_16x16x32_bf16 v[132:135], v[204:207], a[60:63], v[132:135]
    s_waitcnt vmcnt(10) lgkmcnt(4)
    s_barrier
    v_mfma_f32_16x16x32_bf16 v[104:107], v[208:211], a[64:67], v[104:107]
    ds_read_b64_tr_b16 v[200:201], v3 offset:0
    v_permlane16_swap_b32 v21, v23
    v_mfma_f32_16x16x32_bf16 v[108:111], v[208:211], a[68:71], v[108:111]
    v_permlane16_swap_b32 v24, v26
    v_permlane16_swap_b32 v25, v27
    v_mfma_f32_16x16x32_bf16 v[112:115], v[208:211], a[72:75], v[112:115]
    ds_read_b64_tr_b16 v[202:203], v3 offset:2048
    v_permlane16_swap_b32 v28, v30
    v_mfma_f32_16x16x32_bf16 v[116:119], v[208:211], a[76:79], v[116:119]
    v_permlane16_swap_b32 v29, v31
    v_permlane16_swap_b32 v32, v34
    v_mfma_f32_16x16x32_bf16 v[120:123], v[212:215], a[64:67], v[120:123]
    ds_read_b64_tr_b16 v[204:205], v5 offset:0
    v_permlane16_swap_b32 v33, v35
    v_mfma_f32_16x16x32_bf16 v[124:127], v[212:215], a[68:71], v[124:127]
    buffer_store_dwordx4 v[20:23], v8, s[24:27], s62 offen offset:0 sc1
    v_mfma_f32_16x16x32_bf16 v[128:131], v[212:215], a[72:75], v[128:131]
    ds_read_b64_tr_b16 v[206:207], v5 offset:2048
    v_mfma_f32_16x16x32_bf16 v[132:135], v[212:215], a[76:79], v[132:135]
    s_waitcnt lgkmcnt(4)
    v_mfma_f32_16x16x32_bf16 v[104:107], v[216:219], a[80:83], v[104:107]
    ds_read_b64_tr_b16 v[208:209], v3 offset:4096
    buffer_store_dwordx4 v[24:27], v8, s[24:27], s62 offen offset:1024 sc1
    v_mfma_f32_16x16x32_bf16 v[108:111], v[216:219], a[84:87], v[108:111]
    v_mfma_f32_16x16x32_bf16 v[112:115], v[216:219], a[88:91], v[112:115]
    ds_read_b64_tr_b16 v[210:211], v3 offset:6144
    v_mfma_f32_16x16x32_bf16 v[116:119], v[216:219], a[92:95], v[116:119]
    v_mfma_f32_16x16x32_bf16 v[120:123], v[220:223], a[80:83], v[120:123]
    ds_read_b64_tr_b16 v[212:213], v5 offset:4096
    v_mfma_f32_16x16x32_bf16 v[124:127], v[220:223], a[84:87], v[124:127]
    v_mfma_f32_16x16x32_bf16 v[128:131], v[220:223], a[88:91], v[128:131]
    ds_read_b64_tr_b16 v[214:215], v5 offset:6144
    v_mfma_f32_16x16x32_bf16 v[132:135], v[220:223], a[92:95], v[132:135]
    s_waitcnt lgkmcnt(4)
    v_mfma_f32_16x16x32_bf16 v[104:107], v[200:203], a[96:99], v[104:107]
    ds_read_b64_tr_b16 v[216:217], v3 offset:8192
    buffer_store_dwordx4 v[28:31], v8, s[24:27], s62 offen offset:2048 sc1
    v_mfma_f32_16x16x32_bf16 v[108:111], v[200:203], a[100:103], v[108:111]
    v_mfma_f32_16x16x32_bf16 v[112:115], v[200:203], a[104:107], v[112:115]
    ds_read_b64_tr_b16 v[218:219], v3 offset:10240
    v_mfma_f32_16x16x32_bf16 v[116:119], v[200:203], a[108:111], v[116:119]
    v_mfma_f32_16x16x32_bf16 v[120:123], v[204:207], a[96:99], v[120:123]
    ds_read_b64_tr_b16 v[220:221], v5 offset:8192
    v_mfma_f32_16x16x32_bf16 v[124:127], v[204:207], a[100:103], v[124:127]
    v_mfma_f32_16x16x32_bf16 v[128:131], v[204:207], a[104:107], v[128:131]
    ds_read_b64_tr_b16 v[222:223], v5 offset:10240
    v_mfma_f32_16x16x32_bf16 v[132:135], v[204:207], a[108:111], v[132:135]
    s_waitcnt lgkmcnt(4)
    v_mfma_f32_16x16x32_bf16 v[104:107], v[208:211], a[112:115], v[104:107]
    ds_read_b64_tr_b16 v[200:201], v3 offset:12288
    buffer_store_dwordx4 v[32:35], v8, s[24:27], s62 offen offset:3072 sc1
    v_mfma_f32_16x16x32_bf16 v[108:111], v[208:211], a[116:119], v[108:111]
    s_nop 0
    v_cvt_pk_bf16_f32 v20, v168, v169
    v_mfma_f32_16x16x32_bf16 v[112:115], v[208:211], a[120:123], v[112:115]
    ds_read_b64_tr_b16 v[202:203], v3 offset:14336
    v_cvt_pk_bf16_f32 v21, v170, v171
    v_mfma_f32_16x16x32_bf16 v[116:119], v[208:211], a[124:127], v[116:119]
    v_cvt_pk_bf16_f32 v22, v184, v185
    v_cvt_pk_bf16_f32 v23, v186, v187
    v_mfma_f32_16x16x32_bf16 v[120:123], v[212:215], a[112:115], v[120:123]
    ds_read_b64_tr_b16 v[204:205], v5 offset:12288
    v_cvt_pk_bf16_f32 v24, v172, v173
    v_mfma_f32_16x16x32_bf16 v[124:127], v[212:215], a[116:119], v[124:127]
    v_cvt_pk_bf16_f32 v25, v174, v175
    v_cvt_pk_bf16_f32 v26, v188, v189
    v_mfma_f32_16x16x32_bf16 v[128:131], v[212:215], a[120:123], v[128:131]
    ds_read_b64_tr_b16 v[206:207], v5 offset:14336
    v_cvt_pk_bf16_f32 v27, v190, v191
    v_mfma_f32_16x16x32_bf16 v[132:135], v[212:215], a[124:127], v[132:135]
    v_cvt_pk_bf16_f32 v28, v176, v177
    s_waitcnt lgkmcnt(4)
    v_mfma_f32_16x16x32_bf16 v[104:107], v[216:219], a[128:131], v[104:107]
    ds_read_b64_tr_b16 v[208:209], v3 offset:16384
    v_cvt_pk_bf16_f32 v29, v178, v179
    v_mfma_f32_16x16x32_bf16 v[108:111], v[216:219], a[132:135], v[108:111]
    v_cvt_pk_bf16_f32 v30, v192, v193
    v_cvt_pk_bf16_f32 v31, v194, v195
    v_mfma_f32_16x16x32_bf16 v[112:115], v[216:219], a[136:139], v[112:115]
    ds_read_b64_tr_b16 v[210:211], v3 offset:18432
    v_cvt_pk_bf16_f32 v32, v180, v181
    v_mfma_f32_16x16x32_bf16 v[116:119], v[216:219], a[140:143], v[116:119]
    v_cvt_pk_bf16_f32 v33, v182, v183
    v_cvt_pk_bf16_f32 v34, v196, v197
    v_mfma_f32_16x16x32_bf16 v[120:123], v[220:223], a[128:131], v[120:123]
    ds_read_b64_tr_b16 v[212:213], v5 offset:16384
    v_cvt_pk_bf16_f32 v35, v198, v199
    v_mfma_f32_16x16x32_bf16 v[124:127], v[220:223], a[132:135], v[124:127]
    s_add_u32 s62, s94, 32768
    s_nop 0
    v_mfma_f32_16x16x32_bf16 v[128:131], v[220:223], a[136:139], v[128:131]
    ds_read_b64_tr_b16 v[214:215], v5 offset:18432
    v_permlane16_swap_b32 v20, v22
    v_mfma_f32_16x16x32_bf16 v[132:135], v[220:223], a[140:143], v[132:135]
    v_permlane16_swap_b32 v21, v23
    s_waitcnt lgkmcnt(4)
    v_mfma_f32_16x16x32_bf16 v[104:107], v[200:203], a[144:147], v[104:107]
    ds_read_b64_tr_b16 v[216:217], v3 offset:20480
    v_permlane16_swap_b32 v24, v26
    v_mfma_f32_16x16x32_bf16 v[108:111], v[200:203], a[148:151], v[108:111]
    v_permlane16_swap_b32 v25, v27
    v_permlane16_swap_b32 v28, v30
    v_mfma_f32_16x16x32_bf16 v[112:115], v[200:203], a[152:155], v[112:115]
    ds_read_b64_tr_b16 v[218:219], v3 offset:22528
    v_permlane16_swap_b32 v29, v31
    v_mfma_f32_16x16x32_bf16 v[116:119], v[200:203], a[156:159], v[116:119]
    v_permlane16_swap_b32 v32, v34
    v_permlane16_swap_b32 v33, v35
    v_mfma_f32_16x16x32_bf16 v[120:123], v[204:207], a[144:147], v[120:123]
    ds_read_b64_tr_b16 v[220:221], v5 offset:20480
    buffer_store_dwordx4 v[20:23], v8, s[24:27], s62 offen offset:0 sc1
    v_mfma_f32_16x16x32_bf16 v[124:127], v[204:207], a[148:151], v[124:127]
    v_mfma_f32_16x16x32_bf16 v[128:131], v[204:207], a[152:155], v[128:131]
    ds_read_b64_tr_b16 v[222:223], v5 offset:22528
    v_mfma_f32_16x16x32_bf16 v[132:135], v[204:207], a[156:159], v[132:135]
    s_waitcnt vmcnt(9) lgkmcnt(4)
    s_barrier
    v_mfma_f32_16x16x32_bf16 v[104:107], v[208:211], a[160:163], v[104:107]
    ds_read_b64_tr_b16 v[200:201], v3 offset:24576
    buffer_store_dwordx4 v[24:27], v8, s[24:27], s62 offen offset:1024 sc1
    v_mfma_f32_16x16x32_bf16 v[108:111], v[208:211], a[164:167], v[108:111]
    v_mfma_f32_16x16x32_bf16 v[112:115], v[208:211], a[168:171], v[112:115]
    ds_read_b64_tr_b16 v[202:203], v3 offset:26624
    v_mfma_f32_16x16x32_bf16 v[116:119], v[208:211], a[172:175], v[116:119]
    v_mfma_f32_16x16x32_bf16 v[120:123], v[212:215], a[160:163], v[120:123]
    ds_read_b64_tr_b16 v[204:205], v5 offset:24576
    v_mfma_f32_16x16x32_bf16 v[124:127], v[212:215], a[164:167], v[124:127]
    v_mfma_f32_16x16x32_bf16 v[128:131], v[212:215], a[168:171], v[128:131]
    ds_read_b64_tr_b16 v[206:207], v5 offset:26624
    v_mfma_f32_16x16x32_bf16 v[132:135], v[212:215], a[172:175], v[132:135]
    s_waitcnt lgkmcnt(4)
    v_mfma_f32_16x16x32_bf16 v[104:107], v[216:219], a[176:179], v[104:107]
    ds_read_b64_tr_b16 v[208:209], v3 offset:28672
    buffer_store_dwordx4 v[28:31], v8, s[24:27], s62 offen offset:2048 sc1
    v_mfma_f32_16x16x32_bf16 v[108:111], v[216:219], a[180:183], v[108:111]
    v_mfma_f32_16x16x32_bf16 v[112:115], v[216:219], a[184:187], v[112:115]
    ds_read_b64_tr_b16 v[210:211], v3 offset:30720
    v_mfma_f32_16x16x32_bf16 v[116:119], v[216:219], a[188:191], v[116:119]
    v_mfma_f32_16x16x32_bf16 v[120:123], v[220:223], a[176:179], v[120:123]
    ds_read_b64_tr_b16 v[212:213], v5 offset:28672
    v_mfma_f32_16x16x32_bf16 v[124:127], v[220:223], a[180:183], v[124:127]
    v_mfma_f32_16x16x32_bf16 v[128:131], v[220:223], a[184:187], v[128:131]
    ds_read_b64_tr_b16 v[214:215], v5 offset:30720
    v_mfma_f32_16x16x32_bf16 v[132:135], v[220:223], a[188:191], v[132:135]
    s_waitcnt lgkmcnt(4)
    v_mfma_f32_16x16x32_bf16 v[104:107], v[200:203], a[192:195], v[104:107]
    ds_read_b64_tr_b16 v[216:217], v3 offset:32768
    buffer_store_dwordx4 v[32:35], v8, s[24:27], s62 offen offset:3072 sc1
    v_mfma_f32_16x16x32_bf16 v[108:111], v[200:203], a[196:199], v[108:111]
    s_nop 0
    v_cvt_pk_bf16_f32 v20, v136, v137
    v_mfma_f32_16x16x32_bf16 v[112:115], v[200:203], a[200:203], v[112:115]
    ds_read_b64_tr_b16 v[218:219], v3 offset:34816
    v_cvt_pk_bf16_f32 v21, v138, v139
    v_mfma_f32_16x16x32_bf16 v[116:119], v[200:203], a[204:207], v[116:119]
    v_cvt_pk_bf16_f32 v22, v140, v141
    v_cvt_pk_bf16_f32 v23, v142, v143
    v_mfma_f32_16x16x32_bf16 v[120:123], v[204:207], a[192:195], v[120:123]
    ds_read_b64_tr_b16 v[220:221], v5 offset:32768
    v_cvt_pk_bf16_f32 v24, v144, v145
    v_mfma_f32_16x16x32_bf16 v[124:127], v[204:207], a[196:199], v[124:127]
    v_cvt_pk_bf16_f32 v25, v146, v147
    v_cvt_pk_bf16_f32 v26, v148, v149
    v_mfma_f32_16x16x32_bf16 v[128:131], v[204:207], a[200:203], v[128:131]
    ds_read_b64_tr_b16 v[222:223], v5 offset:34816
    v_cvt_pk_bf16_f32 v27, v150, v151
    v_mfma_f32_16x16x32_bf16 v[132:135], v[204:207], a[204:207], v[132:135]
    s_nop 1
    s_waitcnt lgkmcnt(4)
    v_mfma_f32_16x16x32_bf16 v[104:107], v[208:211], a[208:211], v[104:107]
    ds_read_b64_tr_b16 v[200:201], v3 offset:36864
    v_permlane16_swap_b32 v20, v22
    v_mfma_f32_16x16x32_bf16 v[108:111], v[208:211], a[212:215], v[108:111]
    v_permlane16_swap_b32 v21, v23
    v_permlane16_swap_b32 v24, v26
    v_mfma_f32_16x16x32_bf16 v[112:115], v[208:211], a[216:219], v[112:115]
    ds_read_b64_tr_b16 v[202:203], v3 offset:38912
    v_permlane16_swap_b32 v25, v27
    v_mfma_f32_16x16x32_bf16 v[116:119], v[208:211], a[220:223], v[116:119]
    buffer_store_dwordx4 v[20:23], v1, s[24:27], 0 offen offset:0 sc1
    v_mfma_f32_16x16x32_bf16 v[120:123], v[212:215], a[208:211], v[120:123]
    ds_read_b64_tr_b16 v[204:205], v5 offset:36864
    v_mfma_f32_16x16x32_bf16 v[124:127], v[212:215], a[212:215], v[124:127]
    v_mfma_f32_16x16x32_bf16 v[128:131], v[212:215], a[216:219], v[128:131]
    ds_read_b64_tr_b16 v[206:207], v5 offset:38912
    v_mfma_f32_16x16x32_bf16 v[132:135], v[212:215], a[220:223], v[132:135]
    s_waitcnt lgkmcnt(4)
    v_mfma_f32_16x16x32_bf16 v[104:107], v[216:219], a[224:227], v[104:107]
    ds_read_b64_tr_b16 v[208:209], v3 offset:40960
    buffer_store_dwordx4 v[24:27], v1, s[24:27], 0 offen offset:1024 sc1
    v_mfma_f32_16x16x32_bf16 v[108:111], v[216:219], a[228:231], v[108:111]
    v_mfma_f32_16x16x32_bf16 v[112:115], v[216:219], a[232:235], v[112:115]
    ds_read_b64_tr_b16 v[210:211], v3 offset:43008
    v_mfma_f32_16x16x32_bf16 v[116:119], v[216:219], a[236:239], v[116:119]
    v_mfma_f32_16x16x32_bf16 v[120:123], v[220:223], a[224:227], v[120:123]
    ds_read_b64_tr_b16 v[212:213], v5 offset:40960
    v_mfma_f32_16x16x32_bf16 v[124:127], v[220:223], a[228:231], v[124:127]
    v_mfma_f32_16x16x32_bf16 v[128:131], v[220:223], a[232:235], v[128:131]
    ds_read_b64_tr_b16 v[214:215], v5 offset:43008
    v_mfma_f32_16x16x32_bf16 v[132:135], v[220:223], a[236:239], v[132:135]
    s_waitcnt lgkmcnt(4)
    v_mfma_f32_16x16x32_bf16 v[104:107], v[200:203], a[240:243], v[104:107]
    ds_read_b64_tr_b16 v[216:217], v3 offset:45056
    v_mfma_f32_16x16x32_bf16 v[108:111], v[200:203], a[244:247], v[108:111]
    v_mfma_f32_16x16x32_bf16 v[112:115], v[200:203], a[248:251], v[112:115]
    ds_read_b64_tr_b16 v[218:219], v3 offset:47104
    v_mfma_f32_16x16x32_bf16 v[116:119], v[200:203], a[252:255], v[116:119]
    v_mfma_f32_16x16x32_bf16 v[120:123], v[204:207], a[240:243], v[120:123]
    ds_read_b64_tr_b16 v[220:221], v5 offset:45056
    v_mfma_f32_16x16x32_bf16 v[124:127], v[204:207], a[244:247], v[124:127]
    v_mfma_f32_16x16x32_bf16 v[128:131], v[204:207], a[248:251], v[128:131]
    ds_read_b64_tr_b16 v[222:223], v5 offset:47104
    v_mfma_f32_16x16x32_bf16 v[132:135], v[204:207], a[252:255], v[132:135]
    s_waitcnt lgkmcnt(4)
    v_mfma_f32_16x16x32_bf16 v[104:107], v[208:211], v[224:227], v[104:107]
    v_mfma_f32_16x16x32_bf16 v[108:111], v[208:211], v[228:231], v[108:111]
    v_mfma_f32_16x16x32_bf16 v[112:115], v[208:211], v[232:235], v[112:115]
    v_mfma_f32_16x16x32_bf16 v[116:119], v[208:211], v[236:239], v[116:119]
    v_mfma_f32_16x16x32_bf16 v[120:123], v[212:215], v[224:227], v[120:123]
    v_mfma_f32_16x16x32_bf16 v[124:127], v[212:215], v[228:231], v[124:127]
    v_mfma_f32_16x16x32_bf16 v[128:131], v[212:215], v[232:235], v[128:131]
    v_mfma_f32_16x16x32_bf16 v[132:135], v[212:215], v[236:239], v[132:135]
    s_waitcnt lgkmcnt(0)
    v_mfma_f32_16x16x32_bf16 v[104:107], v[216:219], v[240:243], v[104:107]
    v_mfma_f32_16x16x32_bf16 v[108:111], v[216:219], v[244:247], v[108:111]
    v_mfma_f32_16x16x32_bf16 v[112:115], v[216:219], v[248:251], v[112:115]
    v_mfma_f32_16x16x32_bf16 v[116:119], v[216:219], v[252:255], v[116:119]
    v_mfma_f32_16x16x32_bf16 v[120:123], v[220:223], v[240:243], v[120:123]
    v_mfma_f32_16x16x32_bf16 v[124:127], v[220:223], v[244:247], v[124:127]
    v_mfma_f32_16x16x32_bf16 v[128:131], v[220:223], v[248:251], v[128:131]
    v_mfma_f32_16x16x32_bf16 v[132:135], v[220:223], v[252:255], v[132:135]
    s_nop 7
    v_cvt_pk_bf16_f32 v20, v104, v105
    v_cvt_pk_bf16_f32 v21, v106, v107
    v_cvt_pk_bf16_f32 v22, v120, v121
    v_cvt_pk_bf16_f32 v23, v122, v123
    v_cvt_pk_bf16_f32 v24, v108, v109
    v_cvt_pk_bf16_f32 v25, v110, v111
    v_cvt_pk_bf16_f32 v26, v124, v125
    v_cvt_pk_bf16_f32 v27, v126, v127
    v_cvt_pk_bf16_f32 v28, v112, v113
    v_cvt_pk_bf16_f32 v29, v114, v115
    v_cvt_pk_bf16_f32 v30, v128, v129
    v_cvt_pk_bf16_f32 v31, v130, v131
    v_cvt_pk_bf16_f32 v32, v116, v117
    v_cvt_pk_bf16_f32 v33, v118, v119
    v_cvt_pk_bf16_f32 v34, v132, v133
    v_cvt_pk_bf16_f32 v35, v134, v135
    s_add_u32 s62, s94, 49152
    s_nop 0
    v_permlane16_swap_b32 v20, v22
    v_permlane16_swap_b32 v21, v23
    v_permlane16_swap_b32 v24, v26
    v_permlane16_swap_b32 v25, v27
    v_permlane16_swap_b32 v28, v30
    v_permlane16_swap_b32 v29, v31
    v_permlane16_swap_b32 v32, v34
    v_permlane16_swap_b32 v33, v35
    buffer_store_dwordx4 v[20:23], v8, s[24:27], s62 offen offset:0 sc1
    buffer_store_dwordx4 v[24:27], v8, s[24:27], s62 offen offset:1024 sc1
    buffer_store_dwordx4 v[28:31], v8, s[24:27], s62 offen offset:2048 sc1
    buffer_store_dwordx4 v[32:35], v8, s[24:27], s62 offen offset:3072 sc1
    s_nop 0
ffn_kernel_end:
    s_endpgm
.text
.globl red_kernel
.p2align 8
.type red_kernel,@function
red_kernel:
    s_cmp_ge_u32 s2, 576
    s_cbranch_scc1 red_kernel_end
    s_load_dwordx2 s[4:5], s[0:1], 72
    s_load_dwordx2 s[6:7], s[0:1], 56
    s_mul_i32 s20, s2, 7282
    s_lshr_b32 s20, s20, 16
    s_mul_i32 s21, s20, 9
    s_sub_u32 s21, s2, s21
    v_lshrrev_b32 v1, 3, v0
    s_lshl_b32 s22, s20, 5
    v_add_u32 v1, s22, v1
    v_and_b32 v2, 7, v0
    s_movk_i32 s23, 1152
    v_mul_lo_u32 v3, v1, s23
    v_lshl_add_u32 v3, v2, 4, v3
    s_lshl_b32 s22, s21, 7
    v_add_u32 v3, s22, v3
    s_lshr_b32 s22, s20, 2
    s_mul_i32 s22, s22, 9
    s_add_u32 s22, s22, s21
    s_lshl_b32 s22, s22, 14
    v_and_b32 v10, 127, v1
    v_and_b32 v11, 3, v0
    s_cmp_eq_u32 s21, 4
    s_cbranch_scc1 red_kernel_l4
    v_lshlrev_b32 v10, 6, v10
    v_lshl_add_u32 v10, v11, 4, v10
    s_branch red_kernel_l4d
red_kernel_l4:
    v_lshlrev_b32 v10, 5, v10
    v_and_b32 v11, 1, v0
    v_lshl_add_u32 v10, v11, 4, v10
    v_bfe_u32 v11, v0, 1, 1
    v_lshl_add_u32 v10, v11, 12, v10
red_kernel_l4d:
    v_bfe_u32 v11, v0, 2, 1
    v_lshl_add_u32 v10, v11, 13, v10
    v_add_u32 v10, s22, v10
    v_lshlrev_b32 v2, 3, v1
    s_waitcnt lgkmcnt(0)
    s_add_u32 s8, s4, 6291456
    s_addc_u32 s9, s5, 0
    s_mov_b32 s10, 18874368
    s_mov_b32 s11, 0x20000
    s_mov_b32 s12, s4
    s_mov_b32 s13, s5
    s_mov_b32 s14, 2359296
    s_mov_b32 s15, 0x20000
    s_add_u32 s16, s4, 2359296
    s_addc_u32 s17, s5, 0
    s_mov_b32 s18, 16384
    s_mov_b32 s19, 0x20000
    s_mov_b32 s24, s6
    s_mov_b32 s25, s7
    s_mov_b32 s26, 2359296
    s_mov_b32 s27, 0x20000
    s_mov_b32 s28, 0
    buffer_load_dwordx4 v[32:35], v10, s[8:11], s28 offen
    s_mov_b32 s28, 2359296
    buffer_load_dwordx4 v[36:39], v10, s[8:11], s28 offen
    s_mov_b32 s28, 4718592
    buffer_load_dwordx4 v[40:43], v10, s[8:11], s28 offen
    s_mov_b32 s28, 7077888
    buffer_load_dwordx4 v[44:47], v10, s[8:11], s28 offen
    s_mov_b32 s28, 9437184
    buffer_load_dwordx4 v[48:51], v10, s[8:11], s28 offen
    s_mov_b32 s28, 11796480
    buffer_load_dwordx4 v[52:55], v10, s[8:11], s28 offen
    s_mov_b32 s28, 14155776
    buffer_load_dwordx4 v[56:59], v10, s[8:11], s28 offen
    s_mov_b32 s28, 16515072
    buffer_load_dwordx4 v[60:63], v10, s[8:11], s28 offen
    buffer_load_dwordx4 v[12:15], v3, s[12:15], 0 offen
    buffer_load_dwordx2 v[4:5], v2, s[16:19], 0 offen
    s_waitcnt vmcnt(9)
    v_lshlrev_b32 v20, 16, v32
    v_and_b32 v21, 0xffff0000, v32
    v_lshlrev_b32 v22, 16, v33
    v_and_b32 v23, 0xffff0000, v33
    v_lshlrev_b32 v24, 16, v34
    v_and_b32 v25, 0xffff0000, v34
    v_lshlrev_b32 v26, 16, v35
    v_and_b32 v27, 0xffff0000, v35
    s_waitcnt vmcnt(8)
    v_lshlrev_b32 v28, 16, v36
    v_and_b32 v29, 0xffff0000, v36
    v_pk_add_f32 v[20:21], v[20:21], v[28:29]
    v_lshlrev_b32 v28, 16, v37
    v_and_b32 v29, 0xffff0000, v37
    v_pk_add_f32 v[22:23], v[22:23], v[28:29]
    v_lshlrev_b32 v28, 16, v38
    v_and_b32 v29, 0xffff0000, v38
    v_pk_add_f32 v[24:25], v[24:25], v[28:29]
    v_lshlrev_b32 v28, 16, v39
    v_and_b32 v29, 0xffff0000, v39
    v_pk_add_f32 v[26:27], v[26:27], v[28:29]
    s_waitcnt vmcnt(7)
    v_lshlrev_b32 v28, 16, v40
    v_and_b32 v29, 0xffff0000, v40
    v_pk_add_f32 v[20:21], v[20:21], v[28:29]
    v_lshlrev_b32 v28, 16, v41
    v_and_b32 v29, 0xffff0000, v41
    v_pk_add_f32 v[22:23], v[22:23], v[28:29]
    v_lshlrev_b32 v28, 16, v42
    v_and_b32 v29, 0xffff0000, v42
    v_pk_add_f32 v[24:25], v[24:25], v[28:29]
    v_lshlrev_b32 v28, 16, v43
    v_and_b32 v29, 0xffff0000, v43
    v_pk_add_f32 v[26:27], v[26:27], v[28:29]
    s_waitcnt vmcnt(6)
    v_lshlrev_b32 v28, 16, v44
    v_and_b32 v29, 0xffff0000, v44
    v_pk_add_f32 v[20:21], v[20:21], v[28:29]
    v_lshlrev_b32 v28, 16, v45
    v_and_b32 v29, 0xffff0000, v45
    v_pk_add_f32 v[22:23], v[22:23], v[28:29]
    v_lshlrev_b32 v28, 16, v46
    v_and_b32 v29, 0xffff0000, v46
    v_pk_add_f32 v[24:25], v[24:25], v[28:29]
    v_lshlrev_b32 v28, 16, v47
    v_and_b32 v29, 0xffff0000, v47
    v_pk_add_f32 v[26:27], v[26:27], v[28:29]
    s_waitcnt vmcnt(5)
    v_lshlrev_b32 v28, 16, v48
    v_and_b32 v29, 0xffff0000, v48
    v_pk_add_f32 v[20:21], v[20:21], v[28:29]
    v_lshlrev_b32 v28, 16, v49
    v_and_b32 v29, 0xffff0000, v49
    v_pk_add_f32 v[22:23], v[22:23], v[28:29]
    v_lshlrev_b32 v28, 16, v50
    v_and_b32 v29, 0xffff0000, v50
    v_pk_add_f32 v[24:25], v[24:25], v[28:29]
    v_lshlrev_b32 v28, 16, v51
    v_and_b32 v29, 0xffff0000, v51
    v_pk_add_f32 v[26:27], v[26:27], v[28:29]
    s_waitcnt vmcnt(4)
    v_lshlrev_b32 v28, 16, v52
    v_and_b32 v29, 0xffff0000, v52
    v_pk_add_f32 v[20:21], v[20:21], v[28:29]
    v_lshlrev_b32 v28, 16, v53
    v_and_b32 v29, 0xffff0000, v53
    v_pk_add_f32 v[22:23], v[22:23], v[28:29]
    v_lshlrev_b32 v28, 16, v54
    v_and_b32 v29, 0xffff0000, v54
    v_pk_add_f32 v[24:25], v[24:25], v[28:29]
    v_lshlrev_b32 v28, 16, v55
    v_and_b32 v29, 0xffff0000, v55
    v_pk_add_f32 v[26:27], v[26:27], v[28:29]
    s_waitcnt vmcnt(3)
    v_lshlrev_b32 v28, 16, v56
    v_and_b32 v29, 0xffff0000, v56
    v_pk_add_f32 v[20:21], v[20:21], v[28:29]
    v_lshlrev_b32 v28, 16, v57
    v_and_b32 v29, 0xffff0000, v57
    v_pk_add_f32 v[22:23], v[22:23], v[28:29]
    v_lshlrev_b32 v28, 16, v58
    v_and_b32 v29, 0xffff0000, v58
    v_pk_add_f32 v[24:25], v[24:25], v[28:29]
    v_lshlrev_b32 v28, 16, v59
    v_and_b32 v29, 0xffff0000, v59
    v_pk_add_f32 v[26:27], v[26:27], v[28:29]
    s_waitcnt vmcnt(2)
    v_lshlrev_b32 v28, 16, v60
    v_and_b32 v29, 0xffff0000, v60
    v_pk_add_f32 v[20:21], v[20:21], v[28:29]
    v_lshlrev_b32 v28, 16, v61
    v_and_b32 v29, 0xffff0000, v61
    v_pk_add_f32 v[22:23], v[22:23], v[28:29]
    v_lshlrev_b32 v28, 16, v62
    v_and_b32 v29, 0xffff0000, v62
    v_pk_add_f32 v[24:25], v[24:25], v[28:29]
    v_lshlrev_b32 v28, 16, v63
    v_and_b32 v29, 0xffff0000, v63
    v_pk_add_f32 v[26:27], v[26:27], v[28:29]
    s_waitcnt vmcnt(0)
    v_mov_b32 v6, 0x3727c5ac
    v_fmac_f32 v6, 0x3ae38e39, v5
    v_mov_b32 v5, v6
    v_rcp_f32 v5, v5
    s_nop 0
    v_lshlrev_b32 v28, 16, v12
    v_and_b32 v29, 0xffff0000, v12
    v_add_f32 v28, v28, v4
    v_add_f32 v29, v29, v4
    v_fma_f32 v28, v20, v5, v28
    v_fma_f32 v29, v21, v5, v29
    v_cvt_pk_bf16_f32 v32, v28, v29
    v_lshlrev_b32 v28, 16, v13
    v_and_b32 v29, 0xffff0000, v13
    v_add_f32 v28, v28, v4
    v_add_f32 v29, v29, v4
    v_fma_f32 v28, v22, v5, v28
    v_fma_f32 v29, v23, v5, v29
    v_cvt_pk_bf16_f32 v33, v28, v29
    v_lshlrev_b32 v28, 16, v14
    v_and_b32 v29, 0xffff0000, v14
    v_add_f32 v28, v28, v4
    v_add_f32 v29, v29, v4
    v_fma_f32 v28, v24, v5, v28
    v_fma_f32 v29, v25, v5, v29
    v_cvt_pk_bf16_f32 v34, v28, v29
    v_lshlrev_b32 v28, 16, v15
    v_and_b32 v29, 0xffff0000, v15
    v_add_f32 v28, v28, v4
    v_add_f32 v29, v29, v4
    v_fma_f32 v28, v26, v5, v28
    v_fma_f32 v29, v27, v5, v29
    v_cvt_pk_bf16_f32 v35, v28, v29
    buffer_store_dwordx4 v[32:35], v3, s[24:27], 0 offen
red_kernel_end:
    s_endpgm
code_end:
    s_endpgm
.section .rodata,"a"
.p2align 6
kd_base:
.p2align 6
.amdhsa_kernel k1_kernel
  .amdhsa_next_free_vgpr 168
  .amdhsa_next_free_sgpr 102
  .amdhsa_accum_offset 168
  .amdhsa_group_segment_fixed_size 0
  .amdhsa_kernarg_size 80
  .amdhsa_user_sgpr_count 2
  .amdhsa_user_sgpr_kernarg_segment_ptr 1
  .amdhsa_system_sgpr_workgroup_id_x 1
  .amdhsa_float_denorm_mode_32 3
  .amdhsa_float_denorm_mode_16_64 3
.end_amdhsa_kernel
.p2align 6
.amdhsa_kernel k3_kernel
  .amdhsa_next_free_vgpr 256
  .amdhsa_next_free_sgpr 102
  .amdhsa_accum_offset 256
  .amdhsa_group_segment_fixed_size 0
  .amdhsa_kernarg_size 80
  .amdhsa_user_sgpr_count 2
  .amdhsa_user_sgpr_kernarg_segment_ptr 1
  .amdhsa_system_sgpr_workgroup_id_x 1
  .amdhsa_float_denorm_mode_32 3
  .amdhsa_float_denorm_mode_16_64 3
.end_amdhsa_kernel
.p2align 6
.amdhsa_kernel ffn_kernel
  .amdhsa_next_free_vgpr 512
  .amdhsa_next_free_sgpr 102
  .amdhsa_accum_offset 256
  .amdhsa_group_segment_fixed_size 0
  .amdhsa_kernarg_size 80
  .amdhsa_user_sgpr_count 2
  .amdhsa_user_sgpr_kernarg_segment_ptr 1
  .amdhsa_system_sgpr_workgroup_id_x 1
  .amdhsa_float_denorm_mode_32 3
  .amdhsa_float_denorm_mode_16_64 3
.end_amdhsa_kernel
.p2align 6
.amdhsa_kernel red_kernel
  .amdhsa_next_free_vgpr 96
  .amdhsa_next_free_sgpr 102
  .amdhsa_accum_offset 96
  .amdhsa_group_segment_fixed_size 0
  .amdhsa_kernarg_size 80
  .amdhsa_user_sgpr_count 2
  .amdhsa_user_sgpr_kernarg_segment_ptr 1
  .amdhsa_system_sgpr_workgroup_id_x 1
  .amdhsa_float_denorm_mode_32 3
  .amdhsa_float_denorm_mode_16_64 3
.end_amdhsa_kernel
```
